```python
import torch

def _softmax(x, axis=-1):
    return torch.softmax(x, dim=axis)

def _gelu(x):
    return torch.nn.functional.gelu(x, approximate='tanh')

def _silu(x):
    return torch.nn.functional.silu(x)

def _sigmoid(x):
    return torch.sigmoid(x)

def _layernorm(x, axis=-1, eps=1e-05):
    m = x.mean(dim=axis, keepdim=True)
    v = x.var(dim=axis, keepdim=True, unbiased=False)
    return (x - m) / torch.sqrt(v + eps)

def _scatter_add(tgt, idx, src, axis=0):
    return tgt.clone().index_add_(axis, idx, src)

def _segment_sum(src, seg, n):
    out = torch.zeros((n,) + src.shape[1:], dtype=src.dtype)
    return out.index_add_(0, seg, src)

def _pad(x, pw):
    flat = tuple((v for pair in reversed(pw) for v in pair))
    return torch.nn.functional.pad(x, flat)
kernel_name = 'parallel_sum__memory_aug_recurrent_mem_tr__swiglu_ffn__prompt'

def setup_inputs():

    _w = lambda a: (lambda t: t.to(torch.bfloat16) if t.is_floating_point() else t)(torch.as_tensor(a))

    def _A_setup():
        B, S, Dm = (1, 2048, 640)
        H, Dh = (32, 128)
        M, seg = (8, 32)
        seg = min(seg, S)
        S = S // seg * seg
        return {'x': _w((lambda *s: torch.randn(*s, dtype=torch.bfloat16) * 0.05)(B, S, Dm)), 'mem0': _w((lambda *s: torch.randn(*s, dtype=torch.bfloat16) * 1.6)(B, M, Dm)), 'Wq': _w((lambda *s: torch.randn(*s, dtype=torch.bfloat16) * 0.8)(Dm, H, Dh) * Dm ** (-0.5)), 'Wk': _w((lambda *s: torch.randn(*s, dtype=torch.bfloat16) * 0.8)(Dm, H, Dh) * Dm ** (-0.5)), 'Wv': _w((lambda *s: torch.randn(*s, dtype=torch.bfloat16) * 1.6)(Dm, H, Dh) * Dm ** (-0.5)), 'Wo': _w((lambda *s: torch.randn(*s, dtype=torch.bfloat16) * 1.6)(H, Dh, Dm) * (H * Dh) ** (-0.5)), 'seg_len': seg}
    _A_in = _A_setup()

    def _B_setup():
        B, S, D, F = (1, 2048, 640, 1728)
        return {'x': _w((lambda *s: torch.randn(*s, dtype=torch.bfloat16) * 0.05)(B, S, D)), 'w_gate': _w((lambda *s: torch.randn(*s, dtype=torch.bfloat16) * 0.05)(D, F)), 'w_up': _w((lambda *s: torch.randn(*s, dtype=torch.bfloat16) * 0.05)(D, F)), 'w_down': _w((lambda *s: torch.randn(*s, dtype=torch.bfloat16) * 0.05)(F, D))}
    _B_in = _B_setup()
    return {'A_x': _A_in['x'], 'A_mem0': _A_in['mem0'], 'A_Wq': _A_in['Wq'], 'A_Wk': _A_in['Wk'], 'A_Wv': _A_in['Wv'], 'A_Wo': _A_in['Wo'], 'A_seg_len': _A_in['seg_len'], 'B_x': _B_in['x'], 'B_w_gate': _B_in['w_gate'], 'B_w_up': _B_in['w_up'], 'B_w_down': _B_in['w_down']}

def reference(A_x, A_mem0, A_Wq, A_Wk, A_Wv, A_Wo, A_seg_len, B_x, B_w_gate, B_w_up, B_w_down):

    def _A_ref(x, mem0, Wq, Wk, Wv, Wo, seg_len):
        B, S, Dm = x.shape
        H, Dh = (Wq.shape[1], Wq.shape[2])
        M = mem0.shape[1]
        scale = Dh ** (-0.5)
        n_seg = S // seg_len
        L = M + seg_len
        idx = torch.arange(L)
        mask = (idx[:, None] < M) | (idx[:, None] >= idx[None, :])
        mem = mem0
        outs = []
        for s in range(n_seg):
            xs = x[:, s * seg_len:(s + 1) * seg_len, :].clone()
            h = torch.concatenate([mem, xs], axis=1)
            q = torch.einsum('btd,dhe->bhte', h, Wq)
            k = torch.einsum('btd,dhe->bhte', h, Wk)
            v = torch.einsum('btd,dhe->bhte', h, Wv)
            scores = torch.einsum('bhqe,bhke->bhqk', q, k) * scale
            scores = torch.where(mask[None, None], scores, -1000000000.0)
            p = _softmax(scores, axis=-1)
            o = torch.einsum('bhqk,bhke->bhqe', p, v)
            o = torch.einsum('bhte,hed->btd', o, Wo)
            mem = o[:, :M, :].clone()
            outs.append(o[:, M:, :])
        return torch.concatenate(outs, axis=1)

    def _B_ref(x, w_gate, w_up, w_down):
        g = _silu(x @ w_gate)
        u = x @ w_up
        return g * u @ w_down
    x = A_x
    xn = _layernorm(x, axis=-1)
    return x + _A_ref(xn, A_mem0, A_Wq, A_Wk, A_Wv, A_Wo, A_seg_len) + _B_ref(xn, B_w_gate, B_w_up, B_w_down)
```

```asm
; @launch grid=(256,1,1) block=(256,1,1) lds=163840
.amdgcn_target "amdgcn-amd-amdhsa--gfx950"
.text
.globl parallel_sum__memory_aug_recurrent_mem_tr__swiglu_ffn__prompt_kernel
.p2align 8
.type parallel_sum__memory_aug_recurrent_mem_tr__swiglu_ffn__prompt_kernel,@function
parallel_sum__memory_aug_recurrent_mem_tr__swiglu_ffn__prompt_kernel:
    s_cmp_ge_u32 s2, 256
    s_cbranch_scc1 END
    s_load_dwordx16 s[4:19], s[0:1], 0
    s_load_dwordx8 s[20:27], s[0:1], 64
    s_load_dwordx4 s[28:31], s[0:1], 96
    s_getreg_b32 s33, hwreg(HW_REG_XCC_ID, 0, 3)
    v_lshrrev_b32 v1, 6, v0
    s_nop 0
    v_readfirstlane_b32 s34, v1
    s_mov_b32 s36, s33
    s_lshr_b32 s35, s2, 3
    s_mov_b32 s37, 0
    s_mov_b32 s101, 1
    s_waitcnt lgkmcnt(0)
    s_mov_b32 s40, s30
    s_mov_b32 s41, s31
    s_mov_b32 s42, 0x10000000
    s_mov_b32 s43, 0x20000
    s_mov_b32 s44, s28
    s_mov_b32 s45, s29
    s_mov_b32 s46, 0x100
    s_mov_b32 s47, 0x20000
    s_cmp_lg_u32 s34, 1
    s_cbranch_scc1 NOINIT_1
    s_lshl_b32 s69, s33, 5
    s_lshl_b32 s70, 1, s35
    v_mov_b32 v1, s70
    s_mov_b64 exec, 1
    buffer_atomic_or v1, off, s[44:47], s69 offset:4
    s_mov_b64 exec, -1
    v_bfe_u32 v2, v0, 0, 6
    v_lshlrev_b32 v1, 4, v2
    v_mov_b32 v4, -1
    v_mov_b32 v8, 0
    v_mov_b32 v5, -1
    v_mov_b32 v9, 0
    v_mov_b32 v6, -1
    v_mov_b32 v10, 0
    v_mov_b32 v7, -1
    v_mov_b32 v11, 0
    s_mul_i32 s69, s2, 5120
    s_add_u32 s69, s69, 0x500000
    buffer_store_dwordx4 v[4:7], v1, s[40:43], s69 offen offset:0 sc1
    buffer_store_dwordx4 v[4:7], v1, s[40:43], s69 offen offset:1024 sc1
    buffer_store_dwordx4 v[4:7], v1, s[40:43], s69 offen offset:2048 sc1
    buffer_store_dwordx4 v[4:7], v1, s[40:43], s69 offen offset:3072 sc1
    s_add_u32 s69, s69, 4096
    buffer_store_dwordx4 v[4:7], v1, s[40:43], s69 offen sc1
    s_lshl_b32 s70, s2, 10
    s_add_u32 s69, s70, 0x400000
    buffer_store_dwordx4 v[4:7], v1, s[40:43], s69 offen sc1
    s_cmp_ge_u32 s2, 144
    s_cbranch_scc1 NOINIT_1_a
    s_add_u32 s69, s69, 0x40000
    buffer_store_dwordx4 v[4:7], v1, s[40:43], s69 offen sc1
    s_cmp_ge_u32 s2, 24
    s_cbranch_scc1 NOINIT_1_a
    buffer_store_dwordx4 v[8:11], v1, s[40:43], s70 offen sc1
NOINIT_1_a:
NOINIT_1:
    s_branch DISPATCH
RESPEC:
    s_waitcnt vmcnt(0) lgkmcnt(0)
    s_barrier
    s_load_dwordx16 s[4:19], s[0:1], 0
    s_load_dwordx8 s[20:27], s[0:1], 64
    s_load_dwordx4 s[28:31], s[0:1], 96
    s_mov_b32 s101, 0
    s_cmp_lg_u32 s34, 0
    s_cbranch_scc1 W0_2
    s_lshl_b32 s69, s33, 5
    v_mov_b32 v1, 1
    s_mov_b64 exec, 1
    buffer_atomic_add v1, off, s[44:47], s69 sc0
    s_mov_b64 exec, -1
    s_waitcnt vmcnt(0)
    v_readfirstlane_b32 s69, v1
    v_mov_b32 v2, 0
    s_nop 0
    v_mov_b32 v1, s69
    ds_write_b32 v2, v1
    s_waitcnt lgkmcnt(0)
W0_2:
    s_barrier
    v_mov_b32 v2, 0
    ds_read_b32 v1, v2
    s_waitcnt lgkmcnt(0)
    v_readfirstlane_b32 s3, v1
    s_barrier
    v_bfe_u32 v2, v0, 0, 3
    v_lshlrev_b32 v1, 5, v2
    s_mov_b32 s38, 262144
PL_3:
    buffer_load_dword v2, v1, s[44:47], 0 offen sc1
    s_waitcnt vmcnt(0)
    v_mov_b32 v3, v2
    s_nop 1
    v_add_u32_dpp v3, v3, v3 row_ror:4 row_mask:0xf bank_mask:0xf
    s_nop 1
    v_add_u32_dpp v3, v3, v3 quad_perm:[2,3,0,1] row_mask:0xf bank_mask:0xf
    s_nop 1
    v_add_u32_dpp v3, v3, v3 quad_perm:[1,0,3,2] row_mask:0xf bank_mask:0xf
    v_cmp_gt_u32 vcc, 0x100, v3
    s_cbranch_vccnz PN_4
    s_branch PO_5
PN_4:
    s_sleep 2
    s_sub_u32 s38, s38, 1
    s_cbranch_scc0 PL_3
    s_mov_b32 s68, 1
    s_branch FAIL
PO_5:
    s_waitcnt lgkmcnt(0)
    s_mov_b32 s36, s33
    s_mov_b32 s35, s3
    s_mov_b32 s37, 0
    v_cmp_ne_u32 vcc, 32, v2
    s_cbranch_vccz DISPATCH
    s_mov_b32 s37, 1
    s_mov_b32 s69, s3
    v_readlane_b32 s70, v2, 0
    s_cmp_gt_u32 s33, 0
    s_cselect_b32 s70, s70, 0
    s_add_u32 s69, s69, s70
    v_readlane_b32 s70, v2, 1
    s_cmp_gt_u32 s33, 1
    s_cselect_b32 s70, s70, 0
    s_add_u32 s69, s69, s70
    v_readlane_b32 s70, v2, 2
    s_cmp_gt_u32 s33, 2
    s_cselect_b32 s70, s70, 0
    s_add_u32 s69, s69, s70
    v_readlane_b32 s70, v2, 3
    s_cmp_gt_u32 s33, 3
    s_cselect_b32 s70, s70, 0
    s_add_u32 s69, s69, s70
    v_readlane_b32 s70, v2, 4
    s_cmp_gt_u32 s33, 4
    s_cselect_b32 s70, s70, 0
    s_add_u32 s69, s69, s70
    v_readlane_b32 s70, v2, 5
    s_cmp_gt_u32 s33, 5
    s_cselect_b32 s70, s70, 0
    s_add_u32 s69, s69, s70
    v_readlane_b32 s70, v2, 6
    s_cmp_gt_u32 s33, 6
    s_cselect_b32 s70, s70, 0
    s_add_u32 s69, s69, s70
    s_and_b32 s69, s69, 255
    s_lshr_b32 s36, s69, 5
    s_and_b32 s35, s69, 31
DISPATCH:
    s_cmp_lt_u32 s36, 2
    s_cbranch_scc1 ROLE_CHAIN
    s_cmp_lt_u32 s36, 4
    s_cbranch_scc1 ROLE_QAO
    s_cmp_lt_u32 s36, 6
    s_cbranch_scc1 ROLE_KV
    s_branch ROLE_FFN
ROLE_CHAIN:
    s_mov_b32 s48, s8
    s_mov_b32 s49, s9
    s_mov_b32 s50, 0x500000
    s_mov_b32 s51, 0x20000
    s_mov_b32 s52, s10
    s_mov_b32 s53, s11
    s_mov_b32 s54, 0x500000
    s_mov_b32 s55, 0x20000
    s_lshr_b32 s80, s35, 1
    s_lshl_b32 s69, s36, 4
    s_add_u32 s80, s80, s69
    s_and_b32 s81, s35, 1
    s_lshl_b32 s69, s80, 8
    s_lshl_b32 s70, s34, 17
    s_add_u32 s83, s69, s70
    v_bfe_u32 v28, v0, 0, 4
    v_lshlrev_b32 v100, 4, v28
    v_bfe_u32 v28, v0, 4, 1
    v_lshlrev_b32 v28, 5, v28
    v_xor_b32 v100, v28, v100
    v_bfe_u32 v28, v0, 4, 2
    s_mov_b32 s75, 8192
    v_mad_u32_u24 v100, v28, s75, v100
    v_bfe_u32 v28, v0, 0, 4
    v_lshlrev_b32 v101, 4, v28
    v_bfe_u32 v28, v0, 4, 1
    v_lshlrev_b32 v28, 5, v28
    v_xor_b32 v101, v28, v101
    v_xor_b32 v101, 64, v101
    v_bfe_u32 v28, v0, 4, 2
    s_mov_b32 s75, 8192
    v_mad_u32_u24 v101, v28, s75, v101
    v_bfe_u32 v28, v0, 0, 4
    v_lshlrev_b32 v102, 4, v28
    v_bfe_u32 v28, v0, 4, 1
    v_lshlrev_b32 v28, 5, v28
    v_xor_b32 v102, v28, v102
    v_xor_b32 v102, 128, v102
    v_bfe_u32 v28, v0, 4, 2
    s_mov_b32 s75, 8192
    v_mad_u32_u24 v102, v28, s75, v102
    v_bfe_u32 v28, v0, 0, 4
    v_lshlrev_b32 v103, 4, v28
    v_bfe_u32 v28, v0, 4, 1
    v_lshlrev_b32 v28, 5, v28
    v_xor_b32 v103, v28, v103
    v_xor_b32 v103, 192, v103
    v_bfe_u32 v28, v0, 4, 2
    s_mov_b32 s75, 8192
    v_mad_u32_u24 v103, v28, s75, v103
    s_cmp_eq_u32 s81, 1
    s_cbranch_scc1 SODD_6
    s_add_u32 s71, s83, 0
    s_lshl_b32 s70, s34, 12
    s_add_u32 m0, s70, 45056
    s_nop 0
    buffer_load_dwordx4 v100, s[48:51], s71 offen  lds
    s_add_u32 s69, s71, 32768
    s_lshl_b32 s70, s34, 12
    s_add_u32 m0, s70, 46080
    s_nop 0
    buffer_load_dwordx4 v101, s[48:51], s69 offen  lds
    s_add_u32 s69, s71, 65536
    s_lshl_b32 s70, s34, 12
    s_add_u32 m0, s70, 47104
    s_nop 0
    buffer_load_dwordx4 v102, s[48:51], s69 offen  lds
    s_add_u32 s69, s71, 98304
    s_lshl_b32 s70, s34, 12
    s_add_u32 m0, s70, 48128
    s_nop 0
    buffer_load_dwordx4 v103, s[48:51], s69 offen  lds
    s_cmp_lg_u32 s34, 1
    s_cbranch_scc1 CI_8
    s_cmp_eq_u32 s101, 0
    s_cbranch_scc1 CI_8
    s_waitcnt vmcnt(4)
    s_lshl_b32 s68, s33, 5
    s_add_u32 s68, s68, 16
    v_mov_b32 v28, 1
    s_mov_b64 exec, 1
    buffer_atomic_add v28, off, s[44:47], s68
    s_mov_b64 exec, -1
CI_8:
    s_add_u32 s71, s83, 0
    s_lshl_b32 s70, s34, 12
    s_add_u32 m0, s70, 61440
    s_nop 0
    buffer_load_dwordx4 v100, s[52:55], s71 offen  lds
    s_add_u32 s69, s71, 32768
    s_lshl_b32 s70, s34, 12
    s_add_u32 m0, s70, 62464
    s_nop 0
    buffer_load_dwordx4 v101, s[52:55], s69 offen  lds
    s_add_u32 s69, s71, 65536
    s_lshl_b32 s70, s34, 12
    s_add_u32 m0, s70, 63488
    s_nop 0
    buffer_load_dwordx4 v102, s[52:55], s69 offen  lds
    s_add_u32 s69, s71, 98304
    s_lshl_b32 s70, s34, 12
    s_add_u32 m0, s70, 64512
    s_nop 0
    buffer_load_dwordx4 v103, s[52:55], s69 offen  lds
    s_add_u32 s71, s83, 524288
    s_lshl_b32 s70, s34, 12
    s_add_u32 m0, s70, 77824
    s_nop 0
    buffer_load_dwordx4 v100, s[48:51], s71 offen  lds
    s_add_u32 s69, s71, 32768
    s_lshl_b32 s70, s34, 12
    s_add_u32 m0, s70, 78848
    s_nop 0
    buffer_load_dwordx4 v101, s[48:51], s69 offen  lds
    s_add_u32 s69, s71, 65536
    s_lshl_b32 s70, s34, 12
    s_add_u32 m0, s70, 79872
    s_nop 0
    buffer_load_dwordx4 v102, s[48:51], s69 offen  lds
    s_add_u32 s69, s71, 98304
    s_lshl_b32 s70, s34, 12
    s_add_u32 m0, s70, 80896
    s_nop 0
    buffer_load_dwordx4 v103, s[48:51], s69 offen  lds
    s_add_u32 s71, s83, 524288
    s_lshl_b32 s70, s34, 12
    s_add_u32 m0, s70, 94208
    s_nop 0
    buffer_load_dwordx4 v100, s[52:55], s71 offen  lds
    s_add_u32 s69, s71, 32768
    s_lshl_b32 s70, s34, 12
    s_add_u32 m0, s70, 95232
    s_nop 0
    buffer_load_dwordx4 v101, s[52:55], s69 offen  lds
    s_add_u32 s69, s71, 65536
    s_lshl_b32 s70, s34, 12
    s_add_u32 m0, s70, 96256
    s_nop 0
    buffer_load_dwordx4 v102, s[52:55], s69 offen  lds
    s_add_u32 s69, s71, 98304
    s_lshl_b32 s70, s34, 12
    s_add_u32 m0, s70, 97280
    s_nop 0
    buffer_load_dwordx4 v103, s[52:55], s69 offen  lds
    s_add_u32 s71, s83, 1048576
    s_lshl_b32 s70, s34, 12
    s_add_u32 m0, s70, 110592
    s_nop 0
    buffer_load_dwordx4 v100, s[48:51], s71 offen  lds
    s_add_u32 s69, s71, 32768
    s_lshl_b32 s70, s34, 12
    s_add_u32 m0, s70, 111616
    s_nop 0
    buffer_load_dwordx4 v101, s[48:51], s69 offen  lds
    s_add_u32 s69, s71, 65536
    s_lshl_b32 s70, s34, 12
    s_add_u32 m0, s70, 112640
    s_nop 0
    buffer_load_dwordx4 v102, s[48:51], s69 offen  lds
    s_add_u32 s69, s71, 98304
    s_lshl_b32 s70, s34, 12
    s_add_u32 m0, s70, 113664
    s_nop 0
    buffer_load_dwordx4 v103, s[48:51], s69 offen  lds
    s_mov_b32 s56, s12
    s_mov_b32 s57, s13
    s_mov_b32 s58, 0x500000
    s_mov_b32 s59, 0x20000
    s_mov_b32 s60, s14
    s_mov_b32 s61, s15
    s_mov_b32 s62, 0x500000
    s_mov_b32 s63, 0x20000
    s_mov_b32 s64, s6
    s_mov_b32 s65, s7
    s_mov_b32 s66, 0x2800
    s_mov_b32 s67, 0x20000
    s_lshl_b32 s69, s80, 8
    s_lshl_b32 s70, s34, 18
    s_add_u32 s84, s69, s70
    s_lshl_b32 s70, s81, 7
    s_add_u32 s84, s84, s70
    s_lshl_b32 s69, s80, 1
    s_add_u32 s69, s69, s81
    s_lshl_b32 s69, s69, 2
    s_add_u32 s69, s69, s34
    s_mul_i32 s85, s69, 20480
    v_bfe_u32 v28, v0, 0, 3
    v_lshlrev_b32 v104, 4, v28
    v_bfe_u32 v28, v0, 5, 1
    v_lshlrev_b32 v28, 5, v28
    v_xor_b32 v104, v28, v104
    v_bfe_u32 v28, v0, 3, 3
    v_lshl_add_u32 v104, v28, 13, v104
    v_bfe_u32 v28, v0, 0, 3
    v_lshlrev_b32 v105, 4, v28
    v_bfe_u32 v28, v0, 5, 1
    v_lshlrev_b32 v28, 5, v28
    v_xor_b32 v105, v28, v105
    v_xor_b32 v105, 64, v105
    v_bfe_u32 v28, v0, 3, 3
    v_lshl_add_u32 v105, v28, 13, v105
    v_bfe_u32 v28, v0, 6, 2
    v_lshlrev_b32 v106, 6, v28
    v_bfe_u32 v28, v0, 2, 1
    v_lshlrev_b32 v28, 5, v28
    v_xor_b32 v106, v28, v106
    v_bfe_u32 v28, v0, 4, 1
    v_lshlrev_b32 v28, 6, v28
    v_xor_b32 v106, v28, v106
    v_bfe_u32 v28, v0, 3, 1
    v_lshlrev_b32 v28, 7, v28
    v_xor_b32 v106, v28, v106
    v_bfe_u32 v28, v0, 0, 2
    v_lshl_add_u32 v106, v28, 3, v106
    v_bfe_u32 v28, v0, 5, 1
    v_lshl_add_u32 v106, v28, 12, v106
    v_bfe_u32 v28, v0, 4, 1
    v_lshl_add_u32 v106, v28, 10, v106
    v_bfe_u32 v28, v0, 2, 1
    v_lshl_add_u32 v106, v28, 8, v106
    v_bfe_u32 v28, v0, 3, 1
    v_lshl_add_u32 v106, v28, 11, v106
    v_xor_b32 v107, 32, v106
    v_add_u32 v106, 45056, v106
    v_add_u32 v107, 45056, v107
    v_add_u32 v108, 0x10000, v106
    v_add_u32 v109, 0x10000, v107
    v_bfe_u32 v28, v0, 6, 2
    v_lshlrev_b32 v110, 5, v28
    v_bfe_u32 v28, v0, 4, 1
    v_lshlrev_b32 v28, 5, v28
    v_xor_b32 v110, v28, v110
    v_bfe_u32 v28, v0, 3, 1
    v_lshlrev_b32 v28, 6, v28
    v_xor_b32 v110, v28, v110
    v_bfe_u32 v28, v0, 0, 2
    v_lshl_add_u32 v110, v28, 3, v110
    v_bfe_u32 v28, v0, 5, 1
    v_lshl_add_u32 v110, v28, 11, v110
    v_bfe_u32 v28, v0, 4, 1
    v_lshl_add_u32 v110, v28, 9, v110
    v_bfe_u32 v28, v0, 2, 1
    v_lshl_add_u32 v110, v28, 7, v110
    v_bfe_u32 v28, v0, 3, 1
    v_lshl_add_u32 v110, v28, 10, v110
    v_add_u32 v110, 45056, v110
    v_add_u32 v111, 0x10000, v110
    v_bfe_u32 v17, v0, 0, 6
    v_lshlrev_b32 v2, 4, v17
    v_add_u32 v3, 16384, v2
    v_mov_b32 v17, 0x4444
    v_mov_b32 v18, 0xeeee
    v_and_b32 v19, 2, v0
    v_cmp_ne_u32 vcc, 0, v19
    s_nop 1
    v_cndmask_b32 v1, v17, v18, vcc
    v_mov_b32 v4, 0x2800
    v_bfe_u32 v17, v0, 6, 2
    s_mov_b32 s75, 1280
    v_mad_u32_u24 v4, v17, s75, v4
    v_bfe_u32 v17, v0, 0, 2
    s_mov_b32 s75, 40
    v_mad_u32_u24 v4, v17, s75, v4
    v_bfe_u32 v17, v0, 2, 1
    s_mov_b32 s75, 320
    v_mad_u32_u24 v4, v17, s75, v4
    v_bfe_u32 v17, v0, 3, 1
    s_mov_b32 s75, 160
    v_mad_u32_u24 v4, v17, s75, v4
    v_bfe_u32 v17, v0, 4, 2
    v_lshl_add_u32 v4, v17, 3, v4
    v_mov_b32 v5, 0x2800
    v_bfe_u32 v17, v0, 5, 1
    s_mov_b32 s75, 640
    v_mad_u32_u24 v5, v17, s75, v5
    v_bfe_u32 v17, v0, 4, 1
    s_mov_b32 s75, 160
    v_mad_u32_u24 v5, v17, s75, v5
    v_bfe_u32 v17, v0, 2, 2
    s_mov_b32 s75, 40
    v_mad_u32_u24 v5, v17, s75, v5
    v_bfe_u32 v17, v0, 0, 2
    v_lshl_add_u32 v5, v17, 3, v5
    v_bfe_u32 v17, v0, 6, 2
    v_lshlrev_b32 v6, 8, v17
    v_bfe_u32 v17, v0, 2, 2
    v_lshl_add_u32 v6, v17, 6, v6
    v_bfe_u32 v17, v0, 5, 1
    v_lshl_add_u32 v6, v17, 5, v6
    v_bfe_u32 v17, v0, 0, 1
    v_lshl_add_u32 v6, v17, 4, v6
    v_bfe_u32 v17, v0, 4, 1
    v_lshl_add_u32 v6, v17, 3, v6
    v_bfe_u32 v17, v0, 3, 1
    v_lshlrev_b32 v17, 5, v17
    v_xor_b32 v6, v17, v6
    v_add_u32 v6, 15360, v6
    v_mov_b32 v18, 0x30000
    v_cndmask_b32 v6, v18, v6, vcc
    v_bfe_u32 v17, v0, 4, 2
    v_lshlrev_b32 v7, 12, v17
    v_bfe_u32 v17, v0, 0, 4
    v_lshl_add_u32 v7, v17, 3, v7
    v_bfe_u32 v17, v0, 1, 1
    v_lshlrev_b32 v8, 8, v17
    v_bfe_u32 v17, v0, 2, 1
    v_lshl_add_u32 v8, v17, 5, v8
    v_bfe_u32 v17, v0, 0, 1
    v_lshl_add_u32 v8, v17, 4, v8
    v_bfe_u32 v17, v0, 4, 1
    v_lshl_add_u32 v8, v17, 3, v8
    v_bfe_u32 v17, v0, 5, 1
    v_lshl_add_u32 v8, v17, 2, v8
    v_and_b32 v17, 8, v0
    v_cmp_ne_u32 vcc, 0, v17
    v_mov_b32 v18, 0x40000000
    s_nop 0
    v_cndmask_b32 v8, v8, v18, vcc
    v_and_b32 v17, 7, v0
    v_mov_b32 v18, 0x3f80
    v_mov_b32 v19, 0x3f800000
    v_mov_b32 v10, 0
    v_cmp_eq_u32 vcc, 0, v17
    s_nop 1
    v_cndmask_b32 v10, v10, v18, vcc
    v_cmp_eq_u32 vcc, 1, v17
    s_nop 1
    v_cndmask_b32 v10, v10, v19, vcc
    v_mov_b32 v11, 0
    v_cmp_eq_u32 vcc, 2, v17
    s_nop 1
    v_cndmask_b32 v11, v11, v18, vcc
    v_cmp_eq_u32 vcc, 3, v17
    s_nop 1
    v_cndmask_b32 v11, v11, v19, vcc
    v_mov_b32 v12, 0
    v_cmp_eq_u32 vcc, 4, v17
    s_nop 1
    v_cndmask_b32 v12, v12, v18, vcc
    v_cmp_eq_u32 vcc, 5, v17
    s_nop 1
    v_cndmask_b32 v12, v12, v19, vcc
    v_mov_b32 v13, 0
    v_cmp_eq_u32 vcc, 6, v17
    s_nop 1
    v_cndmask_b32 v13, v13, v18, vcc
    v_cmp_eq_u32 vcc, 7, v17
    s_nop 1
    v_cndmask_b32 v13, v13, v19, vcc
    v_and_b32 v17, 15, v0
    v_bfe_u32 v28, v0, 4, 2
    v_lshlrev_b32 v28, 2, v28
    v_sub_u32 v17, v17, v28
    v_mov_b32 v14, 0
    v_cmp_eq_u32 vcc, 0, v17
    s_nop 1
    v_cndmask_b32 v14, v14, v18, vcc
    v_cmp_eq_u32 vcc, 1, v17
    s_nop 1
    v_cndmask_b32 v14, v14, v19, vcc
    v_mov_b32 v15, 0
    v_cmp_eq_u32 vcc, 2, v17
    s_nop 1
    v_cndmask_b32 v15, v15, v18, vcc
    v_cmp_eq_u32 vcc, 3, v17
    s_nop 1
    v_cndmask_b32 v15, v15, v19, vcc
    v_mov_b32 v16, 0x3f803f80
    v_mov_b32 v17, 0x3f803f80
    v_mov_b32 v18, 0x3f803f80
    v_mov_b32 v19, 0x3f803f80
    s_mul_i32 s69, s34, 1280
    v_add_u32 v9, s69, v5
    s_mov_b32 s5, s80
    s_mov_b32 s6, s81
    s_mov_b32 s4, 0
    s_mov_b32 s8, 0x3e0293ee
    s_mov_b32 s9, 0x3e0293ee
    s_mov_b32 s10, 0xbe0293ee
    s_mul_i32 s69, s36, 655360
    s_add_u32 s69, s69, 0x500000
    s_lshl_b32 s70, s35, 7
    s_add_u32 s70, s70, s69
    s_lshl_b32 s71, s34, 14
    s_add_u32 s11, s70, s71
    s_lshr_b32 s71, s34, 1
    s_lshl_b32 s71, s71, 5
    s_add_u32 s71, s71, s35
    s_lshl_b32 s71, s71, 12
    s_and_b32 s72, s34, 1
    s_lshl_b32 s72, s72, 11
    s_add_u32 s71, s71, s72
    s_add_u32 s7, s71, s69
    s_add_u32 s71, s35, 64
    s_lshl_b32 s71, s71, 12
    s_lshl_b32 s72, s34, 10
    s_add_u32 s71, s71, s72
    s_add_u32 s71, s71, s69
    s_cmp_lt_u32 s35, 16
    s_cselect_b32 s31, s71, 0x40000000
    s_lshl_b32 s71, s34, 5
    s_add_u32 s71, s71, s35
    s_cmp_lt_u32 s71, 80
    s_cselect_b32 s16, 1, 0
    s_cselect_b32 s71, s71, 0
    s_lshl_b32 s72, s71, 12
    s_add_u32 s13, s69, s72
    s_mov_b32 s14, 0
    s_mov_b32 s15, 0
    s_lshr_b32 s73, s71, 2
    s_lshl_b32 s73, s73, 9
    s_and_b32 s72, s71, 3
    s_lshl_b32 s72, s72, 6
    s_add_u32 s73, s73, s72
    s_lshl_b32 s69, s36, 14
    s_add_u32 s69, s69, 0x444000
    s_add_u32 s18, s73, s69
    s_cmp_ge_u32 s71, 32
    s_cselect_b32 s71, 12288, 0
    s_add_u32 s73, s73, s71
    s_lshl_b32 s70, s36, 15
    s_add_u32 s70, s70, 0x400000
    s_add_u32 s17, s73, s70
    s_lshl_b32 s32, s34, 11
    s_lshl_b32 s39, s34, 9
    s_add_u32 s39, s39, 8192
    s_add_u32 s20, s32, s69
    s_add_u32 s12, s39, s69
    s_xor_b32 s70, s70, 0x8000
    s_cmp_ge_u32 s34, 2
    s_cselect_b32 s71, 12288, 0
    s_add_u32 s71, s71, s32
    s_add_u32 s19, s70, s71
    s_add_u32 s71, s39, 12288
    s_add_u32 s29, s70, s71
    s_lshl_b32 s69, s5, 13
    s_lshl_b32 s70, s34, 11
    s_add_u32 s21, s69, s70
    s_add_u32 s21, s21, 0x2000000
    s_lshl_b32 s70, s6, 12
    s_add_u32 s69, s69, s70
    s_lshl_b32 s70, s34, 10
    s_add_u32 s69, s69, s70
    s_add_u32 s22, s69, 0x3000000
    s_lshl_b32 s69, s5, 12
    s_lshl_b32 s70, s34, 10
    s_add_u32 s69, s69, s70
    s_add_u32 s23, s69, 0x700000
    s_lshr_b32 s71, s34, 1
    s_cmp_eq_u32 s71, s6
    s_cselect_b32 s23, s23, 0x40000000
    s_add_u32 s30, s70, 8192
    s_lshl_b32 s69, s5, 11
    s_lshl_b32 s70, s6, 10
    s_add_u32 s69, s69, s70
    s_lshl_b32 s70, s34, 8
    s_add_u32 s69, s69, s70
    s_add_u32 s24, s69, 0xf00000
    s_lshl_b32 s69, s5, 7
    s_add_u32 s26, s69, 0x1000
    s_lshl_b32 s70, s6, 2
    s_add_u32 s69, s69, s70
    s_add_u32 s25, s69, 0x2000
    s_cmp_eq_u32 s34, 2
    s_cselect_b32 s25, s25, 0x40000000
    s_mov_b32 s27, 0
    s_mov_b32 s28, 16384
    s_waitcnt vmcnt(16) lgkmcnt(8)
    s_barrier
    s_add_u32 s71, s83, 1048576
    s_lshl_b32 s70, s34, 12
    s_add_u32 m0, s70, 126976
    s_nop 0
    buffer_load_dwordx4 v100, s[52:55], s71 offen  lds
    s_add_u32 s69, s71, 32768
    s_lshl_b32 s70, s34, 12
    s_add_u32 m0, s70, 128000
    s_nop 0
    buffer_load_dwordx4 v101, s[52:55], s69 offen  lds
    s_add_u32 s69, s71, 65536
    s_lshl_b32 s70, s34, 12
    s_add_u32 m0, s70, 129024
    s_nop 0
    buffer_load_dwordx4 v102, s[52:55], s69 offen  lds
    s_add_u32 s69, s71, 98304
    s_lshl_b32 s70, s34, 12
    s_add_u32 m0, s70, 130048
    s_nop 0
    buffer_load_dwordx4 v103, s[52:55], s69 offen  lds
    ds_read_b64_tr_b16 a[0:1], v106 offset:0
    ds_read_b64_tr_b16 a[2:3], v106 offset:512
    ds_read_b64_tr_b16 a[4:5], v106 offset:8192
    ds_read_b64_tr_b16 a[6:7], v106 offset:8704
    ds_read_b64_tr_b16 a[80:81], v107 offset:0
    ds_read_b64_tr_b16 a[82:83], v107 offset:512
    ds_read_b64_tr_b16 a[84:85], v107 offset:8192
    ds_read_b64_tr_b16 a[86:87], v107 offset:8704
    s_waitcnt vmcnt(16) lgkmcnt(8)
    s_barrier
    s_add_u32 s71, s83, 1572864
    s_lshl_b32 s70, s34, 12
    s_add_u32 m0, s70, 143360
    s_nop 0
    buffer_load_dwordx4 v100, s[48:51], s71 offen  lds
    s_add_u32 s69, s71, 32768
    s_lshl_b32 s70, s34, 12
    s_add_u32 m0, s70, 144384
    s_nop 0
    buffer_load_dwordx4 v101, s[48:51], s69 offen  lds
    s_add_u32 s69, s71, 65536
    s_lshl_b32 s70, s34, 12
    s_add_u32 m0, s70, 145408
    s_nop 0
    buffer_load_dwordx4 v102, s[48:51], s69 offen  lds
    s_add_u32 s69, s71, 98304
    s_lshl_b32 s70, s34, 12
    s_add_u32 m0, s70, 146432
    s_nop 0
    buffer_load_dwordx4 v103, s[48:51], s69 offen  lds
    ds_read_b64_tr_b16 a[160:161], v106 offset:16384
    ds_read_b64_tr_b16 a[162:163], v106 offset:16896
    ds_read_b64_tr_b16 a[164:165], v106 offset:24576
    ds_read_b64_tr_b16 a[166:167], v106 offset:25088
    ds_read_b64_tr_b16 a[240:241], v107 offset:16384
    ds_read_b64_tr_b16 a[242:243], v107 offset:16896
    ds_read_b64_tr_b16 a[244:245], v107 offset:24576
    ds_read_b64_tr_b16 a[246:247], v107 offset:25088
    s_waitcnt vmcnt(16) lgkmcnt(8)
    s_barrier
    s_add_u32 s71, s83, 1572864
    s_lshl_b32 s70, s34, 12
    s_add_u32 m0, s70, 45056
    s_nop 0
    buffer_load_dwordx4 v100, s[52:55], s71 offen  lds
    s_add_u32 s69, s71, 32768
    s_lshl_b32 s70, s34, 12
    s_add_u32 m0, s70, 46080
    s_nop 0
    buffer_load_dwordx4 v101, s[52:55], s69 offen  lds
    s_add_u32 s69, s71, 65536
    s_lshl_b32 s70, s34, 12
    s_add_u32 m0, s70, 47104
    s_nop 0
    buffer_load_dwordx4 v102, s[52:55], s69 offen  lds
    s_add_u32 s69, s71, 98304
    s_lshl_b32 s70, s34, 12
    s_add_u32 m0, s70, 48128
    s_nop 0
    buffer_load_dwordx4 v103, s[52:55], s69 offen  lds
    ds_read_b64_tr_b16 a[8:9], v106 offset:32768
    ds_read_b64_tr_b16 a[10:11], v106 offset:33280
    ds_read_b64_tr_b16 a[12:13], v106 offset:40960
    ds_read_b64_tr_b16 a[14:15], v106 offset:41472
    ds_read_b64_tr_b16 a[88:89], v107 offset:32768
    ds_read_b64_tr_b16 a[90:91], v107 offset:33280
    ds_read_b64_tr_b16 a[92:93], v107 offset:40960
    ds_read_b64_tr_b16 a[94:95], v107 offset:41472
    s_waitcnt vmcnt(16) lgkmcnt(8)
    s_barrier
    s_add_u32 s71, s83, 2097152
    s_lshl_b32 s70, s34, 12
    s_add_u32 m0, s70, 61440
    s_nop 0
    buffer_load_dwordx4 v100, s[48:51], s71 offen  lds
    s_add_u32 s69, s71, 32768
    s_lshl_b32 s70, s34, 12
    s_add_u32 m0, s70, 62464
    s_nop 0
    buffer_load_dwordx4 v101, s[48:51], s69 offen  lds
    s_add_u32 s69, s71, 65536
    s_lshl_b32 s70, s34, 12
    s_add_u32 m0, s70, 63488
    s_nop 0
    buffer_load_dwordx4 v102, s[48:51], s69 offen  lds
    s_add_u32 s69, s71, 98304
    s_lshl_b32 s70, s34, 12
    s_add_u32 m0, s70, 64512
    s_nop 0
    buffer_load_dwordx4 v103, s[48:51], s69 offen  lds
    ds_read_b64_tr_b16 a[168:169], v106 offset:49152
    ds_read_b64_tr_b16 a[170:171], v106 offset:49664
    ds_read_b64_tr_b16 a[172:173], v106 offset:57344
    ds_read_b64_tr_b16 a[174:175], v106 offset:57856
    ds_read_b64_tr_b16 a[248:249], v107 offset:49152
    ds_read_b64_tr_b16 a[250:251], v107 offset:49664
    ds_read_b64_tr_b16 a[252:253], v107 offset:57344
    ds_read_b64_tr_b16 a[254:255], v107 offset:57856
    s_waitcnt vmcnt(16) lgkmcnt(8)
    s_barrier
    s_add_u32 s71, s83, 2097152
    s_lshl_b32 s70, s34, 12
    s_add_u32 m0, s70, 77824
    s_nop 0
    buffer_load_dwordx4 v100, s[52:55], s71 offen  lds
    s_add_u32 s69, s71, 32768
    s_lshl_b32 s70, s34, 12
    s_add_u32 m0, s70, 78848
    s_nop 0
    buffer_load_dwordx4 v101, s[52:55], s69 offen  lds
    s_add_u32 s69, s71, 65536
    s_lshl_b32 s70, s34, 12
    s_add_u32 m0, s70, 79872
    s_nop 0
    buffer_load_dwordx4 v102, s[52:55], s69 offen  lds
    s_add_u32 s69, s71, 98304
    s_lshl_b32 s70, s34, 12
    s_add_u32 m0, s70, 80896
    s_nop 0
    buffer_load_dwordx4 v103, s[52:55], s69 offen  lds
    ds_read_b64_tr_b16 a[16:17], v108 offset:0
    ds_read_b64_tr_b16 a[18:19], v108 offset:512
    ds_read_b64_tr_b16 a[20:21], v108 offset:8192
    ds_read_b64_tr_b16 a[22:23], v108 offset:8704
    ds_read_b64_tr_b16 a[96:97], v109 offset:0
    ds_read_b64_tr_b16 a[98:99], v109 offset:512
    ds_read_b64_tr_b16 a[100:101], v109 offset:8192
    ds_read_b64_tr_b16 a[102:103], v109 offset:8704
    s_waitcnt vmcnt(16) lgkmcnt(8)
    s_barrier
    s_add_u32 s71, s83, 2621440
    s_lshl_b32 s70, s34, 12
    s_add_u32 m0, s70, 94208
    s_nop 0
    buffer_load_dwordx4 v100, s[48:51], s71 offen  lds
    s_add_u32 s69, s71, 32768
    s_lshl_b32 s70, s34, 12
    s_add_u32 m0, s70, 95232
    s_nop 0
    buffer_load_dwordx4 v101, s[48:51], s69 offen  lds
    s_add_u32 s69, s71, 65536
    s_lshl_b32 s70, s34, 12
    s_add_u32 m0, s70, 96256
    s_nop 0
    buffer_load_dwordx4 v102, s[48:51], s69 offen  lds
    s_add_u32 s69, s71, 98304
    s_lshl_b32 s70, s34, 12
    s_add_u32 m0, s70, 97280
    s_nop 0
    buffer_load_dwordx4 v103, s[48:51], s69 offen  lds
    ds_read_b64_tr_b16 a[176:177], v108 offset:16384
    ds_read_b64_tr_b16 a[178:179], v108 offset:16896
    ds_read_b64_tr_b16 a[180:181], v108 offset:24576
    ds_read_b64_tr_b16 a[182:183], v108 offset:25088
    ds_read_b64_tr_b16 v[112:113], v109 offset:16384
    ds_read_b64_tr_b16 v[114:115], v109 offset:16896
    ds_read_b64_tr_b16 v[116:117], v109 offset:24576
    ds_read_b64_tr_b16 v[118:119], v109 offset:25088
    s_waitcnt vmcnt(16) lgkmcnt(8)
    s_barrier
    s_add_u32 s71, s83, 2621440
    s_lshl_b32 s70, s34, 12
    s_add_u32 m0, s70, 110592
    s_nop 0
    buffer_load_dwordx4 v100, s[52:55], s71 offen  lds
    s_add_u32 s69, s71, 32768
    s_lshl_b32 s70, s34, 12
    s_add_u32 m0, s70, 111616
    s_nop 0
    buffer_load_dwordx4 v101, s[52:55], s69 offen  lds
    s_add_u32 s69, s71, 65536
    s_lshl_b32 s70, s34, 12
    s_add_u32 m0, s70, 112640
    s_nop 0
    buffer_load_dwordx4 v102, s[52:55], s69 offen  lds
    s_add_u32 s69, s71, 98304
    s_lshl_b32 s70, s34, 12
    s_add_u32 m0, s70, 113664
    s_nop 0
    buffer_load_dwordx4 v103, s[52:55], s69 offen  lds
    ds_read_b64_tr_b16 a[24:25], v108 offset:32768
    ds_read_b64_tr_b16 a[26:27], v108 offset:33280
    ds_read_b64_tr_b16 a[28:29], v108 offset:40960
    ds_read_b64_tr_b16 a[30:31], v108 offset:41472
    ds_read_b64_tr_b16 a[104:105], v109 offset:32768
    ds_read_b64_tr_b16 a[106:107], v109 offset:33280
    ds_read_b64_tr_b16 a[108:109], v109 offset:40960
    ds_read_b64_tr_b16 a[110:111], v109 offset:41472
    s_waitcnt vmcnt(16) lgkmcnt(8)
    s_barrier
    s_add_u32 s71, s83, 3145728
    s_lshl_b32 s70, s34, 12
    s_add_u32 m0, s70, 126976
    s_nop 0
    buffer_load_dwordx4 v100, s[48:51], s71 offen  lds
    s_add_u32 s69, s71, 32768
    s_lshl_b32 s70, s34, 12
    s_add_u32 m0, s70, 128000
    s_nop 0
    buffer_load_dwordx4 v101, s[48:51], s69 offen  lds
    s_add_u32 s69, s71, 65536
    s_lshl_b32 s70, s34, 12
    s_add_u32 m0, s70, 129024
    s_nop 0
    buffer_load_dwordx4 v102, s[48:51], s69 offen  lds
    s_add_u32 s69, s71, 98304
    s_lshl_b32 s70, s34, 12
    s_add_u32 m0, s70, 130048
    s_nop 0
    buffer_load_dwordx4 v103, s[48:51], s69 offen  lds
    ds_read_b64_tr_b16 a[184:185], v106 offset:0
    ds_read_b64_tr_b16 a[186:187], v106 offset:512
    ds_read_b64_tr_b16 a[188:189], v106 offset:8192
    ds_read_b64_tr_b16 a[190:191], v106 offset:8704
    ds_read_b64_tr_b16 v[120:121], v107 offset:0
    ds_read_b64_tr_b16 v[122:123], v107 offset:512
    ds_read_b64_tr_b16 v[124:125], v107 offset:8192
    ds_read_b64_tr_b16 v[126:127], v107 offset:8704
    s_waitcnt vmcnt(16) lgkmcnt(8)
    s_barrier
    s_add_u32 s71, s83, 3145728
    s_lshl_b32 s70, s34, 12
    s_add_u32 m0, s70, 143360
    s_nop 0
    buffer_load_dwordx4 v100, s[52:55], s71 offen  lds
    s_add_u32 s69, s71, 32768
    s_lshl_b32 s70, s34, 12
    s_add_u32 m0, s70, 144384
    s_nop 0
    buffer_load_dwordx4 v101, s[52:55], s69 offen  lds
    s_add_u32 s69, s71, 65536
    s_lshl_b32 s70, s34, 12
    s_add_u32 m0, s70, 145408
    s_nop 0
    buffer_load_dwordx4 v102, s[52:55], s69 offen  lds
    s_add_u32 s69, s71, 98304
    s_lshl_b32 s70, s34, 12
    s_add_u32 m0, s70, 146432
    s_nop 0
    buffer_load_dwordx4 v103, s[52:55], s69 offen  lds
    ds_read_b64_tr_b16 a[32:33], v106 offset:16384
    ds_read_b64_tr_b16 a[34:35], v106 offset:16896
    ds_read_b64_tr_b16 a[36:37], v106 offset:24576
    ds_read_b64_tr_b16 a[38:39], v106 offset:25088
    ds_read_b64_tr_b16 a[112:113], v107 offset:16384
    ds_read_b64_tr_b16 a[114:115], v107 offset:16896
    ds_read_b64_tr_b16 a[116:117], v107 offset:24576
    ds_read_b64_tr_b16 a[118:119], v107 offset:25088
    s_waitcnt vmcnt(16) lgkmcnt(8)
    s_barrier
    s_add_u32 s71, s83, 3670016
    s_lshl_b32 s70, s34, 12
    s_add_u32 m0, s70, 45056
    s_nop 0
    buffer_load_dwordx4 v100, s[48:51], s71 offen  lds
    s_add_u32 s69, s71, 32768
    s_lshl_b32 s70, s34, 12
    s_add_u32 m0, s70, 46080
    s_nop 0
    buffer_load_dwordx4 v101, s[48:51], s69 offen  lds
    s_add_u32 s69, s71, 65536
    s_lshl_b32 s70, s34, 12
    s_add_u32 m0, s70, 47104
    s_nop 0
    buffer_load_dwordx4 v102, s[48:51], s69 offen  lds
    s_add_u32 s69, s71, 98304
    s_lshl_b32 s70, s34, 12
    s_add_u32 m0, s70, 48128
    s_nop 0
    buffer_load_dwordx4 v103, s[48:51], s69 offen  lds
    ds_read_b64_tr_b16 a[192:193], v106 offset:32768
    ds_read_b64_tr_b16 a[194:195], v106 offset:33280
    ds_read_b64_tr_b16 a[196:197], v106 offset:40960
    ds_read_b64_tr_b16 a[198:199], v106 offset:41472
    ds_read_b64_tr_b16 v[128:129], v107 offset:32768
    ds_read_b64_tr_b16 v[130:131], v107 offset:33280
    ds_read_b64_tr_b16 v[132:133], v107 offset:40960
    ds_read_b64_tr_b16 v[134:135], v107 offset:41472
    s_waitcnt vmcnt(16) lgkmcnt(8)
    s_barrier
    s_add_u32 s71, s83, 3670016
    s_lshl_b32 s70, s34, 12
    s_add_u32 m0, s70, 61440
    s_nop 0
    buffer_load_dwordx4 v100, s[52:55], s71 offen  lds
    s_add_u32 s69, s71, 32768
    s_lshl_b32 s70, s34, 12
    s_add_u32 m0, s70, 62464
    s_nop 0
    buffer_load_dwordx4 v101, s[52:55], s69 offen  lds
    s_add_u32 s69, s71, 65536
    s_lshl_b32 s70, s34, 12
    s_add_u32 m0, s70, 63488
    s_nop 0
    buffer_load_dwordx4 v102, s[52:55], s69 offen  lds
    s_add_u32 s69, s71, 98304
    s_lshl_b32 s70, s34, 12
    s_add_u32 m0, s70, 64512
    s_nop 0
    buffer_load_dwordx4 v103, s[52:55], s69 offen  lds
    ds_read_b64_tr_b16 a[40:41], v106 offset:49152
    ds_read_b64_tr_b16 a[42:43], v106 offset:49664
    ds_read_b64_tr_b16 a[44:45], v106 offset:57344
    ds_read_b64_tr_b16 a[46:47], v106 offset:57856
    ds_read_b64_tr_b16 a[120:121], v107 offset:49152
    ds_read_b64_tr_b16 a[122:123], v107 offset:49664
    ds_read_b64_tr_b16 a[124:125], v107 offset:57344
    ds_read_b64_tr_b16 a[126:127], v107 offset:57856
    s_waitcnt vmcnt(16) lgkmcnt(8)
    s_barrier
    s_add_u32 s71, s83, 4194304
    s_lshl_b32 s70, s34, 12
    s_add_u32 m0, s70, 77824
    s_nop 0
    buffer_load_dwordx4 v100, s[48:51], s71 offen  lds
    s_add_u32 s69, s71, 32768
    s_lshl_b32 s70, s34, 12
    s_add_u32 m0, s70, 78848
    s_nop 0
    buffer_load_dwordx4 v101, s[48:51], s69 offen  lds
    s_add_u32 s69, s71, 65536
    s_lshl_b32 s70, s34, 12
    s_add_u32 m0, s70, 79872
    s_nop 0
    buffer_load_dwordx4 v102, s[48:51], s69 offen  lds
    s_add_u32 s69, s71, 98304
    s_lshl_b32 s70, s34, 12
    s_add_u32 m0, s70, 80896
    s_nop 0
    buffer_load_dwordx4 v103, s[48:51], s69 offen  lds
    ds_read_b64_tr_b16 a[200:201], v108 offset:0
    ds_read_b64_tr_b16 a[202:203], v108 offset:512
    ds_read_b64_tr_b16 a[204:205], v108 offset:8192
    ds_read_b64_tr_b16 a[206:207], v108 offset:8704
    ds_read_b64_tr_b16 v[136:137], v109 offset:0
    ds_read_b64_tr_b16 v[138:139], v109 offset:512
    ds_read_b64_tr_b16 v[140:141], v109 offset:8192
    ds_read_b64_tr_b16 v[142:143], v109 offset:8704
    s_waitcnt vmcnt(16) lgkmcnt(8)
    s_barrier
    s_add_u32 s71, s83, 4194304
    s_lshl_b32 s70, s34, 12
    s_add_u32 m0, s70, 94208
    s_nop 0
    buffer_load_dwordx4 v100, s[52:55], s71 offen  lds
    s_add_u32 s69, s71, 32768
    s_lshl_b32 s70, s34, 12
    s_add_u32 m0, s70, 95232
    s_nop 0
    buffer_load_dwordx4 v101, s[52:55], s69 offen  lds
    s_add_u32 s69, s71, 65536
    s_lshl_b32 s70, s34, 12
    s_add_u32 m0, s70, 96256
    s_nop 0
    buffer_load_dwordx4 v102, s[52:55], s69 offen  lds
    s_add_u32 s69, s71, 98304
    s_lshl_b32 s70, s34, 12
    s_add_u32 m0, s70, 97280
    s_nop 0
    buffer_load_dwordx4 v103, s[52:55], s69 offen  lds
    ds_read_b64_tr_b16 a[48:49], v108 offset:16384
    ds_read_b64_tr_b16 a[50:51], v108 offset:16896
    ds_read_b64_tr_b16 a[52:53], v108 offset:24576
    ds_read_b64_tr_b16 a[54:55], v108 offset:25088
    ds_read_b64_tr_b16 a[128:129], v109 offset:16384
    ds_read_b64_tr_b16 a[130:131], v109 offset:16896
    ds_read_b64_tr_b16 a[132:133], v109 offset:24576
    ds_read_b64_tr_b16 a[134:135], v109 offset:25088
    s_waitcnt vmcnt(16) lgkmcnt(8)
    s_barrier
    s_add_u32 s71, s83, 4718592
    s_lshl_b32 s70, s34, 12
    s_add_u32 m0, s70, 110592
    s_nop 0
    buffer_load_dwordx4 v100, s[48:51], s71 offen  lds
    s_add_u32 s69, s71, 32768
    s_lshl_b32 s70, s34, 12
    s_add_u32 m0, s70, 111616
    s_nop 0
    buffer_load_dwordx4 v101, s[48:51], s69 offen  lds
    s_add_u32 s69, s71, 65536
    s_lshl_b32 s70, s34, 12
    s_add_u32 m0, s70, 112640
    s_nop 0
    buffer_load_dwordx4 v102, s[48:51], s69 offen  lds
    s_add_u32 s69, s71, 98304
    s_lshl_b32 s70, s34, 12
    s_add_u32 m0, s70, 113664
    s_nop 0
    buffer_load_dwordx4 v103, s[48:51], s69 offen  lds
    ds_read_b64_tr_b16 a[208:209], v108 offset:32768
    ds_read_b64_tr_b16 a[210:211], v108 offset:33280
    ds_read_b64_tr_b16 a[212:213], v108 offset:40960
    ds_read_b64_tr_b16 a[214:215], v108 offset:41472
    ds_read_b64_tr_b16 v[144:145], v109 offset:32768
    ds_read_b64_tr_b16 v[146:147], v109 offset:33280
    ds_read_b64_tr_b16 v[148:149], v109 offset:40960
    ds_read_b64_tr_b16 v[150:151], v109 offset:41472
    s_waitcnt vmcnt(16) lgkmcnt(8)
    s_barrier
    s_add_u32 s71, s83, 4718592
    s_lshl_b32 s70, s34, 12
    s_add_u32 m0, s70, 126976
    s_nop 0
    buffer_load_dwordx4 v100, s[52:55], s71 offen  lds
    s_add_u32 s69, s71, 32768
    s_lshl_b32 s70, s34, 12
    s_add_u32 m0, s70, 128000
    s_nop 0
    buffer_load_dwordx4 v101, s[52:55], s69 offen  lds
    s_add_u32 s69, s71, 65536
    s_lshl_b32 s70, s34, 12
    s_add_u32 m0, s70, 129024
    s_nop 0
    buffer_load_dwordx4 v102, s[52:55], s69 offen  lds
    s_add_u32 s69, s71, 98304
    s_lshl_b32 s70, s34, 12
    s_add_u32 m0, s70, 130048
    s_nop 0
    buffer_load_dwordx4 v103, s[52:55], s69 offen  lds
    ds_read_b64_tr_b16 a[56:57], v106 offset:0
    ds_read_b64_tr_b16 a[58:59], v106 offset:512
    ds_read_b64_tr_b16 a[60:61], v106 offset:8192
    ds_read_b64_tr_b16 a[62:63], v106 offset:8704
    ds_read_b64_tr_b16 a[136:137], v107 offset:0
    ds_read_b64_tr_b16 a[138:139], v107 offset:512
    ds_read_b64_tr_b16 a[140:141], v107 offset:8192
    ds_read_b64_tr_b16 a[142:143], v107 offset:8704
    v_mov_b32 v20, 0x4
    v_bfe_u32 v21, v0, 0, 3
    v_lshl_add_u32 v20, v21, 5, v20
    v_bfe_u32 v21, v0, 3, 1
    s_mov_b32 s75, 12
    v_mad_u32_u24 v20, v21, s75, v20
    buffer_load_dword v22, v20, s[44:47], 0 offen sc1
    s_waitcnt vmcnt(16) lgkmcnt(8)
    s_barrier
    s_add_u32 s71, s84, 0
    s_lshl_b32 s70, s34, 12
    s_add_u32 m0, s70, 143360
    s_nop 0
    buffer_load_dwordx4 v104, s[56:59], s71 offen  lds
    s_add_u32 s71, s84, 65536
    s_lshl_b32 s70, s34, 12
    s_add_u32 m0, s70, 144384
    s_nop 0
    buffer_load_dwordx4 v105, s[56:59], s71 offen  lds
    s_add_u32 s71, s84, 131072
    s_lshl_b32 s70, s34, 12
    s_add_u32 m0, s70, 145408
    s_nop 0
    buffer_load_dwordx4 v104, s[56:59], s71 offen  lds
    s_add_u32 s71, s84, 196608
    s_lshl_b32 s70, s34, 12
    s_add_u32 m0, s70, 146432
    s_nop 0
    buffer_load_dwordx4 v105, s[56:59], s71 offen  lds
    ds_read_b64_tr_b16 a[216:217], v106 offset:16384
    ds_read_b64_tr_b16 a[218:219], v106 offset:16896
    ds_read_b64_tr_b16 a[220:221], v106 offset:24576
    ds_read_b64_tr_b16 a[222:223], v106 offset:25088
    ds_read_b64_tr_b16 v[152:153], v107 offset:16384
    ds_read_b64_tr_b16 v[154:155], v107 offset:16896
    ds_read_b64_tr_b16 v[156:157], v107 offset:24576
    ds_read_b64_tr_b16 v[158:159], v107 offset:25088
    s_waitcnt vmcnt(16) lgkmcnt(8)
    s_barrier
    s_add_u32 s71, s84, 1048576
    s_lshl_b32 s70, s34, 12
    s_add_u32 m0, s70, 45056
    s_nop 0
    buffer_load_dwordx4 v104, s[56:59], s71 offen  lds
    s_add_u32 s71, s84, 1114112
    s_lshl_b32 s70, s34, 12
    s_add_u32 m0, s70, 46080
    s_nop 0
    buffer_load_dwordx4 v105, s[56:59], s71 offen  lds
    s_add_u32 s71, s84, 1179648
    s_lshl_b32 s70, s34, 12
    s_add_u32 m0, s70, 47104
    s_nop 0
    buffer_load_dwordx4 v104, s[56:59], s71 offen  lds
    s_add_u32 s71, s84, 1245184
    s_lshl_b32 s70, s34, 12
    s_add_u32 m0, s70, 48128
    s_nop 0
    buffer_load_dwordx4 v105, s[56:59], s71 offen  lds
    ds_read_b64_tr_b16 a[64:65], v106 offset:32768
    ds_read_b64_tr_b16 a[66:67], v106 offset:33280
    ds_read_b64_tr_b16 a[68:69], v106 offset:40960
    ds_read_b64_tr_b16 a[70:71], v106 offset:41472
    ds_read_b64_tr_b16 a[144:145], v107 offset:32768
    ds_read_b64_tr_b16 a[146:147], v107 offset:33280
    ds_read_b64_tr_b16 a[148:149], v107 offset:40960
    ds_read_b64_tr_b16 a[150:151], v107 offset:41472
    s_waitcnt vmcnt(16) lgkmcnt(8)
    s_barrier
    s_add_u32 s71, s84, 2097152
    s_lshl_b32 s70, s34, 12
    s_add_u32 m0, s70, 61440
    s_nop 0
    buffer_load_dwordx4 v104, s[56:59], s71 offen  lds
    s_add_u32 s71, s84, 2162688
    s_lshl_b32 s70, s34, 12
    s_add_u32 m0, s70, 62464
    s_nop 0
    buffer_load_dwordx4 v105, s[56:59], s71 offen  lds
    s_add_u32 s71, s84, 2228224
    s_lshl_b32 s70, s34, 12
    s_add_u32 m0, s70, 63488
    s_nop 0
    buffer_load_dwordx4 v104, s[56:59], s71 offen  lds
    s_add_u32 s71, s84, 2293760
    s_lshl_b32 s70, s34, 12
    s_add_u32 m0, s70, 64512
    s_nop 0
    buffer_load_dwordx4 v105, s[56:59], s71 offen  lds
    ds_read_b64_tr_b16 a[224:225], v106 offset:49152
    ds_read_b64_tr_b16 a[226:227], v106 offset:49664
    ds_read_b64_tr_b16 a[228:229], v106 offset:57344
    ds_read_b64_tr_b16 a[230:231], v106 offset:57856
    ds_read_b64_tr_b16 v[160:161], v107 offset:49152
    ds_read_b64_tr_b16 v[162:163], v107 offset:49664
    ds_read_b64_tr_b16 v[164:165], v107 offset:57344
    ds_read_b64_tr_b16 v[166:167], v107 offset:57856
    s_waitcnt vmcnt(16) lgkmcnt(8)
    s_barrier
    s_add_u32 s71, s84, 3145728
    s_lshl_b32 s70, s34, 12
    s_add_u32 m0, s70, 77824
    s_nop 0
    buffer_load_dwordx4 v104, s[56:59], s71 offen  lds
    s_add_u32 s71, s84, 3211264
    s_lshl_b32 s70, s34, 12
    s_add_u32 m0, s70, 78848
    s_nop 0
    buffer_load_dwordx4 v105, s[56:59], s71 offen  lds
    s_add_u32 s71, s84, 3276800
    s_lshl_b32 s70, s34, 12
    s_add_u32 m0, s70, 79872
    s_nop 0
    buffer_load_dwordx4 v104, s[56:59], s71 offen  lds
    s_add_u32 s71, s84, 3342336
    s_lshl_b32 s70, s34, 12
    s_add_u32 m0, s70, 80896
    s_nop 0
    buffer_load_dwordx4 v105, s[56:59], s71 offen  lds
    ds_read_b64_tr_b16 a[72:73], v108 offset:0
    ds_read_b64_tr_b16 a[74:75], v108 offset:512
    ds_read_b64_tr_b16 a[76:77], v108 offset:8192
    ds_read_b64_tr_b16 a[78:79], v108 offset:8704
    ds_read_b64_tr_b16 a[152:153], v109 offset:0
    ds_read_b64_tr_b16 a[154:155], v109 offset:512
    ds_read_b64_tr_b16 a[156:157], v109 offset:8192
    ds_read_b64_tr_b16 a[158:159], v109 offset:8704
    s_waitcnt vmcnt(16) lgkmcnt(8)
    s_barrier
    s_add_u32 s71, s84, 4194304
    s_lshl_b32 s70, s34, 12
    s_add_u32 m0, s70, 94208
    s_nop 0
    buffer_load_dwordx4 v104, s[56:59], s71 offen  lds
    s_add_u32 s71, s84, 4259840
    s_lshl_b32 s70, s34, 12
    s_add_u32 m0, s70, 95232
    s_nop 0
    buffer_load_dwordx4 v105, s[56:59], s71 offen  lds
    s_add_u32 s71, s84, 4325376
    s_lshl_b32 s70, s34, 12
    s_add_u32 m0, s70, 96256
    s_nop 0
    buffer_load_dwordx4 v104, s[56:59], s71 offen  lds
    s_add_u32 s71, s84, 4390912
    s_lshl_b32 s70, s34, 12
    s_add_u32 m0, s70, 97280
    s_nop 0
    buffer_load_dwordx4 v105, s[56:59], s71 offen  lds
    ds_read_b64_tr_b16 a[232:233], v108 offset:16384
    ds_read_b64_tr_b16 a[234:235], v108 offset:16896
    ds_read_b64_tr_b16 a[236:237], v108 offset:24576
    ds_read_b64_tr_b16 a[238:239], v108 offset:25088
    ds_read_b64_tr_b16 v[168:169], v109 offset:16384
    ds_read_b64_tr_b16 v[170:171], v109 offset:16896
    ds_read_b64_tr_b16 v[172:173], v109 offset:24576
    ds_read_b64_tr_b16 v[174:175], v109 offset:25088
    s_branch SJOIN_7
SODD_6:
    s_add_u32 s71, s83, 0
    s_lshl_b32 s70, s34, 12
    s_add_u32 m0, s70, 45056
    s_nop 0
    buffer_load_dwordx4 v100, s[52:55], s71 offen  lds
    s_add_u32 s69, s71, 32768
    s_lshl_b32 s70, s34, 12
    s_add_u32 m0, s70, 46080
    s_nop 0
    buffer_load_dwordx4 v101, s[52:55], s69 offen  lds
    s_add_u32 s69, s71, 65536
    s_lshl_b32 s70, s34, 12
    s_add_u32 m0, s70, 47104
    s_nop 0
    buffer_load_dwordx4 v102, s[52:55], s69 offen  lds
    s_add_u32 s69, s71, 98304
    s_lshl_b32 s70, s34, 12
    s_add_u32 m0, s70, 48128
    s_nop 0
    buffer_load_dwordx4 v103, s[52:55], s69 offen  lds
    s_cmp_lg_u32 s34, 1
    s_cbranch_scc1 CI_9
    s_cmp_eq_u32 s101, 0
    s_cbranch_scc1 CI_9
    s_waitcnt vmcnt(4)
    s_lshl_b32 s68, s33, 5
    s_add_u32 s68, s68, 16
    v_mov_b32 v28, 1
    s_mov_b64 exec, 1
    buffer_atomic_add v28, off, s[44:47], s68
    s_mov_b64 exec, -1
CI_9:
    s_add_u32 s71, s83, 0
    s_lshl_b32 s70, s34, 12
    s_add_u32 m0, s70, 61440
    s_nop 0
    buffer_load_dwordx4 v100, s[48:51], s71 offen  lds
    s_add_u32 s69, s71, 32768
    s_lshl_b32 s70, s34, 12
    s_add_u32 m0, s70, 62464
    s_nop 0
    buffer_load_dwordx4 v101, s[48:51], s69 offen  lds
    s_add_u32 s69, s71, 65536
    s_lshl_b32 s70, s34, 12
    s_add_u32 m0, s70, 63488
    s_nop 0
    buffer_load_dwordx4 v102, s[48:51], s69 offen  lds
    s_add_u32 s69, s71, 98304
    s_lshl_b32 s70, s34, 12
    s_add_u32 m0, s70, 64512
    s_nop 0
    buffer_load_dwordx4 v103, s[48:51], s69 offen  lds
    s_add_u32 s71, s83, 524288
    s_lshl_b32 s70, s34, 12
    s_add_u32 m0, s70, 77824
    s_nop 0
    buffer_load_dwordx4 v100, s[52:55], s71 offen  lds
    s_add_u32 s69, s71, 32768
    s_lshl_b32 s70, s34, 12
    s_add_u32 m0, s70, 78848
    s_nop 0
    buffer_load_dwordx4 v101, s[52:55], s69 offen  lds
    s_add_u32 s69, s71, 65536
    s_lshl_b32 s70, s34, 12
    s_add_u32 m0, s70, 79872
    s_nop 0
    buffer_load_dwordx4 v102, s[52:55], s69 offen  lds
    s_add_u32 s69, s71, 98304
    s_lshl_b32 s70, s34, 12
    s_add_u32 m0, s70, 80896
    s_nop 0
    buffer_load_dwordx4 v103, s[52:55], s69 offen  lds
    s_add_u32 s71, s83, 524288
    s_lshl_b32 s70, s34, 12
    s_add_u32 m0, s70, 94208
    s_nop 0
    buffer_load_dwordx4 v100, s[48:51], s71 offen  lds
    s_add_u32 s69, s71, 32768
    s_lshl_b32 s70, s34, 12
    s_add_u32 m0, s70, 95232
    s_nop 0
    buffer_load_dwordx4 v101, s[48:51], s69 offen  lds
    s_add_u32 s69, s71, 65536
    s_lshl_b32 s70, s34, 12
    s_add_u32 m0, s70, 96256
    s_nop 0
    buffer_load_dwordx4 v102, s[48:51], s69 offen  lds
    s_add_u32 s69, s71, 98304
    s_lshl_b32 s70, s34, 12
    s_add_u32 m0, s70, 97280
    s_nop 0
    buffer_load_dwordx4 v103, s[48:51], s69 offen  lds
    s_add_u32 s71, s83, 1048576
    s_lshl_b32 s70, s34, 12
    s_add_u32 m0, s70, 110592
    s_nop 0
    buffer_load_dwordx4 v100, s[52:55], s71 offen  lds
    s_add_u32 s69, s71, 32768
    s_lshl_b32 s70, s34, 12
    s_add_u32 m0, s70, 111616
    s_nop 0
    buffer_load_dwordx4 v101, s[52:55], s69 offen  lds
    s_add_u32 s69, s71, 65536
    s_lshl_b32 s70, s34, 12
    s_add_u32 m0, s70, 112640
    s_nop 0
    buffer_load_dwordx4 v102, s[52:55], s69 offen  lds
    s_add_u32 s69, s71, 98304
    s_lshl_b32 s70, s34, 12
    s_add_u32 m0, s70, 113664
    s_nop 0
    buffer_load_dwordx4 v103, s[52:55], s69 offen  lds
    s_mov_b32 s56, s12
    s_mov_b32 s57, s13
    s_mov_b32 s58, 0x500000
    s_mov_b32 s59, 0x20000
    s_mov_b32 s60, s14
    s_mov_b32 s61, s15
    s_mov_b32 s62, 0x500000
    s_mov_b32 s63, 0x20000
    s_mov_b32 s64, s6
    s_mov_b32 s65, s7
    s_mov_b32 s66, 0x2800
    s_mov_b32 s67, 0x20000
    s_lshl_b32 s69, s80, 8
    s_lshl_b32 s70, s34, 18
    s_add_u32 s84, s69, s70
    s_lshl_b32 s70, s81, 7
    s_add_u32 s84, s84, s70
    s_lshl_b32 s69, s80, 1
    s_add_u32 s69, s69, s81
    s_lshl_b32 s69, s69, 2
    s_add_u32 s69, s69, s34
    s_mul_i32 s85, s69, 20480
    v_bfe_u32 v28, v0, 0, 3
    v_lshlrev_b32 v104, 4, v28
    v_bfe_u32 v28, v0, 5, 1
    v_lshlrev_b32 v28, 5, v28
    v_xor_b32 v104, v28, v104
    v_bfe_u32 v28, v0, 3, 3
    v_lshl_add_u32 v104, v28, 13, v104
    v_bfe_u32 v28, v0, 0, 3
    v_lshlrev_b32 v105, 4, v28
    v_bfe_u32 v28, v0, 5, 1
    v_lshlrev_b32 v28, 5, v28
    v_xor_b32 v105, v28, v105
    v_xor_b32 v105, 64, v105
    v_bfe_u32 v28, v0, 3, 3
    v_lshl_add_u32 v105, v28, 13, v105
    v_bfe_u32 v28, v0, 6, 2
    v_lshlrev_b32 v106, 6, v28
    v_bfe_u32 v28, v0, 2, 1
    v_lshlrev_b32 v28, 5, v28
    v_xor_b32 v106, v28, v106
    v_bfe_u32 v28, v0, 4, 1
    v_lshlrev_b32 v28, 6, v28
    v_xor_b32 v106, v28, v106
    v_bfe_u32 v28, v0, 3, 1
    v_lshlrev_b32 v28, 7, v28
    v_xor_b32 v106, v28, v106
    v_bfe_u32 v28, v0, 0, 2
    v_lshl_add_u32 v106, v28, 3, v106
    v_bfe_u32 v28, v0, 5, 1
    v_lshl_add_u32 v106, v28, 12, v106
    v_bfe_u32 v28, v0, 4, 1
    v_lshl_add_u32 v106, v28, 10, v106
    v_bfe_u32 v28, v0, 2, 1
    v_lshl_add_u32 v106, v28, 8, v106
    v_bfe_u32 v28, v0, 3, 1
    v_lshl_add_u32 v106, v28, 11, v106
    v_xor_b32 v107, 32, v106
    v_add_u32 v106, 45056, v106
    v_add_u32 v107, 45056, v107
    v_add_u32 v108, 0x10000, v106
    v_add_u32 v109, 0x10000, v107
    v_bfe_u32 v28, v0, 6, 2
    v_lshlrev_b32 v110, 5, v28
    v_bfe_u32 v28, v0, 4, 1
    v_lshlrev_b32 v28, 5, v28
    v_xor_b32 v110, v28, v110
    v_bfe_u32 v28, v0, 3, 1
    v_lshlrev_b32 v28, 6, v28
    v_xor_b32 v110, v28, v110
    v_bfe_u32 v28, v0, 0, 2
    v_lshl_add_u32 v110, v28, 3, v110
    v_bfe_u32 v28, v0, 5, 1
    v_lshl_add_u32 v110, v28, 11, v110
    v_bfe_u32 v28, v0, 4, 1
    v_lshl_add_u32 v110, v28, 9, v110
    v_bfe_u32 v28, v0, 2, 1
    v_lshl_add_u32 v110, v28, 7, v110
    v_bfe_u32 v28, v0, 3, 1
    v_lshl_add_u32 v110, v28, 10, v110
    v_add_u32 v110, 45056, v110
    v_add_u32 v111, 0x10000, v110
    v_bfe_u32 v17, v0, 0, 6
    v_lshlrev_b32 v2, 4, v17
    v_add_u32 v3, 16384, v2
    v_mov_b32 v17, 0x4444
    v_mov_b32 v18, 0xeeee
    v_and_b32 v19, 2, v0
    v_cmp_ne_u32 vcc, 0, v19
    s_nop 1
    v_cndmask_b32 v1, v17, v18, vcc
    v_mov_b32 v4, 0x2800
    v_bfe_u32 v17, v0, 6, 2
    s_mov_b32 s75, 1280
    v_mad_u32_u24 v4, v17, s75, v4
    v_bfe_u32 v17, v0, 0, 2
    s_mov_b32 s75, 40
    v_mad_u32_u24 v4, v17, s75, v4
    v_bfe_u32 v17, v0, 2, 1
    s_mov_b32 s75, 320
    v_mad_u32_u24 v4, v17, s75, v4
    v_bfe_u32 v17, v0, 3, 1
    s_mov_b32 s75, 160
    v_mad_u32_u24 v4, v17, s75, v4
    v_bfe_u32 v17, v0, 4, 2
    v_lshl_add_u32 v4, v17, 3, v4
    v_mov_b32 v5, 0x2800
    v_bfe_u32 v17, v0, 5, 1
    s_mov_b32 s75, 640
    v_mad_u32_u24 v5, v17, s75, v5
    v_bfe_u32 v17, v0, 4, 1
    s_mov_b32 s75, 160
    v_mad_u32_u24 v5, v17, s75, v5
    v_bfe_u32 v17, v0, 2, 2
    s_mov_b32 s75, 40
    v_mad_u32_u24 v5, v17, s75, v5
    v_bfe_u32 v17, v0, 0, 2
    v_lshl_add_u32 v5, v17, 3, v5
    v_bfe_u32 v17, v0, 6, 2
    v_lshlrev_b32 v6, 8, v17
    v_bfe_u32 v17, v0, 2, 2
    v_lshl_add_u32 v6, v17, 6, v6
    v_bfe_u32 v17, v0, 5, 1
    v_lshl_add_u32 v6, v17, 5, v6
    v_bfe_u32 v17, v0, 0, 1
    v_lshl_add_u32 v6, v17, 4, v6
    v_bfe_u32 v17, v0, 4, 1
    v_lshl_add_u32 v6, v17, 3, v6
    v_bfe_u32 v17, v0, 3, 1
    v_lshlrev_b32 v17, 5, v17
    v_xor_b32 v6, v17, v6
    v_add_u32 v6, 15360, v6
    v_mov_b32 v18, 0x30000
    v_cndmask_b32 v6, v18, v6, vcc
    v_bfe_u32 v17, v0, 4, 2
    v_lshlrev_b32 v7, 12, v17
    v_bfe_u32 v17, v0, 0, 4
    v_lshl_add_u32 v7, v17, 3, v7
    v_bfe_u32 v17, v0, 1, 1
    v_lshlrev_b32 v8, 8, v17
    v_bfe_u32 v17, v0, 2, 1
    v_lshl_add_u32 v8, v17, 5, v8
    v_bfe_u32 v17, v0, 0, 1
    v_lshl_add_u32 v8, v17, 4, v8
    v_bfe_u32 v17, v0, 4, 1
    v_lshl_add_u32 v8, v17, 3, v8
    v_bfe_u32 v17, v0, 5, 1
    v_lshl_add_u32 v8, v17, 2, v8
    v_and_b32 v17, 8, v0
    v_cmp_ne_u32 vcc, 0, v17
    v_mov_b32 v18, 0x40000000
    s_nop 0
    v_cndmask_b32 v8, v8, v18, vcc
    v_and_b32 v17, 7, v0
    v_mov_b32 v18, 0x3f80
    v_mov_b32 v19, 0x3f800000
    v_mov_b32 v10, 0
    v_cmp_eq_u32 vcc, 0, v17
    s_nop 1
    v_cndmask_b32 v10, v10, v18, vcc
    v_cmp_eq_u32 vcc, 1, v17
    s_nop 1
    v_cndmask_b32 v10, v10, v19, vcc
    v_mov_b32 v11, 0
    v_cmp_eq_u32 vcc, 2, v17
    s_nop 1
    v_cndmask_b32 v11, v11, v18, vcc
    v_cmp_eq_u32 vcc, 3, v17
    s_nop 1
    v_cndmask_b32 v11, v11, v19, vcc
    v_mov_b32 v12, 0
    v_cmp_eq_u32 vcc, 4, v17
    s_nop 1
    v_cndmask_b32 v12, v12, v18, vcc
    v_cmp_eq_u32 vcc, 5, v17
    s_nop 1
    v_cndmask_b32 v12, v12, v19, vcc
    v_mov_b32 v13, 0
    v_cmp_eq_u32 vcc, 6, v17
    s_nop 1
    v_cndmask_b32 v13, v13, v18, vcc
    v_cmp_eq_u32 vcc, 7, v17
    s_nop 1
    v_cndmask_b32 v13, v13, v19, vcc
    v_and_b32 v17, 15, v0
    v_bfe_u32 v28, v0, 4, 2
    v_lshlrev_b32 v28, 2, v28
    v_sub_u32 v17, v17, v28
    v_mov_b32 v14, 0
    v_cmp_eq_u32 vcc, 0, v17
    s_nop 1
    v_cndmask_b32 v14, v14, v18, vcc
    v_cmp_eq_u32 vcc, 1, v17
    s_nop 1
    v_cndmask_b32 v14, v14, v19, vcc
    v_mov_b32 v15, 0
    v_cmp_eq_u32 vcc, 2, v17
    s_nop 1
    v_cndmask_b32 v15, v15, v18, vcc
    v_cmp_eq_u32 vcc, 3, v17
    s_nop 1
    v_cndmask_b32 v15, v15, v19, vcc
    v_mov_b32 v16, 0x3f803f80
    v_mov_b32 v17, 0x3f803f80
    v_mov_b32 v18, 0x3f803f80
    v_mov_b32 v19, 0x3f803f80
    s_mul_i32 s69, s34, 1280
    v_add_u32 v9, s69, v5
    s_mov_b32 s5, s80
    s_mov_b32 s6, s81
    s_mov_b32 s4, 0
    s_mov_b32 s8, 0x3e0293ee
    s_mov_b32 s9, 0x3e0293ee
    s_mov_b32 s10, 0xbe0293ee
    s_mul_i32 s69, s36, 655360
    s_add_u32 s69, s69, 0x500000
    s_lshl_b32 s70, s35, 7
    s_add_u32 s70, s70, s69
    s_lshl_b32 s71, s34, 14
    s_add_u32 s11, s70, s71
    s_lshr_b32 s71, s34, 1
    s_lshl_b32 s71, s71, 5
    s_add_u32 s71, s71, s35
    s_lshl_b32 s71, s71, 12
    s_and_b32 s72, s34, 1
    s_lshl_b32 s72, s72, 11
    s_add_u32 s71, s71, s72
    s_add_u32 s7, s71, s69
    s_add_u32 s71, s35, 64
    s_lshl_b32 s71, s71, 12
    s_lshl_b32 s72, s34, 10
    s_add_u32 s71, s71, s72
    s_add_u32 s71, s71, s69
    s_cmp_lt_u32 s35, 16
    s_cselect_b32 s31, s71, 0x40000000
    s_lshl_b32 s71, s34, 5
    s_add_u32 s71, s71, s35
    s_cmp_lt_u32 s71, 80
    s_cselect_b32 s16, 1, 0
    s_cselect_b32 s71, s71, 0
    s_lshl_b32 s72, s71, 12
    s_add_u32 s13, s69, s72
    s_mov_b32 s14, 0
    s_mov_b32 s15, 0
    s_lshr_b32 s73, s71, 2
    s_lshl_b32 s73, s73, 9
    s_and_b32 s72, s71, 3
    s_lshl_b32 s72, s72, 6
    s_add_u32 s73, s73, s72
    s_lshl_b32 s69, s36, 14
    s_add_u32 s69, s69, 0x444000
    s_add_u32 s18, s73, s69
    s_cmp_ge_u32 s71, 32
    s_cselect_b32 s71, 12288, 0
    s_add_u32 s73, s73, s71
    s_lshl_b32 s70, s36, 15
    s_add_u32 s70, s70, 0x400000
    s_add_u32 s17, s73, s70
    s_lshl_b32 s32, s34, 11
    s_lshl_b32 s39, s34, 9
    s_add_u32 s39, s39, 8192
    s_add_u32 s20, s32, s69
    s_add_u32 s12, s39, s69
    s_xor_b32 s70, s70, 0x8000
    s_cmp_ge_u32 s34, 2
    s_cselect_b32 s71, 12288, 0
    s_add_u32 s71, s71, s32
    s_add_u32 s19, s70, s71
    s_add_u32 s71, s39, 12288
    s_add_u32 s29, s70, s71
    s_lshl_b32 s69, s5, 13
    s_lshl_b32 s70, s34, 11
    s_add_u32 s21, s69, s70
    s_add_u32 s21, s21, 0x2000000
    s_lshl_b32 s70, s6, 12
    s_add_u32 s69, s69, s70
    s_lshl_b32 s70, s34, 10
    s_add_u32 s69, s69, s70
    s_add_u32 s22, s69, 0x3000000
    s_lshl_b32 s69, s5, 12
    s_lshl_b32 s70, s34, 10
    s_add_u32 s69, s69, s70
    s_add_u32 s23, s69, 0x700000
    s_lshr_b32 s71, s34, 1
    s_cmp_eq_u32 s71, s6
    s_cselect_b32 s23, s23, 0x40000000
    s_add_u32 s30, s70, 8192
    s_lshl_b32 s69, s5, 11
    s_lshl_b32 s70, s6, 10
    s_add_u32 s69, s69, s70
    s_lshl_b32 s70, s34, 8
    s_add_u32 s69, s69, s70
    s_add_u32 s24, s69, 0xf00000
    s_lshl_b32 s69, s5, 7
    s_add_u32 s26, s69, 0x1000
    s_lshl_b32 s70, s6, 2
    s_add_u32 s69, s69, s70
    s_add_u32 s25, s69, 0x2000
    s_cmp_eq_u32 s34, 2
    s_cselect_b32 s25, s25, 0x40000000
    s_mov_b32 s27, 0
    s_mov_b32 s28, 16384
    s_waitcnt vmcnt(16) lgkmcnt(8)
    s_barrier
    s_add_u32 s71, s83, 1048576
    s_lshl_b32 s70, s34, 12
    s_add_u32 m0, s70, 126976
    s_nop 0
    buffer_load_dwordx4 v100, s[48:51], s71 offen  lds
    s_add_u32 s69, s71, 32768
    s_lshl_b32 s70, s34, 12
    s_add_u32 m0, s70, 128000
    s_nop 0
    buffer_load_dwordx4 v101, s[48:51], s69 offen  lds
    s_add_u32 s69, s71, 65536
    s_lshl_b32 s70, s34, 12
    s_add_u32 m0, s70, 129024
    s_nop 0
    buffer_load_dwordx4 v102, s[48:51], s69 offen  lds
    s_add_u32 s69, s71, 98304
    s_lshl_b32 s70, s34, 12
    s_add_u32 m0, s70, 130048
    s_nop 0
    buffer_load_dwordx4 v103, s[48:51], s69 offen  lds
    ds_read_b64_tr_b16 a[160:161], v106 offset:0
    ds_read_b64_tr_b16 a[162:163], v106 offset:512
    ds_read_b64_tr_b16 a[164:165], v106 offset:8192
    ds_read_b64_tr_b16 a[166:167], v106 offset:8704
    ds_read_b64_tr_b16 a[240:241], v107 offset:0
    ds_read_b64_tr_b16 a[242:243], v107 offset:512
    ds_read_b64_tr_b16 a[244:245], v107 offset:8192
    ds_read_b64_tr_b16 a[246:247], v107 offset:8704
    s_waitcnt vmcnt(16) lgkmcnt(8)
    s_barrier
    s_add_u32 s71, s83, 1572864
    s_lshl_b32 s70, s34, 12
    s_add_u32 m0, s70, 143360
    s_nop 0
    buffer_load_dwordx4 v100, s[52:55], s71 offen  lds
    s_add_u32 s69, s71, 32768
    s_lshl_b32 s70, s34, 12
    s_add_u32 m0, s70, 144384
    s_nop 0
    buffer_load_dwordx4 v101, s[52:55], s69 offen  lds
    s_add_u32 s69, s71, 65536
    s_lshl_b32 s70, s34, 12
    s_add_u32 m0, s70, 145408
    s_nop 0
    buffer_load_dwordx4 v102, s[52:55], s69 offen  lds
    s_add_u32 s69, s71, 98304
    s_lshl_b32 s70, s34, 12
    s_add_u32 m0, s70, 146432
    s_nop 0
    buffer_load_dwordx4 v103, s[52:55], s69 offen  lds
    ds_read_b64_tr_b16 a[0:1], v106 offset:16384
    ds_read_b64_tr_b16 a[2:3], v106 offset:16896
    ds_read_b64_tr_b16 a[4:5], v106 offset:24576
    ds_read_b64_tr_b16 a[6:7], v106 offset:25088
    ds_read_b64_tr_b16 a[80:81], v107 offset:16384
    ds_read_b64_tr_b16 a[82:83], v107 offset:16896
    ds_read_b64_tr_b16 a[84:85], v107 offset:24576
    ds_read_b64_tr_b16 a[86:87], v107 offset:25088
    s_waitcnt vmcnt(16) lgkmcnt(8)
    s_barrier
    s_add_u32 s71, s83, 1572864
    s_lshl_b32 s70, s34, 12
    s_add_u32 m0, s70, 45056
    s_nop 0
    buffer_load_dwordx4 v100, s[48:51], s71 offen  lds
    s_add_u32 s69, s71, 32768
    s_lshl_b32 s70, s34, 12
    s_add_u32 m0, s70, 46080
    s_nop 0
    buffer_load_dwordx4 v101, s[48:51], s69 offen  lds
    s_add_u32 s69, s71, 65536
    s_lshl_b32 s70, s34, 12
    s_add_u32 m0, s70, 47104
    s_nop 0
    buffer_load_dwordx4 v102, s[48:51], s69 offen  lds
    s_add_u32 s69, s71, 98304
    s_lshl_b32 s70, s34, 12
    s_add_u32 m0, s70, 48128
    s_nop 0
    buffer_load_dwordx4 v103, s[48:51], s69 offen  lds
    ds_read_b64_tr_b16 a[168:169], v106 offset:32768
    ds_read_b64_tr_b16 a[170:171], v106 offset:33280
    ds_read_b64_tr_b16 a[172:173], v106 offset:40960
    ds_read_b64_tr_b16 a[174:175], v106 offset:41472
    ds_read_b64_tr_b16 a[248:249], v107 offset:32768
    ds_read_b64_tr_b16 a[250:251], v107 offset:33280
    ds_read_b64_tr_b16 a[252:253], v107 offset:40960
    ds_read_b64_tr_b16 a[254:255], v107 offset:41472
    s_waitcnt vmcnt(16) lgkmcnt(8)
    s_barrier
    s_add_u32 s71, s83, 2097152
    s_lshl_b32 s70, s34, 12
    s_add_u32 m0, s70, 61440
    s_nop 0
    buffer_load_dwordx4 v100, s[52:55], s71 offen  lds
    s_add_u32 s69, s71, 32768
    s_lshl_b32 s70, s34, 12
    s_add_u32 m0, s70, 62464
    s_nop 0
    buffer_load_dwordx4 v101, s[52:55], s69 offen  lds
    s_add_u32 s69, s71, 65536
    s_lshl_b32 s70, s34, 12
    s_add_u32 m0, s70, 63488
    s_nop 0
    buffer_load_dwordx4 v102, s[52:55], s69 offen  lds
    s_add_u32 s69, s71, 98304
    s_lshl_b32 s70, s34, 12
    s_add_u32 m0, s70, 64512
    s_nop 0
    buffer_load_dwordx4 v103, s[52:55], s69 offen  lds
    ds_read_b64_tr_b16 a[8:9], v106 offset:49152
    ds_read_b64_tr_b16 a[10:11], v106 offset:49664
    ds_read_b64_tr_b16 a[12:13], v106 offset:57344
    ds_read_b64_tr_b16 a[14:15], v106 offset:57856
    ds_read_b64_tr_b16 a[88:89], v107 offset:49152
    ds_read_b64_tr_b16 a[90:91], v107 offset:49664
    ds_read_b64_tr_b16 a[92:93], v107 offset:57344
    ds_read_b64_tr_b16 a[94:95], v107 offset:57856
    s_waitcnt vmcnt(16) lgkmcnt(8)
    s_barrier
    s_add_u32 s71, s83, 2097152
    s_lshl_b32 s70, s34, 12
    s_add_u32 m0, s70, 77824
    s_nop 0
    buffer_load_dwordx4 v100, s[48:51], s71 offen  lds
    s_add_u32 s69, s71, 32768
    s_lshl_b32 s70, s34, 12
    s_add_u32 m0, s70, 78848
    s_nop 0
    buffer_load_dwordx4 v101, s[48:51], s69 offen  lds
    s_add_u32 s69, s71, 65536
    s_lshl_b32 s70, s34, 12
    s_add_u32 m0, s70, 79872
    s_nop 0
    buffer_load_dwordx4 v102, s[48:51], s69 offen  lds
    s_add_u32 s69, s71, 98304
    s_lshl_b32 s70, s34, 12
    s_add_u32 m0, s70, 80896
    s_nop 0
    buffer_load_dwordx4 v103, s[48:51], s69 offen  lds
    ds_read_b64_tr_b16 a[176:177], v108 offset:0
    ds_read_b64_tr_b16 a[178:179], v108 offset:512
    ds_read_b64_tr_b16 a[180:181], v108 offset:8192
    ds_read_b64_tr_b16 a[182:183], v108 offset:8704
    ds_read_b64_tr_b16 v[112:113], v109 offset:0
    ds_read_b64_tr_b16 v[114:115], v109 offset:512
    ds_read_b64_tr_b16 v[116:117], v109 offset:8192
    ds_read_b64_tr_b16 v[118:119], v109 offset:8704
    s_waitcnt vmcnt(16) lgkmcnt(8)
    s_barrier
    s_add_u32 s71, s83, 2621440
    s_lshl_b32 s70, s34, 12
    s_add_u32 m0, s70, 94208
    s_nop 0
    buffer_load_dwordx4 v100, s[52:55], s71 offen  lds
    s_add_u32 s69, s71, 32768
    s_lshl_b32 s70, s34, 12
    s_add_u32 m0, s70, 95232
    s_nop 0
    buffer_load_dwordx4 v101, s[52:55], s69 offen  lds
    s_add_u32 s69, s71, 65536
    s_lshl_b32 s70, s34, 12
    s_add_u32 m0, s70, 96256
    s_nop 0
    buffer_load_dwordx4 v102, s[52:55], s69 offen  lds
    s_add_u32 s69, s71, 98304
    s_lshl_b32 s70, s34, 12
    s_add_u32 m0, s70, 97280
    s_nop 0
    buffer_load_dwordx4 v103, s[52:55], s69 offen  lds
    ds_read_b64_tr_b16 a[16:17], v108 offset:16384
    ds_read_b64_tr_b16 a[18:19], v108 offset:16896
    ds_read_b64_tr_b16 a[20:21], v108 offset:24576
    ds_read_b64_tr_b16 a[22:23], v108 offset:25088
    ds_read_b64_tr_b16 a[96:97], v109 offset:16384
    ds_read_b64_tr_b16 a[98:99], v109 offset:16896
    ds_read_b64_tr_b16 a[100:101], v109 offset:24576
    ds_read_b64_tr_b16 a[102:103], v109 offset:25088
    s_waitcnt vmcnt(16) lgkmcnt(8)
    s_barrier
    s_add_u32 s71, s83, 2621440
    s_lshl_b32 s70, s34, 12
    s_add_u32 m0, s70, 110592
    s_nop 0
    buffer_load_dwordx4 v100, s[48:51], s71 offen  lds
    s_add_u32 s69, s71, 32768
    s_lshl_b32 s70, s34, 12
    s_add_u32 m0, s70, 111616
    s_nop 0
    buffer_load_dwordx4 v101, s[48:51], s69 offen  lds
    s_add_u32 s69, s71, 65536
    s_lshl_b32 s70, s34, 12
    s_add_u32 m0, s70, 112640
    s_nop 0
    buffer_load_dwordx4 v102, s[48:51], s69 offen  lds
    s_add_u32 s69, s71, 98304
    s_lshl_b32 s70, s34, 12
    s_add_u32 m0, s70, 113664
    s_nop 0
    buffer_load_dwordx4 v103, s[48:51], s69 offen  lds
    ds_read_b64_tr_b16 a[184:185], v108 offset:32768
    ds_read_b64_tr_b16 a[186:187], v108 offset:33280
    ds_read_b64_tr_b16 a[188:189], v108 offset:40960
    ds_read_b64_tr_b16 a[190:191], v108 offset:41472
    ds_read_b64_tr_b16 v[120:121], v109 offset:32768
    ds_read_b64_tr_b16 v[122:123], v109 offset:33280
    ds_read_b64_tr_b16 v[124:125], v109 offset:40960
    ds_read_b64_tr_b16 v[126:127], v109 offset:41472
    s_waitcnt vmcnt(16) lgkmcnt(8)
    s_barrier
    s_add_u32 s71, s83, 3145728
    s_lshl_b32 s70, s34, 12
    s_add_u32 m0, s70, 126976
    s_nop 0
    buffer_load_dwordx4 v100, s[52:55], s71 offen  lds
    s_add_u32 s69, s71, 32768
    s_lshl_b32 s70, s34, 12
    s_add_u32 m0, s70, 128000
    s_nop 0
    buffer_load_dwordx4 v101, s[52:55], s69 offen  lds
    s_add_u32 s69, s71, 65536
    s_lshl_b32 s70, s34, 12
    s_add_u32 m0, s70, 129024
    s_nop 0
    buffer_load_dwordx4 v102, s[52:55], s69 offen  lds
    s_add_u32 s69, s71, 98304
    s_lshl_b32 s70, s34, 12
    s_add_u32 m0, s70, 130048
    s_nop 0
    buffer_load_dwordx4 v103, s[52:55], s69 offen  lds
    ds_read_b64_tr_b16 a[24:25], v106 offset:0
    ds_read_b64_tr_b16 a[26:27], v106 offset:512
    ds_read_b64_tr_b16 a[28:29], v106 offset:8192
    ds_read_b64_tr_b16 a[30:31], v106 offset:8704
    ds_read_b64_tr_b16 a[104:105], v107 offset:0
    ds_read_b64_tr_b16 a[106:107], v107 offset:512
    ds_read_b64_tr_b16 a[108:109], v107 offset:8192
    ds_read_b64_tr_b16 a[110:111], v107 offset:8704
    s_waitcnt vmcnt(16) lgkmcnt(8)
    s_barrier
    s_add_u32 s71, s83, 3145728
    s_lshl_b32 s70, s34, 12
    s_add_u32 m0, s70, 143360
    s_nop 0
    buffer_load_dwordx4 v100, s[48:51], s71 offen  lds
    s_add_u32 s69, s71, 32768
    s_lshl_b32 s70, s34, 12
    s_add_u32 m0, s70, 144384
    s_nop 0
    buffer_load_dwordx4 v101, s[48:51], s69 offen  lds
    s_add_u32 s69, s71, 65536
    s_lshl_b32 s70, s34, 12
    s_add_u32 m0, s70, 145408
    s_nop 0
    buffer_load_dwordx4 v102, s[48:51], s69 offen  lds
    s_add_u32 s69, s71, 98304
    s_lshl_b32 s70, s34, 12
    s_add_u32 m0, s70, 146432
    s_nop 0
    buffer_load_dwordx4 v103, s[48:51], s69 offen  lds
    ds_read_b64_tr_b16 a[192:193], v106 offset:16384
    ds_read_b64_tr_b16 a[194:195], v106 offset:16896
    ds_read_b64_tr_b16 a[196:197], v106 offset:24576
    ds_read_b64_tr_b16 a[198:199], v106 offset:25088
    ds_read_b64_tr_b16 v[128:129], v107 offset:16384
    ds_read_b64_tr_b16 v[130:131], v107 offset:16896
    ds_read_b64_tr_b16 v[132:133], v107 offset:24576
    ds_read_b64_tr_b16 v[134:135], v107 offset:25088
    s_waitcnt vmcnt(16) lgkmcnt(8)
    s_barrier
    s_add_u32 s71, s83, 3670016
    s_lshl_b32 s70, s34, 12
    s_add_u32 m0, s70, 45056
    s_nop 0
    buffer_load_dwordx4 v100, s[52:55], s71 offen  lds
    s_add_u32 s69, s71, 32768
    s_lshl_b32 s70, s34, 12
    s_add_u32 m0, s70, 46080
    s_nop 0
    buffer_load_dwordx4 v101, s[52:55], s69 offen  lds
    s_add_u32 s69, s71, 65536
    s_lshl_b32 s70, s34, 12
    s_add_u32 m0, s70, 47104
    s_nop 0
    buffer_load_dwordx4 v102, s[52:55], s69 offen  lds
    s_add_u32 s69, s71, 98304
    s_lshl_b32 s70, s34, 12
    s_add_u32 m0, s70, 48128
    s_nop 0
    buffer_load_dwordx4 v103, s[52:55], s69 offen  lds
    ds_read_b64_tr_b16 a[32:33], v106 offset:32768
    ds_read_b64_tr_b16 a[34:35], v106 offset:33280
    ds_read_b64_tr_b16 a[36:37], v106 offset:40960
    ds_read_b64_tr_b16 a[38:39], v106 offset:41472
    ds_read_b64_tr_b16 a[112:113], v107 offset:32768
    ds_read_b64_tr_b16 a[114:115], v107 offset:33280
    ds_read_b64_tr_b16 a[116:117], v107 offset:40960
    ds_read_b64_tr_b16 a[118:119], v107 offset:41472
    s_waitcnt vmcnt(16) lgkmcnt(8)
    s_barrier
    s_add_u32 s71, s83, 3670016
    s_lshl_b32 s70, s34, 12
    s_add_u32 m0, s70, 61440
    s_nop 0
    buffer_load_dwordx4 v100, s[48:51], s71 offen  lds
    s_add_u32 s69, s71, 32768
    s_lshl_b32 s70, s34, 12
    s_add_u32 m0, s70, 62464
    s_nop 0
    buffer_load_dwordx4 v101, s[48:51], s69 offen  lds
    s_add_u32 s69, s71, 65536
    s_lshl_b32 s70, s34, 12
    s_add_u32 m0, s70, 63488
    s_nop 0
    buffer_load_dwordx4 v102, s[48:51], s69 offen  lds
    s_add_u32 s69, s71, 98304
    s_lshl_b32 s70, s34, 12
    s_add_u32 m0, s70, 64512
    s_nop 0
    buffer_load_dwordx4 v103, s[48:51], s69 offen  lds
    ds_read_b64_tr_b16 a[200:201], v106 offset:49152
    ds_read_b64_tr_b16 a[202:203], v106 offset:49664
    ds_read_b64_tr_b16 a[204:205], v106 offset:57344
    ds_read_b64_tr_b16 a[206:207], v106 offset:57856
    ds_read_b64_tr_b16 v[136:137], v107 offset:49152
    ds_read_b64_tr_b16 v[138:139], v107 offset:49664
    ds_read_b64_tr_b16 v[140:141], v107 offset:57344
    ds_read_b64_tr_b16 v[142:143], v107 offset:57856
    s_waitcnt vmcnt(16) lgkmcnt(8)
    s_barrier
    s_add_u32 s71, s83, 4194304
    s_lshl_b32 s70, s34, 12
    s_add_u32 m0, s70, 77824
    s_nop 0
    buffer_load_dwordx4 v100, s[52:55], s71 offen  lds
    s_add_u32 s69, s71, 32768
    s_lshl_b32 s70, s34, 12
    s_add_u32 m0, s70, 78848
    s_nop 0
    buffer_load_dwordx4 v101, s[52:55], s69 offen  lds
    s_add_u32 s69, s71, 65536
    s_lshl_b32 s70, s34, 12
    s_add_u32 m0, s70, 79872
    s_nop 0
    buffer_load_dwordx4 v102, s[52:55], s69 offen  lds
    s_add_u32 s69, s71, 98304
    s_lshl_b32 s70, s34, 12
    s_add_u32 m0, s70, 80896
    s_nop 0
    buffer_load_dwordx4 v103, s[52:55], s69 offen  lds
    ds_read_b64_tr_b16 a[40:41], v108 offset:0
    ds_read_b64_tr_b16 a[42:43], v108 offset:512
    ds_read_b64_tr_b16 a[44:45], v108 offset:8192
    ds_read_b64_tr_b16 a[46:47], v108 offset:8704
    ds_read_b64_tr_b16 a[120:121], v109 offset:0
    ds_read_b64_tr_b16 a[122:123], v109 offset:512
    ds_read_b64_tr_b16 a[124:125], v109 offset:8192
    ds_read_b64_tr_b16 a[126:127], v109 offset:8704
    s_waitcnt vmcnt(16) lgkmcnt(8)
    s_barrier
    s_add_u32 s71, s83, 4194304
    s_lshl_b32 s70, s34, 12
    s_add_u32 m0, s70, 94208
    s_nop 0
    buffer_load_dwordx4 v100, s[48:51], s71 offen  lds
    s_add_u32 s69, s71, 32768
    s_lshl_b32 s70, s34, 12
    s_add_u32 m0, s70, 95232
    s_nop 0
    buffer_load_dwordx4 v101, s[48:51], s69 offen  lds
    s_add_u32 s69, s71, 65536
    s_lshl_b32 s70, s34, 12
    s_add_u32 m0, s70, 96256
    s_nop 0
    buffer_load_dwordx4 v102, s[48:51], s69 offen  lds
    s_add_u32 s69, s71, 98304
    s_lshl_b32 s70, s34, 12
    s_add_u32 m0, s70, 97280
    s_nop 0
    buffer_load_dwordx4 v103, s[48:51], s69 offen  lds
    ds_read_b64_tr_b16 a[208:209], v108 offset:16384
    ds_read_b64_tr_b16 a[210:211], v108 offset:16896
    ds_read_b64_tr_b16 a[212:213], v108 offset:24576
    ds_read_b64_tr_b16 a[214:215], v108 offset:25088
    ds_read_b64_tr_b16 v[144:145], v109 offset:16384
    ds_read_b64_tr_b16 v[146:147], v109 offset:16896
    ds_read_b64_tr_b16 v[148:149], v109 offset:24576
    ds_read_b64_tr_b16 v[150:151], v109 offset:25088
    s_waitcnt vmcnt(16) lgkmcnt(8)
    s_barrier
    s_add_u32 s71, s83, 4718592
    s_lshl_b32 s70, s34, 12
    s_add_u32 m0, s70, 110592
    s_nop 0
    buffer_load_dwordx4 v100, s[52:55], s71 offen  lds
    s_add_u32 s69, s71, 32768
    s_lshl_b32 s70, s34, 12
    s_add_u32 m0, s70, 111616
    s_nop 0
    buffer_load_dwordx4 v101, s[52:55], s69 offen  lds
    s_add_u32 s69, s71, 65536
    s_lshl_b32 s70, s34, 12
    s_add_u32 m0, s70, 112640
    s_nop 0
    buffer_load_dwordx4 v102, s[52:55], s69 offen  lds
    s_add_u32 s69, s71, 98304
    s_lshl_b32 s70, s34, 12
    s_add_u32 m0, s70, 113664
    s_nop 0
    buffer_load_dwordx4 v103, s[52:55], s69 offen  lds
    ds_read_b64_tr_b16 a[48:49], v108 offset:32768
    ds_read_b64_tr_b16 a[50:51], v108 offset:33280
    ds_read_b64_tr_b16 a[52:53], v108 offset:40960
    ds_read_b64_tr_b16 a[54:55], v108 offset:41472
    ds_read_b64_tr_b16 a[128:129], v109 offset:32768
    ds_read_b64_tr_b16 a[130:131], v109 offset:33280
    ds_read_b64_tr_b16 a[132:133], v109 offset:40960
    ds_read_b64_tr_b16 a[134:135], v109 offset:41472
    s_waitcnt vmcnt(16) lgkmcnt(8)
    s_barrier
    s_add_u32 s71, s83, 4718592
    s_lshl_b32 s70, s34, 12
    s_add_u32 m0, s70, 126976
    s_nop 0
    buffer_load_dwordx4 v100, s[48:51], s71 offen  lds
    s_add_u32 s69, s71, 32768
    s_lshl_b32 s70, s34, 12
    s_add_u32 m0, s70, 128000
    s_nop 0
    buffer_load_dwordx4 v101, s[48:51], s69 offen  lds
    s_add_u32 s69, s71, 65536
    s_lshl_b32 s70, s34, 12
    s_add_u32 m0, s70, 129024
    s_nop 0
    buffer_load_dwordx4 v102, s[48:51], s69 offen  lds
    s_add_u32 s69, s71, 98304
    s_lshl_b32 s70, s34, 12
    s_add_u32 m0, s70, 130048
    s_nop 0
    buffer_load_dwordx4 v103, s[48:51], s69 offen  lds
    ds_read_b64_tr_b16 a[216:217], v106 offset:0
    ds_read_b64_tr_b16 a[218:219], v106 offset:512
    ds_read_b64_tr_b16 a[220:221], v106 offset:8192
    ds_read_b64_tr_b16 a[222:223], v106 offset:8704
    ds_read_b64_tr_b16 v[152:153], v107 offset:0
    ds_read_b64_tr_b16 v[154:155], v107 offset:512
    ds_read_b64_tr_b16 v[156:157], v107 offset:8192
    ds_read_b64_tr_b16 v[158:159], v107 offset:8704
    v_mov_b32 v20, 0x4
    v_bfe_u32 v21, v0, 0, 3
    v_lshl_add_u32 v20, v21, 5, v20
    v_bfe_u32 v21, v0, 3, 1
    s_mov_b32 s75, 12
    v_mad_u32_u24 v20, v21, s75, v20
    buffer_load_dword v22, v20, s[44:47], 0 offen sc1
    s_waitcnt vmcnt(16) lgkmcnt(8)
    s_barrier
    s_add_u32 s71, s84, 0
    s_lshl_b32 s70, s34, 12
    s_add_u32 m0, s70, 143360
    s_nop 0
    buffer_load_dwordx4 v104, s[56:59], s71 offen  lds
    s_add_u32 s71, s84, 65536
    s_lshl_b32 s70, s34, 12
    s_add_u32 m0, s70, 144384
    s_nop 0
    buffer_load_dwordx4 v105, s[56:59], s71 offen  lds
    s_add_u32 s71, s84, 131072
    s_lshl_b32 s70, s34, 12
    s_add_u32 m0, s70, 145408
    s_nop 0
    buffer_load_dwordx4 v104, s[56:59], s71 offen  lds
    s_add_u32 s71, s84, 196608
    s_lshl_b32 s70, s34, 12
    s_add_u32 m0, s70, 146432
    s_nop 0
    buffer_load_dwordx4 v105, s[56:59], s71 offen  lds
    ds_read_b64_tr_b16 a[56:57], v106 offset:16384
    ds_read_b64_tr_b16 a[58:59], v106 offset:16896
    ds_read_b64_tr_b16 a[60:61], v106 offset:24576
    ds_read_b64_tr_b16 a[62:63], v106 offset:25088
    ds_read_b64_tr_b16 a[136:137], v107 offset:16384
    ds_read_b64_tr_b16 a[138:139], v107 offset:16896
    ds_read_b64_tr_b16 a[140:141], v107 offset:24576
    ds_read_b64_tr_b16 a[142:143], v107 offset:25088
    s_waitcnt vmcnt(16) lgkmcnt(8)
    s_barrier
    s_add_u32 s71, s84, 1048576
    s_lshl_b32 s70, s34, 12
    s_add_u32 m0, s70, 45056
    s_nop 0
    buffer_load_dwordx4 v104, s[56:59], s71 offen  lds
    s_add_u32 s71, s84, 1114112
    s_lshl_b32 s70, s34, 12
    s_add_u32 m0, s70, 46080
    s_nop 0
    buffer_load_dwordx4 v105, s[56:59], s71 offen  lds
    s_add_u32 s71, s84, 1179648
    s_lshl_b32 s70, s34, 12
    s_add_u32 m0, s70, 47104
    s_nop 0
    buffer_load_dwordx4 v104, s[56:59], s71 offen  lds
    s_add_u32 s71, s84, 1245184
    s_lshl_b32 s70, s34, 12
    s_add_u32 m0, s70, 48128
    s_nop 0
    buffer_load_dwordx4 v105, s[56:59], s71 offen  lds
    ds_read_b64_tr_b16 a[224:225], v106 offset:32768
    ds_read_b64_tr_b16 a[226:227], v106 offset:33280
    ds_read_b64_tr_b16 a[228:229], v106 offset:40960
    ds_read_b64_tr_b16 a[230:231], v106 offset:41472
    ds_read_b64_tr_b16 v[160:161], v107 offset:32768
    ds_read_b64_tr_b16 v[162:163], v107 offset:33280
    ds_read_b64_tr_b16 v[164:165], v107 offset:40960
    ds_read_b64_tr_b16 v[166:167], v107 offset:41472
    s_waitcnt vmcnt(16) lgkmcnt(8)
    s_barrier
    s_add_u32 s71, s84, 2097152
    s_lshl_b32 s70, s34, 12
    s_add_u32 m0, s70, 61440
    s_nop 0
    buffer_load_dwordx4 v104, s[56:59], s71 offen  lds
    s_add_u32 s71, s84, 2162688
    s_lshl_b32 s70, s34, 12
    s_add_u32 m0, s70, 62464
    s_nop 0
    buffer_load_dwordx4 v105, s[56:59], s71 offen  lds
    s_add_u32 s71, s84, 2228224
    s_lshl_b32 s70, s34, 12
    s_add_u32 m0, s70, 63488
    s_nop 0
    buffer_load_dwordx4 v104, s[56:59], s71 offen  lds
    s_add_u32 s71, s84, 2293760
    s_lshl_b32 s70, s34, 12
    s_add_u32 m0, s70, 64512
    s_nop 0
    buffer_load_dwordx4 v105, s[56:59], s71 offen  lds
    ds_read_b64_tr_b16 a[64:65], v106 offset:49152
    ds_read_b64_tr_b16 a[66:67], v106 offset:49664
    ds_read_b64_tr_b16 a[68:69], v106 offset:57344
    ds_read_b64_tr_b16 a[70:71], v106 offset:57856
    ds_read_b64_tr_b16 a[144:145], v107 offset:49152
    ds_read_b64_tr_b16 a[146:147], v107 offset:49664
    ds_read_b64_tr_b16 a[148:149], v107 offset:57344
    ds_read_b64_tr_b16 a[150:151], v107 offset:57856
    s_waitcnt vmcnt(16) lgkmcnt(8)
    s_barrier
    s_add_u32 s71, s84, 3145728
    s_lshl_b32 s70, s34, 12
    s_add_u32 m0, s70, 77824
    s_nop 0
    buffer_load_dwordx4 v104, s[56:59], s71 offen  lds
    s_add_u32 s71, s84, 3211264
    s_lshl_b32 s70, s34, 12
    s_add_u32 m0, s70, 78848
    s_nop 0
    buffer_load_dwordx4 v105, s[56:59], s71 offen  lds
    s_add_u32 s71, s84, 3276800
    s_lshl_b32 s70, s34, 12
    s_add_u32 m0, s70, 79872
    s_nop 0
    buffer_load_dwordx4 v104, s[56:59], s71 offen  lds
    s_add_u32 s71, s84, 3342336
    s_lshl_b32 s70, s34, 12
    s_add_u32 m0, s70, 80896
    s_nop 0
    buffer_load_dwordx4 v105, s[56:59], s71 offen  lds
    ds_read_b64_tr_b16 a[232:233], v108 offset:0
    ds_read_b64_tr_b16 a[234:235], v108 offset:512
    ds_read_b64_tr_b16 a[236:237], v108 offset:8192
    ds_read_b64_tr_b16 a[238:239], v108 offset:8704
    ds_read_b64_tr_b16 v[168:169], v109 offset:0
    ds_read_b64_tr_b16 v[170:171], v109 offset:512
    ds_read_b64_tr_b16 v[172:173], v109 offset:8192
    ds_read_b64_tr_b16 v[174:175], v109 offset:8704
    s_waitcnt vmcnt(16) lgkmcnt(8)
    s_barrier
    s_add_u32 s71, s84, 4194304
    s_lshl_b32 s70, s34, 12
    s_add_u32 m0, s70, 94208
    s_nop 0
    buffer_load_dwordx4 v104, s[56:59], s71 offen  lds
    s_add_u32 s71, s84, 4259840
    s_lshl_b32 s70, s34, 12
    s_add_u32 m0, s70, 95232
    s_nop 0
    buffer_load_dwordx4 v105, s[56:59], s71 offen  lds
    s_add_u32 s71, s84, 4325376
    s_lshl_b32 s70, s34, 12
    s_add_u32 m0, s70, 96256
    s_nop 0
    buffer_load_dwordx4 v104, s[56:59], s71 offen  lds
    s_add_u32 s71, s84, 4390912
    s_lshl_b32 s70, s34, 12
    s_add_u32 m0, s70, 97280
    s_nop 0
    buffer_load_dwordx4 v105, s[56:59], s71 offen  lds
    ds_read_b64_tr_b16 a[72:73], v108 offset:16384
    ds_read_b64_tr_b16 a[74:75], v108 offset:16896
    ds_read_b64_tr_b16 a[76:77], v108 offset:24576
    ds_read_b64_tr_b16 a[78:79], v108 offset:25088
    ds_read_b64_tr_b16 a[152:153], v109 offset:16384
    ds_read_b64_tr_b16 a[154:155], v109 offset:16896
    ds_read_b64_tr_b16 a[156:157], v109 offset:24576
    ds_read_b64_tr_b16 a[158:159], v109 offset:25088
SJOIN_7:
    s_waitcnt vmcnt(16) lgkmcnt(8)
    s_barrier
    v_bfe_u32 v28, v0, 0, 4
    v_lshlrev_b32 v100, 4, v28
    v_bfe_u32 v28, v0, 4, 1
    v_lshlrev_b32 v28, 5, v28
    v_xor_b32 v100, v28, v100
    v_bfe_u32 v28, v0, 4, 2
    s_mov_b32 s75, 1280
    v_mad_u32_u24 v100, v28, s75, v100
    v_bfe_u32 v28, v0, 0, 4
    v_lshlrev_b32 v101, 4, v28
    v_bfe_u32 v28, v0, 4, 1
    v_lshlrev_b32 v28, 5, v28
    v_xor_b32 v101, v28, v101
    v_xor_b32 v101, 64, v101
    v_bfe_u32 v28, v0, 4, 2
    s_mov_b32 s75, 1280
    v_mad_u32_u24 v101, v28, s75, v101
    v_bfe_u32 v28, v0, 0, 4
    v_lshlrev_b32 v102, 4, v28
    v_bfe_u32 v28, v0, 4, 1
    v_lshlrev_b32 v28, 5, v28
    v_xor_b32 v102, v28, v102
    v_xor_b32 v102, 128, v102
    v_bfe_u32 v28, v0, 4, 2
    s_mov_b32 s75, 1280
    v_mad_u32_u24 v102, v28, s75, v102
    v_bfe_u32 v28, v0, 0, 4
    v_lshlrev_b32 v103, 4, v28
    v_bfe_u32 v28, v0, 4, 1
    v_lshlrev_b32 v28, 5, v28
    v_xor_b32 v103, v28, v103
    v_xor_b32 v103, 192, v103
    v_bfe_u32 v28, v0, 4, 2
    s_mov_b32 s75, 1280
    v_mad_u32_u24 v103, v28, s75, v103
    s_add_u32 s71, s85, 0
    s_lshl_b32 s70, s34, 12
    s_add_u32 m0, s70, 110592
    s_nop 0
    buffer_load_dwordx4 v100, s[60:63], s71 offen  lds
    s_add_u32 s69, s71, 5120
    s_lshl_b32 s70, s34, 12
    s_add_u32 m0, s70, 111616
    s_nop 0
    buffer_load_dwordx4 v101, s[60:63], s69 offen  lds
    s_add_u32 s69, s71, 10240
    s_lshl_b32 s70, s34, 12
    s_add_u32 m0, s70, 112640
    s_nop 0
    buffer_load_dwordx4 v102, s[60:63], s69 offen  lds
    s_add_u32 s69, s71, 15360
    s_lshl_b32 s70, s34, 12
    s_add_u32 m0, s70, 113664
    s_nop 0
    buffer_load_dwordx4 v103, s[60:63], s69 offen  lds
    ds_read_b64_tr_b16 v[176:177], v111 offset:32768
    ds_read_b64_tr_b16 v[178:179], v111 offset:33024
    ds_read_b64_tr_b16 v[180:181], v111 offset:36864
    ds_read_b64_tr_b16 v[182:183], v111 offset:37120
    ds_read_b64_tr_b16 v[184:185], v111 offset:40960
    ds_read_b64_tr_b16 v[186:187], v111 offset:41216
    ds_read_b64_tr_b16 v[188:189], v111 offset:45056
    ds_read_b64_tr_b16 v[190:191], v111 offset:45312
    s_waitcnt vmcnt(16) lgkmcnt(8)
    s_barrier
    s_add_u32 s71, s85, 256
    s_lshl_b32 s70, s34, 12
    s_add_u32 m0, s70, 126976
    s_nop 0
    buffer_load_dwordx4 v100, s[60:63], s71 offen  lds
    s_add_u32 s69, s71, 5120
    s_lshl_b32 s70, s34, 12
    s_add_u32 m0, s70, 128000
    s_nop 0
    buffer_load_dwordx4 v101, s[60:63], s69 offen  lds
    s_add_u32 s69, s71, 10240
    s_lshl_b32 s70, s34, 12
    s_add_u32 m0, s70, 129024
    s_nop 0
    buffer_load_dwordx4 v102, s[60:63], s69 offen  lds
    s_add_u32 s69, s71, 15360
    s_lshl_b32 s70, s34, 12
    s_add_u32 m0, s70, 130048
    s_nop 0
    buffer_load_dwordx4 v103, s[60:63], s69 offen  lds
    ds_read_b64_tr_b16 v[192:193], v110 offset:0
    ds_read_b64_tr_b16 v[194:195], v110 offset:256
    ds_read_b64_tr_b16 v[196:197], v110 offset:4096
    ds_read_b64_tr_b16 v[198:199], v110 offset:4352
    ds_read_b64_tr_b16 v[200:201], v110 offset:8192
    ds_read_b64_tr_b16 v[202:203], v110 offset:8448
    ds_read_b64_tr_b16 v[204:205], v110 offset:12288
    ds_read_b64_tr_b16 v[206:207], v110 offset:12544
    v_mov_b32 v104, v22
    s_waitcnt vmcnt(16) lgkmcnt(8)
    s_barrier
    s_add_u32 s71, s85, 512
    s_lshl_b32 s70, s34, 12
    s_add_u32 m0, s70, 143360
    s_nop 0
    buffer_load_dwordx4 v100, s[60:63], s71 offen  lds
    s_add_u32 s69, s71, 5120
    s_lshl_b32 s70, s34, 12
    s_add_u32 m0, s70, 144384
    s_nop 0
    buffer_load_dwordx4 v101, s[60:63], s69 offen  lds
    s_add_u32 s69, s71, 10240
    s_lshl_b32 s70, s34, 12
    s_add_u32 m0, s70, 145408
    s_nop 0
    buffer_load_dwordx4 v102, s[60:63], s69 offen  lds
    s_add_u32 s69, s71, 15360
    s_lshl_b32 s70, s34, 12
    s_add_u32 m0, s70, 146432
    s_nop 0
    buffer_load_dwordx4 v103, s[60:63], s69 offen  lds
    ds_read_b64_tr_b16 v[208:209], v110 offset:16384
    ds_read_b64_tr_b16 v[210:211], v110 offset:16640
    ds_read_b64_tr_b16 v[212:213], v110 offset:20480
    ds_read_b64_tr_b16 v[214:215], v110 offset:20736
    ds_read_b64_tr_b16 v[216:217], v110 offset:24576
    ds_read_b64_tr_b16 v[218:219], v110 offset:24832
    ds_read_b64_tr_b16 v[220:221], v110 offset:28672
    ds_read_b64_tr_b16 v[222:223], v110 offset:28928
    s_waitcnt vmcnt(16) lgkmcnt(8)
    s_barrier
    s_add_u32 s71, s85, 768
    s_lshl_b32 s70, s34, 12
    s_add_u32 m0, s70, 45056
    s_nop 0
    buffer_load_dwordx4 v100, s[60:63], s71 offen  lds
    s_add_u32 s69, s71, 5120
    s_lshl_b32 s70, s34, 12
    s_add_u32 m0, s70, 46080
    s_nop 0
    buffer_load_dwordx4 v101, s[60:63], s69 offen  lds
    s_add_u32 s69, s71, 10240
    s_lshl_b32 s70, s34, 12
    s_add_u32 m0, s70, 47104
    s_nop 0
    buffer_load_dwordx4 v102, s[60:63], s69 offen  lds
    s_add_u32 s69, s71, 15360
    s_lshl_b32 s70, s34, 12
    s_add_u32 m0, s70, 48128
    s_nop 0
    buffer_load_dwordx4 v103, s[60:63], s69 offen  lds
    ds_read_b64_tr_b16 v[224:225], v110 offset:32768
    ds_read_b64_tr_b16 v[226:227], v110 offset:33024
    ds_read_b64_tr_b16 v[228:229], v110 offset:36864
    ds_read_b64_tr_b16 v[230:231], v110 offset:37120
    ds_read_b64_tr_b16 v[232:233], v110 offset:40960
    ds_read_b64_tr_b16 v[234:235], v110 offset:41216
    ds_read_b64_tr_b16 v[236:237], v110 offset:45056
    ds_read_b64_tr_b16 v[238:239], v110 offset:45312
    s_waitcnt vmcnt(16) lgkmcnt(8)
    s_barrier
    s_add_u32 s71, s85, 1024
    s_lshl_b32 s70, s34, 12
    s_add_u32 m0, s70, 61440
    s_nop 0
    buffer_load_dwordx4 v100, s[60:63], s71 offen  lds
    s_add_u32 s69, s71, 5120
    s_lshl_b32 s70, s34, 12
    s_add_u32 m0, s70, 62464
    s_nop 0
    buffer_load_dwordx4 v101, s[60:63], s69 offen  lds
    s_add_u32 s69, s71, 10240
    s_lshl_b32 s70, s34, 12
    s_add_u32 m0, s70, 63488
    s_nop 0
    buffer_load_dwordx4 v102, s[60:63], s69 offen  lds
    s_add_u32 s69, s71, 15360
    s_lshl_b32 s70, s34, 12
    s_add_u32 m0, s70, 64512
    s_nop 0
    buffer_load_dwordx4 v103, s[60:63], s69 offen  lds
    ds_read_b64_tr_b16 v[240:241], v110 offset:49152
    ds_read_b64_tr_b16 v[242:243], v110 offset:49408
    ds_read_b64_tr_b16 v[244:245], v110 offset:53248
    ds_read_b64_tr_b16 v[246:247], v110 offset:53504
    ds_read_b64_tr_b16 v[248:249], v110 offset:57344
    ds_read_b64_tr_b16 v[250:251], v110 offset:57600
    ds_read_b64_tr_b16 v[252:253], v110 offset:61440
    ds_read_b64_tr_b16 v[254:255], v110 offset:61696
    buffer_load_dwordx2 v[102:103], off, s[40:43], s26 sc1
    buffer_load_dword v101, off, s[44:47], 0 offset:8 sc1
    s_waitcnt vmcnt(16) lgkmcnt(8)
    s_barrier
    ds_read_b64_tr_b16 v[20:21], v108 offset:0
    ds_read_b64_tr_b16 v[22:23], v108 offset:512
    ds_read_b64_tr_b16 v[24:25], v108 offset:8192
    ds_read_b64_tr_b16 v[26:27], v108 offset:8704
    ds_read_b64_tr_b16 v[28:29], v109 offset:0
    ds_read_b64_tr_b16 v[30:31], v109 offset:512
    ds_read_b64_tr_b16 v[32:33], v109 offset:8192
    ds_read_b64_tr_b16 v[34:35], v109 offset:8704
    s_waitcnt vmcnt(12) lgkmcnt(8)
    s_barrier
    ds_read_b64_tr_b16 v[36:37], v108 offset:16384
    ds_read_b64_tr_b16 v[38:39], v108 offset:16896
    ds_read_b64_tr_b16 v[40:41], v108 offset:24576
    ds_read_b64_tr_b16 v[42:43], v108 offset:25088
    ds_read_b64_tr_b16 v[44:45], v109 offset:16384
    ds_read_b64_tr_b16 v[46:47], v109 offset:16896
    ds_read_b64_tr_b16 v[48:49], v109 offset:24576
    ds_read_b64_tr_b16 v[50:51], v109 offset:25088
    s_waitcnt vmcnt(8) lgkmcnt(8)
    s_barrier
    ds_read_b64_tr_b16 v[52:53], v108 offset:32768
    ds_read_b64_tr_b16 v[54:55], v108 offset:33280
    ds_read_b64_tr_b16 v[56:57], v108 offset:40960
    ds_read_b64_tr_b16 v[58:59], v108 offset:41472
    ds_read_b64_tr_b16 v[60:61], v109 offset:32768
    ds_read_b64_tr_b16 v[62:63], v109 offset:33280
    ds_read_b64_tr_b16 v[64:65], v109 offset:40960
    ds_read_b64_tr_b16 v[66:67], v109 offset:41472
    s_waitcnt vmcnt(0)
    v_readfirstlane_b32 s54, v101
    v_and_b32 v105, 8, v0
    v_cmp_ne_u32 vcc, 0, v105
    v_mov_b32 v105, -1
    s_nop 0
    v_cndmask_b32 v105, v105, 32, vcc
    v_cmp_ne_u32 vcc, v105, v104
    v_min_u32 v102, v102, v103
    s_cbranch_vccnz VS_10
    v_readfirstlane_b32 s27, v102
    s_branch VF_11
VS_10:
    v_mov_b32 v100, 0x4
    v_bfe_u32 v101, v0, 0, 3
    v_lshl_add_u32 v100, v101, 5, v100
    v_bfe_u32 v101, v0, 3, 1
    s_mov_b32 s75, 12
    v_mad_u32_u24 v100, v101, s75, v100
    s_mov_b32 s38, 262144
PL_12:
    buffer_load_dword v101, v100, s[44:47], 0 offen sc1
    s_waitcnt vmcnt(0)
    v_and_b32 v102, 8, v0
    v_cmp_ne_u32 vcc, 0, v102
    s_nop 1
    v_cndmask_b32 v102, 0, v101, vcc
    s_nop 1
    v_add_u32_dpp v102, v102, v102 row_ror:8 row_mask:0xf bank_mask:0xf
    s_nop 1
    v_add_u32_dpp v102, v102, v102 row_ror:4 row_mask:0xf bank_mask:0xf
    s_nop 1
    v_add_u32_dpp v102, v102, v102 quad_perm:[2,3,0,1] row_mask:0xf bank_mask:0xf
    s_nop 1
    v_add_u32_dpp v102, v102, v102 quad_perm:[1,0,3,2] row_mask:0xf bank_mask:0xf
    v_cmp_gt_u32 vcc, 0x100, v102
    s_cbranch_vccnz PN_13
    s_branch PO_14
PN_13:
    s_sleep 1
    s_sub_u32 s38, s38, 1
    s_cbranch_scc0 PL_12
    s_mov_b32 s68, 2
    s_branch FAIL
PO_14:
    s_cmp_eq_u32 s101, 0
    s_cbranch_scc1 VOK_15
    v_and_b32 v102, 8, v0
    v_cmp_ne_u32 vcc, 0, v102
    v_mov_b32 v102, -1
    s_nop 0
    v_cndmask_b32 v102, v102, 32, vcc
    v_cmp_ne_u32 vcc, v102, v101
    s_cbranch_vccz VOK_15
    s_branch RESPEC
VOK_15:
    s_mov_b32 s27, 0
VF_11:
    s_add_u32 s69, s4, 1
    s_min_u32 s69, s69, 64
    s_cmp_ge_u32 s27, s69
    s_cbranch_scc1 KVOK_16
    s_mov_b32 s38, 262144
PL_17:
    buffer_load_dwordx2 v[100:101], off, s[40:43], s26 sc1
    s_waitcnt vmcnt(0)
    v_min_u32 v100, v100, v101
    s_nop 0
    v_readfirstlane_b32 s27, v100
    s_cmp_lt_u32 s27, s69
    s_cbranch_scc1 PN_18
    s_branch PO_19
PN_18:
    s_sub_u32 s38, s38, 1
    s_cbranch_scc0 PL_17
    s_mov_b32 s68, 11
    s_branch FAIL
PO_19:
KVOK_16:
    s_lshl_b32 s70, s34, 11
    s_add_u32 m0, s70, s28
    s_nop 0
    buffer_load_dwordx4 v2, s[40:43], s21 offen sc1 lds
    buffer_load_dwordx4 v2, s[40:43], s21 offen offset:1024 sc1 lds
    s_add_u32 m0, s30, s28
    s_nop 0
    buffer_load_dwordx4 v2, s[40:43], s22 offen sc1 lds
    s_waitcnt vmcnt(4) lgkmcnt(8)
    s_barrier
    ds_read_b64_tr_b16 v[68:69], v106 offset:0
    ds_read_b64_tr_b16 v[70:71], v106 offset:512
    ds_read_b64_tr_b16 v[72:73], v106 offset:8192
    ds_read_b64_tr_b16 v[74:75], v106 offset:8704
    ds_read_b64_tr_b16 v[76:77], v107 offset:0
    ds_read_b64_tr_b16 v[78:79], v107 offset:512
    ds_read_b64_tr_b16 v[80:81], v107 offset:8192
    ds_read_b64_tr_b16 v[82:83], v107 offset:8704
    s_waitcnt vmcnt(0) lgkmcnt(8)
    s_barrier
    ds_read_b64_tr_b16 v[84:85], v106 offset:16384
    ds_read_b64_tr_b16 v[86:87], v106 offset:16896
    ds_read_b64_tr_b16 v[88:89], v106 offset:24576
    ds_read_b64_tr_b16 v[90:91], v106 offset:25088
    ds_read_b64_tr_b16 v[92:93], v107 offset:16384
    ds_read_b64_tr_b16 v[94:95], v107 offset:16896
    ds_read_b64_tr_b16 v[96:97], v107 offset:24576
    ds_read_b64_tr_b16 v[98:99], v107 offset:25088
    s_waitcnt lgkmcnt(0)
    s_barrier
    v_mov_b32 v100, 0xb000
    v_bfe_u32 v101, v0, 0, 3
    v_lshl_add_u32 v100, v101, 5, v100
    v_bfe_u32 v101, v0, 3, 1
    v_lshl_add_u32 v100, v101, 4, v100
    v_bfe_u32 v101, v0, 4, 2
    v_lshl_add_u32 v100, v101, 8, v100
    v_bfe_u32 v101, v0, 6, 2
    s_mov_b32 s75, 20480
    v_mad_u32_u24 v100, v101, s75, v100
    ds_write_b128 v100, v[20:23] offset:0
    ds_write_b128 v100, v[24:27] offset:1024
    ds_write_b128 v100, v[28:31] offset:2048
    ds_write_b128 v100, v[32:35] offset:3072
    ds_write_b128 v100, v[36:39] offset:4096
    ds_write_b128 v100, v[40:43] offset:5120
    ds_write_b128 v100, v[44:47] offset:6144
    ds_write_b128 v100, v[48:51] offset:7168
    ds_write_b128 v100, v[52:55] offset:8192
    ds_write_b128 v100, v[56:59] offset:9216
    ds_write_b128 v100, v[60:63] offset:10240
    ds_write_b128 v100, v[64:67] offset:11264
    ds_write_b128 v100, v[68:71] offset:12288
    ds_write_b128 v100, v[72:75] offset:13312
    ds_write_b128 v100, v[76:79] offset:14336
    ds_write_b128 v100, v[80:83] offset:15360
    ds_write_b128 v100, v[84:87] offset:16384
    ds_write_b128 v100, v[88:91] offset:17408
    ds_write_b128 v100, v[92:95] offset:18432
    ds_write_b128 v100, v[96:99] offset:19456
    v_bfe_u32 v103, v0, 2, 2
    s_mov_b32 s75, 2560
    v_mul_u32_u24 v102, s75, v103
    v_bfe_u32 v103, v0, 0, 1
    s_mov_b32 s75, 1280
    v_mad_u32_u24 v102, v103, s75, v102
    v_bfe_u32 v103, v0, 4, 2
    v_lshl_add_u32 v102, v103, 5, v102
    v_bfe_u32 v103, v0, 1, 1
    v_lshl_add_u32 v102, v103, 4, v102
    v_bfe_u32 v103, v0, 6, 2
    v_lshl_add_u32 v102, v103, 8, v102
    buffer_load_dwordx4 v[48:51], v102, s[64:67], 0 offen
    buffer_load_dwordx4 v[52:55], v102, s[64:67], 0 offen offset:128
    v_mov_b32 v102, 0x400
    v_bfe_u32 v103, v0, 3, 2
    s_mov_b32 s75, 2560
    v_mad_u32_u24 v102, v103, s75, v102
    v_bfe_u32 v103, v0, 1, 1
    s_mov_b32 s75, 1280
    v_mad_u32_u24 v102, v103, s75, v102
    v_bfe_u32 v103, v0, 7, 1
    v_lshl_add_u32 v102, v103, 7, v102
    v_bfe_u32 v103, v0, 5, 2
    v_lshl_add_u32 v102, v103, 5, v102
    v_bfe_u32 v103, v0, 2, 1
    v_lshl_add_u32 v102, v103, 4, v102
    v_bfe_u32 v103, v0, 0, 1
    v_lshl_add_u32 v102, v103, 3, v102
    buffer_load_dwordx2 v[56:57], v102, s[64:67], 0 offen
    v_mov_b32 v101, 0xb000
    v_bfe_u32 v102, v0, 0, 6
    v_lshl_add_u32 v101, v102, 4, v101
    v_bfe_u32 v102, v0, 6, 2
    s_mov_b32 s75, 20480
    v_mad_u32_u24 v101, v102, s75, v101
    v_mov_b32 v0, v101
    v_mov_b64 v[20:21], 0
    v_mov_b64 v[22:23], 0
    v_mov_b64 v[24:25], 0
    v_mov_b64 v[26:27], 0
    v_mov_b64 v[28:29], 0
    v_mov_b64 v[30:31], 0
    v_mov_b64 v[32:33], 0
    v_mov_b64 v[34:35], 0
    v_mov_b64 v[36:37], 0
    v_mov_b64 v[38:39], 0
    v_mov_b64 v[40:41], 0
    v_mov_b64 v[42:43], 0
    v_mov_b64 v[44:45], 0
    v_mov_b64 v[46:47], 0
    s_add_u32 s21, s21, 0x40000
    s_add_u32 s22, s22, 0x40000
    s_xor_b32 s28, s28, 0xc000
    s_lshl_b32 s69, s34, 11
    s_add_u32 s52, s69, s28
    s_add_u32 s53, s30, s28
    s_mov_b32 s48, 0x40000000
    s_mov_b32 s49, 0x40000000
    s_mov_b32 s50, 0x40000000
    s_mov_b32 s51, 0x40000000
    s_add_u32 s69, s4, 2
    s_min_u32 s69, s69, 64
    s_cmp_ge_u32 s27, s69
    s_cbranch_scc1 KVOK_20
    s_mov_b32 s38, 262144
PL_21:
    buffer_load_dwordx2 v[108:109], off, s[40:43], s26 sc1
    s_waitcnt vmcnt(0)
    v_min_u32 v108, v108, v109
    s_nop 0
    v_readfirstlane_b32 s27, v108
    s_cmp_lt_u32 s27, s69
    s_cbranch_scc1 PN_22
    s_branch PO_23
PN_22:
    s_sub_u32 s38, s38, 1
    s_cbranch_scc0 PL_21
    s_mov_b32 s68, 11
    s_branch FAIL
PO_23:
KVOK_20:
    s_cmp_eq_u32 s54, 2
    s_cselect_b32 s69, 0x2000, 0
    s_add_u32 s17, s17, s69
    s_add_u32 s19, s19, s69
    s_add_u32 s29, s29, s69
    v_lshrrev_b32 v109, 1, v2
    v_add_u32 v110, s32, v2
    v_add_u32 v111, s39, v109
    s_waitcnt vmcnt(0) lgkmcnt(0)
    v_mfma_f32_16x16x16_bf16 v[88:91], v[14:15], v[48:49], 0
    v_mfma_f32_16x16x16_bf16 v[92:95], v[14:15], v[50:51], 0
    v_mfma_f32_16x16x16_bf16 v[96:99], v[14:15], v[52:53], 0
    v_mfma_f32_16x16x16_bf16 v[100:103], v[14:15], v[54:55], 0
    v_mfma_f32_16x16x16_bf16 v[104:107], v[14:15], v[56:57], 0
    s_cmp_lg_u32 s37, 0
    s_cbranch_scc1 CH_LOOP_safe
.p2align 6
    s_nop 0
    s_nop 0
CH_LOOP_fast:
    s_cmp_ge_u32 s34, 2
    s_cbranch_scc1 PfastW2_26
    s_cmp_eq_u32 s34, 1
    s_cbranch_scc1 PfastW1_25
PfastW0_24:
    v_cvt_pk_bf16_f32 v48, v88, v89
    v_cvt_pk_bf16_f32 v49, v90, v91
    v_cvt_pk_bf16_f32 v50, v92, v93
    v_cvt_pk_bf16_f32 v51, v94, v95
    ds_write_b128 v110, v[48:51] offset:0
    v_cvt_pk_bf16_f32 v52, v96, v97
    v_cvt_pk_bf16_f32 v53, v98, v99
    v_cvt_pk_bf16_f32 v54, v100, v101
    v_cvt_pk_bf16_f32 v55, v102, v103
    v_smfmac_f32_16x16x64_bf16 v[28:31], v[48:51], a[0:7], v1
    ds_write_b128 v110, v[52:55] offset:1024
    v_cvt_pk_bf16_f32 v56, v104, v105
    v_cvt_pk_bf16_f32 v57, v106, v107
    v_smfmac_f32_16x16x64_bf16 v[32:35], v[48:51], a[80:87], v1
    ds_write_b64 v111, v[56:57] offset:0
    v_smfmac_f32_16x16x64_bf16 v[28:31], v[52:55], a[8:15], v1
    v_mov_b64 v[100:101], -1
    v_mov_b64 v[102:103], -1
    v_smfmac_f32_16x16x64_bf16 v[32:35], v[52:55], a[88:95], v1
    s_waitcnt lgkmcnt(0)
    s_barrier
    ds_read_b128 v[56:59], v2 offset:2048
    ds_read_b128 v[60:63], v2 offset:3072
    v_smfmac_f32_16x16x64_bf16 v[36:39], v[48:51], a[160:167], v1
    ds_read_b128 v[64:67], v2 offset:4096
    s_mov_b32 m0, s52
    v_smfmac_f32_16x16x64_bf16 v[40:43], v[48:51], a[240:247], v1
    ds_read_b128 v[68:71], v2 offset:5120
    buffer_load_dwordx4 v2, s[40:43], s21 offen sc1 lds
    v_smfmac_f32_16x16x64_bf16 v[36:39], v[52:55], a[168:175], v1
    ds_read_b128 v[72:75], v2 offset:6144
    v_smfmac_f32_16x16x64_bf16 v[40:43], v[52:55], a[248:255], v1
    ds_read_b128 v[76:79], v2 offset:7168
    s_waitcnt lgkmcnt(5)
    v_smfmac_f32_16x16x64_bf16 v[28:31], v[56:59], a[16:23], v1
    ds_read_b128 v[80:83], v2 offset:8192
    buffer_load_dwordx4 v2, s[40:43], s21 offen offset:1024 sc1 lds
    v_smfmac_f32_16x16x64_bf16 v[32:35], v[56:59], a[96:103], v1
    ds_read_b128 v[84:87], v2 offset:9216
    s_waitcnt lgkmcnt(6)
    v_smfmac_f32_16x16x64_bf16 v[28:31], v[60:63], a[24:31], v1
    s_mov_b32 m0, s53
    v_smfmac_f32_16x16x64_bf16 v[32:35], v[60:63], a[104:111], v1
    s_waitcnt lgkmcnt(5)
    buffer_load_dwordx4 v2, s[40:43], s22 offen sc1 lds
    v_smfmac_f32_16x16x64_bf16 v[28:31], v[64:67], a[32:39], v1
    v_smfmac_f32_16x16x64_bf16 v[32:35], v[64:67], a[112:119], v1
    s_waitcnt lgkmcnt(4)
    buffer_store_dwordx4 v[100:103], v2, s[40:43], s50 offen
    v_smfmac_f32_16x16x64_bf16 v[28:31], v[68:71], a[40:47], v1
    v_smfmac_f32_16x16x64_bf16 v[32:35], v[68:71], a[120:127], v1
    s_waitcnt lgkmcnt(3)
    v_smfmac_f32_16x16x64_bf16 v[28:31], v[72:75], a[48:55], v1
    buffer_store_dwordx4 v[100:103], v2, s[40:43], s50 offen offset:1024
    v_smfmac_f32_16x16x64_bf16 v[32:35], v[72:75], a[128:135], v1
    s_waitcnt lgkmcnt(2)
    v_smfmac_f32_16x16x64_bf16 v[28:31], v[76:79], a[56:63], v1
    v_smfmac_f32_16x16x64_bf16 v[32:35], v[76:79], a[136:143], v1
    s_waitcnt lgkmcnt(0)
    buffer_store_dwordx4 v[100:103], v2, s[40:43], s51 offen
    v_smfmac_f32_16x16x64_bf16 v[28:31], v[80:83], a[64:71], v1
    v_smfmac_f32_16x16x64_bf16 v[32:35], v[80:83], a[144:151], v1
    v_smfmac_f32_16x16x64_bf16 v[28:31], v[84:87], a[72:79], v1
    buffer_store_dword v100, v8, s[40:43], s49 offen
    v_smfmac_f32_16x16x64_bf16 v[32:35], v[84:87], a[152:159], v1
    v_smfmac_f32_16x16x64_bf16 v[36:39], v[56:59], a[176:183], v1
    buffer_store_dword v100, v8, s[40:43], s48 offen sc1
    v_smfmac_f32_16x16x64_bf16 v[40:43], v[56:59], v[112:119], v1
    v_smfmac_f32_16x16x64_bf16 v[36:39], v[60:63], a[184:191], v1
    v_add_f32 v28, v28, v30
    v_add_f32 v29, v29, v31
    v_smfmac_f32_16x16x64_bf16 v[40:43], v[60:63], v[120:127], v1
    v_add_f32 v32, v32, v34
    v_add_f32 v33, v33, v35
    v_smfmac_f32_16x16x64_bf16 v[36:39], v[64:67], a[192:199], v1
    v_cvt_pk_bf16_f32 v93, v28, v29
    v_smfmac_f32_16x16x64_bf16 v[40:43], v[64:67], v[128:135], v1
    v_cvt_pk_bf16_f32 v95, v32, v33
    v_smfmac_f32_16x16x64_bf16 v[36:39], v[68:71], a[200:207], v1
    v_mov_b32 v92, s4
    v_smfmac_f32_16x16x64_bf16 v[40:43], v[68:71], v[136:143], v1
    buffer_store_dword v92, off, s[40:43], s25 sc1
    v_smfmac_f32_16x16x64_bf16 v[36:39], v[72:75], a[208:215], v1
    ds_read_b128 v[108:111], v3 offset:0
    v_smfmac_f32_16x16x64_bf16 v[40:43], v[72:75], v[144:151], v1
    v_smfmac_f32_16x16x64_bf16 v[36:39], v[76:79], a[216:223], v1
    ds_read_b128 v[104:107], v3 offset:4096
    v_smfmac_f32_16x16x64_bf16 v[40:43], v[76:79], v[152:159], v1
    v_smfmac_f32_16x16x64_bf16 v[36:39], v[80:83], a[224:231], v1
    ds_read_b128 v[96:99], v3 offset:1024
    v_smfmac_f32_16x16x64_bf16 v[40:43], v[80:83], v[160:167], v1
    v_smfmac_f32_16x16x64_bf16 v[36:39], v[84:87], a[232:239], v1
    ds_read_b128 v[100:103], v3 offset:5120
    v_smfmac_f32_16x16x64_bf16 v[40:43], v[84:87], v[168:175], v1
    v_smfmac_f32_16x16x64_bf16 v[44:47], v[48:51], v[176:183], v1
    v_smfmac_f32_16x16x64_bf16 v[44:47], v[52:55], v[184:191], v1
    v_add_f32 v36, v36, v38
    v_add_f32 v37, v37, v39
    v_add_f32 v40, v40, v42
    v_add_f32 v41, v41, v43
    v_cvt_pk_bf16_f32 v92, v36, v37
    v_cvt_pk_bf16_f32 v94, v40, v41
    ds_write_b64 v4, v[92:93]
    ds_write_b64 v4, v[94:95] offset:640
    v_smfmac_f32_16x16x64_bf16 v[44:47], v[56:59], v[192:199], v1
    v_smfmac_f32_16x16x64_bf16 v[44:47], v[60:63], v[200:207], v1
    v_smfmac_f32_16x16x64_bf16 v[44:47], v[64:67], v[208:215], v1
    s_waitcnt lgkmcnt(0)
    s_barrier
    ds_read_b64_tr_b16 v[48:49], v5 offset:0
    ds_read_b64_tr_b16 v[50:51], v5 offset:320
    v_smfmac_f32_16x16x64_bf16 v[44:47], v[68:71], v[216:223], v1
    ds_read_b64_tr_b16 v[52:53], v5 offset:1280
    v_smfmac_f32_16x16x64_bf16 v[44:47], v[72:75], v[224:231], v1
    ds_read_b64_tr_b16 v[54:55], v5 offset:1600
    v_smfmac_f32_16x16x64_bf16 v[44:47], v[76:79], v[232:239], v1
    ds_read_b64_tr_b16 v[56:57], v5 offset:2560
    v_smfmac_f32_16x16x64_bf16 v[44:47], v[80:83], v[240:247], v1
    ds_read_b64_tr_b16 v[58:59], v5 offset:2880
    v_smfmac_f32_16x16x64_bf16 v[44:47], v[84:87], v[248:255], v1
    ds_read_b64_tr_b16 v[60:61], v5 offset:3840
    s_branch PfastE_28
PfastW1_25:
    v_cvt_pk_bf16_f32 v48, v88, v89
    v_cvt_pk_bf16_f32 v49, v90, v91
    v_cvt_pk_bf16_f32 v50, v92, v93
    v_cvt_pk_bf16_f32 v51, v94, v95
    ds_write_b128 v110, v[48:51] offset:0
    v_cvt_pk_bf16_f32 v52, v96, v97
    v_cvt_pk_bf16_f32 v53, v98, v99
    v_cvt_pk_bf16_f32 v54, v100, v101
    v_cvt_pk_bf16_f32 v55, v102, v103
    v_smfmac_f32_16x16x64_bf16 v[28:31], v[48:51], a[16:23], v1
    ds_write_b128 v110, v[52:55] offset:1024
    v_cvt_pk_bf16_f32 v56, v104, v105
    v_cvt_pk_bf16_f32 v57, v106, v107
    v_smfmac_f32_16x16x64_bf16 v[32:35], v[48:51], a[96:103], v1
    ds_write_b64 v111, v[56:57] offset:0
    v_smfmac_f32_16x16x64_bf16 v[28:31], v[52:55], a[24:31], v1
    v_mov_b64 v[100:101], -1
    v_mov_b64 v[102:103], -1
    v_smfmac_f32_16x16x64_bf16 v[32:35], v[52:55], a[104:111], v1
    s_waitcnt lgkmcnt(0)
    s_barrier
    ds_read_b128 v[56:59], v2 offset:4096
    ds_read_b128 v[60:63], v2 offset:5120
    v_smfmac_f32_16x16x64_bf16 v[36:39], v[48:51], a[176:183], v1
    ds_read_b128 v[64:67], v2 offset:6144
    s_mov_b32 m0, s52
    v_smfmac_f32_16x16x64_bf16 v[40:43], v[48:51], v[112:119], v1
    ds_read_b128 v[68:71], v2 offset:7168
    buffer_load_dwordx4 v2, s[40:43], s21 offen sc1 lds
    v_smfmac_f32_16x16x64_bf16 v[36:39], v[52:55], a[184:191], v1
    ds_read_b128 v[72:75], v2 offset:8192
    v_smfmac_f32_16x16x64_bf16 v[40:43], v[52:55], v[120:127], v1
    ds_read_b128 v[76:79], v2 offset:9216
    s_waitcnt lgkmcnt(5)
    v_smfmac_f32_16x16x64_bf16 v[28:31], v[56:59], a[32:39], v1
    ds_read_b128 v[80:83], v2 offset:0
    buffer_load_dwordx4 v2, s[40:43], s21 offen offset:1024 sc1 lds
    v_smfmac_f32_16x16x64_bf16 v[32:35], v[56:59], a[112:119], v1
    ds_read_b128 v[84:87], v2 offset:1024
    s_waitcnt lgkmcnt(6)
    v_smfmac_f32_16x16x64_bf16 v[28:31], v[60:63], a[40:47], v1
    s_mov_b32 m0, s53
    v_smfmac_f32_16x16x64_bf16 v[32:35], v[60:63], a[120:127], v1
    s_waitcnt lgkmcnt(5)
    buffer_load_dwordx4 v2, s[40:43], s22 offen sc1 lds
    v_smfmac_f32_16x16x64_bf16 v[28:31], v[64:67], a[48:55], v1
    v_smfmac_f32_16x16x64_bf16 v[32:35], v[64:67], a[128:135], v1
    s_waitcnt lgkmcnt(4)
    buffer_store_dwordx4 v[100:103], v2, s[40:43], s50 offen
    v_smfmac_f32_16x16x64_bf16 v[28:31], v[68:71], a[56:63], v1
    v_smfmac_f32_16x16x64_bf16 v[32:35], v[68:71], a[136:143], v1
    s_waitcnt lgkmcnt(3)
    v_smfmac_f32_16x16x64_bf16 v[28:31], v[72:75], a[64:71], v1
    buffer_store_dwordx4 v[100:103], v2, s[40:43], s50 offen offset:1024
    v_smfmac_f32_16x16x64_bf16 v[32:35], v[72:75], a[144:151], v1
    s_waitcnt lgkmcnt(2)
    v_smfmac_f32_16x16x64_bf16 v[28:31], v[76:79], a[72:79], v1
    v_smfmac_f32_16x16x64_bf16 v[32:35], v[76:79], a[152:159], v1
    s_waitcnt lgkmcnt(0)
    buffer_store_dwordx4 v[100:103], v2, s[40:43], s51 offen
    v_smfmac_f32_16x16x64_bf16 v[28:31], v[80:83], a[0:7], v1
    v_smfmac_f32_16x16x64_bf16 v[32:35], v[80:83], a[80:87], v1
    v_smfmac_f32_16x16x64_bf16 v[28:31], v[84:87], a[8:15], v1
    buffer_store_dword v100, v8, s[40:43], s49 offen
    v_smfmac_f32_16x16x64_bf16 v[32:35], v[84:87], a[88:95], v1
    v_smfmac_f32_16x16x64_bf16 v[36:39], v[56:59], a[192:199], v1
    buffer_store_dword v100, v8, s[40:43], s48 offen sc1
    v_smfmac_f32_16x16x64_bf16 v[40:43], v[56:59], v[128:135], v1
    v_smfmac_f32_16x16x64_bf16 v[36:39], v[60:63], a[200:207], v1
    v_add_f32 v28, v28, v30
    v_add_f32 v29, v29, v31
    v_smfmac_f32_16x16x64_bf16 v[40:43], v[60:63], v[136:143], v1
    v_add_f32 v32, v32, v34
    v_add_f32 v33, v33, v35
    v_smfmac_f32_16x16x64_bf16 v[36:39], v[64:67], a[208:215], v1
    v_cvt_pk_bf16_f32 v93, v28, v29
    v_smfmac_f32_16x16x64_bf16 v[40:43], v[64:67], v[144:151], v1
    v_cvt_pk_bf16_f32 v95, v32, v33
    v_smfmac_f32_16x16x64_bf16 v[36:39], v[68:71], a[216:223], v1
    v_mov_b32 v92, s4
    v_smfmac_f32_16x16x64_bf16 v[40:43], v[68:71], v[152:159], v1
    buffer_store_dword v92, off, s[40:43], s25 sc1
    v_smfmac_f32_16x16x64_bf16 v[36:39], v[72:75], a[224:231], v1
    ds_read_b128 v[108:111], v3 offset:0
    v_smfmac_f32_16x16x64_bf16 v[40:43], v[72:75], v[160:167], v1
    v_smfmac_f32_16x16x64_bf16 v[36:39], v[76:79], a[232:239], v1
    ds_read_b128 v[104:107], v3 offset:4096
    v_smfmac_f32_16x16x64_bf16 v[40:43], v[76:79], v[168:175], v1
    v_smfmac_f32_16x16x64_bf16 v[36:39], v[80:83], a[160:167], v1
    ds_read_b128 v[96:99], v3 offset:1024
    v_smfmac_f32_16x16x64_bf16 v[40:43], v[80:83], a[240:247], v1
    v_smfmac_f32_16x16x64_bf16 v[36:39], v[84:87], a[168:175], v1
    ds_read_b128 v[100:103], v3 offset:5120
    v_smfmac_f32_16x16x64_bf16 v[40:43], v[84:87], a[248:255], v1
    v_smfmac_f32_16x16x64_bf16 v[44:47], v[48:51], v[192:199], v1
    v_smfmac_f32_16x16x64_bf16 v[44:47], v[52:55], v[200:207], v1
    v_add_f32 v36, v36, v38
    v_add_f32 v37, v37, v39
    v_add_f32 v40, v40, v42
    v_add_f32 v41, v41, v43
    v_cvt_pk_bf16_f32 v92, v36, v37
    v_cvt_pk_bf16_f32 v94, v40, v41
    ds_write_b64 v4, v[92:93]
    ds_write_b64 v4, v[94:95] offset:640
    v_smfmac_f32_16x16x64_bf16 v[44:47], v[56:59], v[208:215], v1
    v_smfmac_f32_16x16x64_bf16 v[44:47], v[60:63], v[216:223], v1
    v_smfmac_f32_16x16x64_bf16 v[44:47], v[64:67], v[224:231], v1
    s_waitcnt lgkmcnt(0)
    s_barrier
    ds_read_b64_tr_b16 v[48:49], v5 offset:0
    ds_read_b64_tr_b16 v[50:51], v5 offset:320
    v_smfmac_f32_16x16x64_bf16 v[44:47], v[68:71], v[232:239], v1
    ds_read_b64_tr_b16 v[52:53], v5 offset:1280
    v_smfmac_f32_16x16x64_bf16 v[44:47], v[72:75], v[240:247], v1
    ds_read_b64_tr_b16 v[54:55], v5 offset:1600
    v_smfmac_f32_16x16x64_bf16 v[44:47], v[76:79], v[248:255], v1
    ds_read_b64_tr_b16 v[56:57], v5 offset:2560
    v_smfmac_f32_16x16x64_bf16 v[44:47], v[80:83], v[176:183], v1
    ds_read_b64_tr_b16 v[58:59], v5 offset:2880
    v_smfmac_f32_16x16x64_bf16 v[44:47], v[84:87], v[184:191], v1
    ds_read_b64_tr_b16 v[60:61], v5 offset:3840
    s_branch PfastE_28
PfastW2_26:
    s_cmp_eq_u32 s34, 3
    s_cbranch_scc1 PfastW3_27
    v_cvt_pk_bf16_f32 v48, v88, v89
    v_cvt_pk_bf16_f32 v49, v90, v91
    v_cvt_pk_bf16_f32 v50, v92, v93
    v_cvt_pk_bf16_f32 v51, v94, v95
    ds_write_b128 v110, v[48:51] offset:0
    v_cvt_pk_bf16_f32 v52, v96, v97
    v_cvt_pk_bf16_f32 v53, v98, v99
    v_cvt_pk_bf16_f32 v54, v100, v101
    v_cvt_pk_bf16_f32 v55, v102, v103
    v_smfmac_f32_16x16x64_bf16 v[28:31], v[48:51], a[32:39], v1
    ds_write_b128 v110, v[52:55] offset:1024
    v_cvt_pk_bf16_f32 v56, v104, v105
    v_cvt_pk_bf16_f32 v57, v106, v107
    v_smfmac_f32_16x16x64_bf16 v[32:35], v[48:51], a[112:119], v1
    ds_write_b64 v111, v[56:57] offset:0
    v_smfmac_f32_16x16x64_bf16 v[28:31], v[52:55], a[40:47], v1
    v_mov_b64 v[100:101], -1
    v_mov_b64 v[102:103], -1
    v_smfmac_f32_16x16x64_bf16 v[32:35], v[52:55], a[120:127], v1
    s_waitcnt lgkmcnt(0)
    s_barrier
    ds_read_b128 v[56:59], v2 offset:6144
    ds_read_b128 v[60:63], v2 offset:7168
    v_smfmac_f32_16x16x64_bf16 v[36:39], v[48:51], a[192:199], v1
    ds_read_b128 v[64:67], v2 offset:8192
    s_mov_b32 m0, s52
    v_smfmac_f32_16x16x64_bf16 v[40:43], v[48:51], v[128:135], v1
    ds_read_b128 v[68:71], v2 offset:9216
    buffer_load_dwordx4 v2, s[40:43], s21 offen sc1 lds
    v_smfmac_f32_16x16x64_bf16 v[36:39], v[52:55], a[200:207], v1
    ds_read_b128 v[72:75], v2 offset:0
    v_smfmac_f32_16x16x64_bf16 v[40:43], v[52:55], v[136:143], v1
    ds_read_b128 v[76:79], v2 offset:1024
    s_waitcnt lgkmcnt(5)
    v_smfmac_f32_16x16x64_bf16 v[28:31], v[56:59], a[48:55], v1
    ds_read_b128 v[80:83], v2 offset:2048
    buffer_load_dwordx4 v2, s[40:43], s21 offen offset:1024 sc1 lds
    v_smfmac_f32_16x16x64_bf16 v[32:35], v[56:59], a[128:135], v1
    ds_read_b128 v[84:87], v2 offset:3072
    s_waitcnt lgkmcnt(6)
    v_smfmac_f32_16x16x64_bf16 v[28:31], v[60:63], a[56:63], v1
    s_mov_b32 m0, s53
    v_smfmac_f32_16x16x64_bf16 v[32:35], v[60:63], a[136:143], v1
    s_waitcnt lgkmcnt(5)
    buffer_load_dwordx4 v2, s[40:43], s22 offen sc1 lds
    v_smfmac_f32_16x16x64_bf16 v[28:31], v[64:67], a[64:71], v1
    v_smfmac_f32_16x16x64_bf16 v[32:35], v[64:67], a[144:151], v1
    s_waitcnt lgkmcnt(4)
    buffer_store_dwordx4 v[100:103], v2, s[40:43], s50 offen
    v_smfmac_f32_16x16x64_bf16 v[28:31], v[68:71], a[72:79], v1
    v_smfmac_f32_16x16x64_bf16 v[32:35], v[68:71], a[152:159], v1
    s_waitcnt lgkmcnt(3)
    v_smfmac_f32_16x16x64_bf16 v[28:31], v[72:75], a[0:7], v1
    buffer_store_dwordx4 v[100:103], v2, s[40:43], s50 offen offset:1024
    v_smfmac_f32_16x16x64_bf16 v[32:35], v[72:75], a[80:87], v1
    s_waitcnt lgkmcnt(2)
    v_smfmac_f32_16x16x64_bf16 v[28:31], v[76:79], a[8:15], v1
    v_smfmac_f32_16x16x64_bf16 v[32:35], v[76:79], a[88:95], v1
    s_waitcnt lgkmcnt(0)
    buffer_store_dwordx4 v[100:103], v2, s[40:43], s51 offen
    v_smfmac_f32_16x16x64_bf16 v[28:31], v[80:83], a[16:23], v1
    v_smfmac_f32_16x16x64_bf16 v[32:35], v[80:83], a[96:103], v1
    v_smfmac_f32_16x16x64_bf16 v[28:31], v[84:87], a[24:31], v1
    buffer_store_dword v100, v8, s[40:43], s49 offen
    v_smfmac_f32_16x16x64_bf16 v[32:35], v[84:87], a[104:111], v1
    v_smfmac_f32_16x16x64_bf16 v[36:39], v[56:59], a[208:215], v1
    buffer_store_dword v100, v8, s[40:43], s48 offen sc1
    v_smfmac_f32_16x16x64_bf16 v[40:43], v[56:59], v[144:151], v1
    v_smfmac_f32_16x16x64_bf16 v[36:39], v[60:63], a[216:223], v1
    v_add_f32 v28, v28, v30
    v_add_f32 v29, v29, v31
    v_smfmac_f32_16x16x64_bf16 v[40:43], v[60:63], v[152:159], v1
    v_add_f32 v32, v32, v34
    v_add_f32 v33, v33, v35
    v_smfmac_f32_16x16x64_bf16 v[36:39], v[64:67], a[224:231], v1
    v_cvt_pk_bf16_f32 v93, v28, v29
    v_smfmac_f32_16x16x64_bf16 v[40:43], v[64:67], v[160:167], v1
    v_cvt_pk_bf16_f32 v95, v32, v33
    v_smfmac_f32_16x16x64_bf16 v[36:39], v[68:71], a[232:239], v1
    v_mov_b32 v92, s4
    v_smfmac_f32_16x16x64_bf16 v[40:43], v[68:71], v[168:175], v1
    buffer_store_dword v92, off, s[40:43], s25 sc1
    v_smfmac_f32_16x16x64_bf16 v[36:39], v[72:75], a[160:167], v1
    ds_read_b128 v[108:111], v3 offset:0
    v_smfmac_f32_16x16x64_bf16 v[40:43], v[72:75], a[240:247], v1
    v_smfmac_f32_16x16x64_bf16 v[36:39], v[76:79], a[168:175], v1
    ds_read_b128 v[104:107], v3 offset:4096
    v_smfmac_f32_16x16x64_bf16 v[40:43], v[76:79], a[248:255], v1
    v_smfmac_f32_16x16x64_bf16 v[36:39], v[80:83], a[176:183], v1
    ds_read_b128 v[96:99], v3 offset:1024
    v_smfmac_f32_16x16x64_bf16 v[40:43], v[80:83], v[112:119], v1
    v_smfmac_f32_16x16x64_bf16 v[36:39], v[84:87], a[184:191], v1
    ds_read_b128 v[100:103], v3 offset:5120
    v_smfmac_f32_16x16x64_bf16 v[40:43], v[84:87], v[120:127], v1
    v_smfmac_f32_16x16x64_bf16 v[44:47], v[48:51], v[208:215], v1
    v_smfmac_f32_16x16x64_bf16 v[44:47], v[52:55], v[216:223], v1
    v_add_f32 v36, v36, v38
    v_add_f32 v37, v37, v39
    v_add_f32 v40, v40, v42
    v_add_f32 v41, v41, v43
    v_cvt_pk_bf16_f32 v92, v36, v37
    v_cvt_pk_bf16_f32 v94, v40, v41
    ds_write_b64 v4, v[92:93]
    ds_write_b64 v4, v[94:95] offset:640
    v_smfmac_f32_16x16x64_bf16 v[44:47], v[56:59], v[224:231], v1
    v_smfmac_f32_16x16x64_bf16 v[44:47], v[60:63], v[232:239], v1
    v_smfmac_f32_16x16x64_bf16 v[44:47], v[64:67], v[240:247], v1
    s_waitcnt lgkmcnt(0)
    s_barrier
    ds_read_b64_tr_b16 v[48:49], v5 offset:0
    ds_read_b64_tr_b16 v[50:51], v5 offset:320
    v_smfmac_f32_16x16x64_bf16 v[44:47], v[68:71], v[248:255], v1
    ds_read_b64_tr_b16 v[52:53], v5 offset:1280
    v_smfmac_f32_16x16x64_bf16 v[44:47], v[72:75], v[176:183], v1
    ds_read_b64_tr_b16 v[54:55], v5 offset:1600
    v_smfmac_f32_16x16x64_bf16 v[44:47], v[76:79], v[184:191], v1
    ds_read_b64_tr_b16 v[56:57], v5 offset:2560
    v_smfmac_f32_16x16x64_bf16 v[44:47], v[80:83], v[192:199], v1
    ds_read_b64_tr_b16 v[58:59], v5 offset:2880
    v_smfmac_f32_16x16x64_bf16 v[44:47], v[84:87], v[200:207], v1
    ds_read_b64_tr_b16 v[60:61], v5 offset:3840
    s_branch PfastE_28
PfastW3_27:
    v_cvt_pk_bf16_f32 v48, v88, v89
    v_cvt_pk_bf16_f32 v49, v90, v91
    v_cvt_pk_bf16_f32 v50, v92, v93
    v_cvt_pk_bf16_f32 v51, v94, v95
    ds_write_b128 v110, v[48:51] offset:0
    v_cvt_pk_bf16_f32 v52, v96, v97
    v_cvt_pk_bf16_f32 v53, v98, v99
    v_cvt_pk_bf16_f32 v54, v100, v101
    v_cvt_pk_bf16_f32 v55, v102, v103
    v_smfmac_f32_16x16x64_bf16 v[28:31], v[48:51], a[48:55], v1
    ds_write_b128 v110, v[52:55] offset:1024
    v_cvt_pk_bf16_f32 v56, v104, v105
    v_cvt_pk_bf16_f32 v57, v106, v107
    v_smfmac_f32_16x16x64_bf16 v[32:35], v[48:51], a[128:135], v1
    ds_write_b64 v111, v[56:57] offset:0
    v_smfmac_f32_16x16x64_bf16 v[28:31], v[52:55], a[56:63], v1
    v_mov_b64 v[100:101], -1
    v_mov_b64 v[102:103], -1
    v_smfmac_f32_16x16x64_bf16 v[32:35], v[52:55], a[136:143], v1
    s_waitcnt lgkmcnt(0)
    s_barrier
    ds_read_b128 v[56:59], v2 offset:8192
    ds_read_b128 v[60:63], v2 offset:9216
    v_smfmac_f32_16x16x64_bf16 v[36:39], v[48:51], a[208:215], v1
    ds_read_b128 v[64:67], v2 offset:0
    s_mov_b32 m0, s52
    v_smfmac_f32_16x16x64_bf16 v[40:43], v[48:51], v[144:151], v1
    ds_read_b128 v[68:71], v2 offset:1024
    buffer_load_dwordx4 v2, s[40:43], s21 offen sc1 lds
    v_smfmac_f32_16x16x64_bf16 v[36:39], v[52:55], a[216:223], v1
    ds_read_b128 v[72:75], v2 offset:2048
    v_smfmac_f32_16x16x64_bf16 v[40:43], v[52:55], v[152:159], v1
    ds_read_b128 v[76:79], v2 offset:3072
    s_waitcnt lgkmcnt(5)
    v_smfmac_f32_16x16x64_bf16 v[28:31], v[56:59], a[64:71], v1
    ds_read_b128 v[80:83], v2 offset:4096
    buffer_load_dwordx4 v2, s[40:43], s21 offen offset:1024 sc1 lds
    v_smfmac_f32_16x16x64_bf16 v[32:35], v[56:59], a[144:151], v1
    ds_read_b128 v[84:87], v2 offset:5120
    s_waitcnt lgkmcnt(6)
    v_smfmac_f32_16x16x64_bf16 v[28:31], v[60:63], a[72:79], v1
    s_mov_b32 m0, s53
    v_smfmac_f32_16x16x64_bf16 v[32:35], v[60:63], a[152:159], v1
    s_waitcnt lgkmcnt(5)
    buffer_load_dwordx4 v2, s[40:43], s22 offen sc1 lds
    v_smfmac_f32_16x16x64_bf16 v[28:31], v[64:67], a[0:7], v1
    v_smfmac_f32_16x16x64_bf16 v[32:35], v[64:67], a[80:87], v1
    s_waitcnt lgkmcnt(4)
    buffer_store_dwordx4 v[100:103], v2, s[40:43], s50 offen
    v_smfmac_f32_16x16x64_bf16 v[28:31], v[68:71], a[8:15], v1
    v_smfmac_f32_16x16x64_bf16 v[32:35], v[68:71], a[88:95], v1
    s_waitcnt lgkmcnt(3)
    v_smfmac_f32_16x16x64_bf16 v[28:31], v[72:75], a[16:23], v1
    buffer_store_dwordx4 v[100:103], v2, s[40:43], s50 offen offset:1024
    v_smfmac_f32_16x16x64_bf16 v[32:35], v[72:75], a[96:103], v1
    s_waitcnt lgkmcnt(2)
    v_smfmac_f32_16x16x64_bf16 v[28:31], v[76:79], a[24:31], v1
    v_smfmac_f32_16x16x64_bf16 v[32:35], v[76:79], a[104:111], v1
    s_waitcnt lgkmcnt(0)
    buffer_store_dwordx4 v[100:103], v2, s[40:43], s51 offen
    v_smfmac_f32_16x16x64_bf16 v[28:31], v[80:83], a[32:39], v1
    v_smfmac_f32_16x16x64_bf16 v[32:35], v[80:83], a[112:119], v1
    v_smfmac_f32_16x16x64_bf16 v[28:31], v[84:87], a[40:47], v1
    buffer_store_dword v100, v8, s[40:43], s49 offen
    v_smfmac_f32_16x16x64_bf16 v[32:35], v[84:87], a[120:127], v1
    v_smfmac_f32_16x16x64_bf16 v[36:39], v[56:59], a[224:231], v1
    buffer_store_dword v100, v8, s[40:43], s48 offen sc1
    v_smfmac_f32_16x16x64_bf16 v[40:43], v[56:59], v[160:167], v1
    v_smfmac_f32_16x16x64_bf16 v[36:39], v[60:63], a[232:239], v1
    v_add_f32 v28, v28, v30
    v_add_f32 v29, v29, v31
    v_smfmac_f32_16x16x64_bf16 v[40:43], v[60:63], v[168:175], v1
    v_add_f32 v32, v32, v34
    v_add_f32 v33, v33, v35
    v_smfmac_f32_16x16x64_bf16 v[36:39], v[64:67], a[160:167], v1
    v_cvt_pk_bf16_f32 v93, v28, v29
    v_smfmac_f32_16x16x64_bf16 v[40:43], v[64:67], a[240:247], v1
    v_cvt_pk_bf16_f32 v95, v32, v33
    v_smfmac_f32_16x16x64_bf16 v[36:39], v[68:71], a[168:175], v1
    v_mov_b32 v92, s4
    v_smfmac_f32_16x16x64_bf16 v[40:43], v[68:71], a[248:255], v1
    buffer_store_dword v92, off, s[40:43], s25 sc1
    v_smfmac_f32_16x16x64_bf16 v[36:39], v[72:75], a[176:183], v1
    ds_read_b128 v[108:111], v3 offset:0
    v_smfmac_f32_16x16x64_bf16 v[40:43], v[72:75], v[112:119], v1
    v_smfmac_f32_16x16x64_bf16 v[36:39], v[76:79], a[184:191], v1
    ds_read_b128 v[104:107], v3 offset:4096
    v_smfmac_f32_16x16x64_bf16 v[40:43], v[76:79], v[120:127], v1
    v_smfmac_f32_16x16x64_bf16 v[36:39], v[80:83], a[192:199], v1
    ds_read_b128 v[96:99], v3 offset:1024
    v_smfmac_f32_16x16x64_bf16 v[40:43], v[80:83], v[128:135], v1
    v_smfmac_f32_16x16x64_bf16 v[36:39], v[84:87], a[200:207], v1
    ds_read_b128 v[100:103], v3 offset:5120
    v_smfmac_f32_16x16x64_bf16 v[40:43], v[84:87], v[136:143], v1
    v_smfmac_f32_16x16x64_bf16 v[44:47], v[48:51], v[224:231], v1
    v_smfmac_f32_16x16x64_bf16 v[44:47], v[52:55], v[232:239], v1
    v_add_f32 v36, v36, v38
    v_add_f32 v37, v37, v39
    v_add_f32 v40, v40, v42
    v_add_f32 v41, v41, v43
    v_cvt_pk_bf16_f32 v92, v36, v37
    v_cvt_pk_bf16_f32 v94, v40, v41
    ds_write_b64 v4, v[92:93]
    ds_write_b64 v4, v[94:95] offset:640
    v_smfmac_f32_16x16x64_bf16 v[44:47], v[56:59], v[240:247], v1
    v_smfmac_f32_16x16x64_bf16 v[44:47], v[60:63], v[248:255], v1
    v_smfmac_f32_16x16x64_bf16 v[44:47], v[64:67], v[176:183], v1
    s_waitcnt lgkmcnt(0)
    s_barrier
    ds_read_b64_tr_b16 v[48:49], v5 offset:0
    ds_read_b64_tr_b16 v[50:51], v5 offset:320
    v_smfmac_f32_16x16x64_bf16 v[44:47], v[68:71], v[184:191], v1
    ds_read_b64_tr_b16 v[52:53], v5 offset:1280
    v_smfmac_f32_16x16x64_bf16 v[44:47], v[72:75], v[192:199], v1
    ds_read_b64_tr_b16 v[54:55], v5 offset:1600
    v_smfmac_f32_16x16x64_bf16 v[44:47], v[76:79], v[200:207], v1
    ds_read_b64_tr_b16 v[56:57], v5 offset:2560
    v_smfmac_f32_16x16x64_bf16 v[44:47], v[80:83], v[208:215], v1
    ds_read_b64_tr_b16 v[58:59], v5 offset:2880
    v_smfmac_f32_16x16x64_bf16 v[44:47], v[84:87], v[216:223], v1
    ds_read_b64_tr_b16 v[60:61], v5 offset:3840
PfastE_28:
    s_waitcnt lgkmcnt(5)
    v_mfma_f32_16x16x32_bf16 v[80:83], v[108:111], v[48:51], 0
    ds_read_b64_tr_b16 v[62:63], v5 offset:4160
    ds_read_b128 v[108:111], v3 offset:2048
    v_mfma_f32_16x16x32_bf16 v[84:87], v[104:107], v[48:51], 0
    ds_read_b128 v[104:107], v3 offset:6144
    v_mfma_f32_16x16x32_bf16 v[88:91], v[48:51], v[48:51], 0
    s_waitcnt lgkmcnt(6)
    v_mfma_f32_16x16x32_bf16 v[80:83], v[96:99], v[52:55], v[80:83]
    ds_read_b128 v[96:99], v3 offset:3072
    v_mfma_f32_16x16x32_bf16 v[84:87], v[100:103], v[52:55], v[84:87]
    ds_read_b128 v[100:103], v3 offset:7168
    v_mfma_f32_16x16x32_bf16 v[88:91], v[52:55], v[52:55], v[88:91]
    v_add_f32 v44, v44, v46
    v_add_f32 v45, v45, v47
    v_cvt_pk_bf16_f32 v20, v44, v45
    s_waitcnt lgkmcnt(6)
    s_waitcnt lgkmcnt(3)
    v_mfma_f32_16x16x32_bf16 v[80:83], v[108:111], v[56:59], v[80:83]
    s_waitcnt lgkmcnt(2)
    v_mfma_f32_16x16x32_bf16 v[84:87], v[104:107], v[56:59], v[84:87]
    v_add_u32 v93, s30, v3
    v_mfma_f32_16x16x32_bf16 v[88:91], v[56:59], v[56:59], v[88:91]
    s_waitcnt lgkmcnt(1)
    v_mfma_f32_16x16x32_bf16 v[80:83], v[96:99], v[60:63], v[80:83]
    ds_read_b128 v[96:99], v93
    s_waitcnt lgkmcnt(1)
    v_mfma_f32_16x16x32_bf16 v[84:87], v[100:103], v[60:63], v[84:87]
    ds_read_b64_tr_b16 v[100:101], v9 offset:0
    v_mfma_f32_16x16x32_bf16 v[88:91], v[60:63], v[60:63], v[88:91]
    ds_read_b64_tr_b16 v[102:103], v9 offset:320
    ds_read_b128 v[48:51], v0 offset:0
    ds_read_b128 v[52:55], v0 offset:1024
    ds_read_b128 v[56:59], v0 offset:2048
    ds_read_b128 v[60:63], v0 offset:3072
    v_max3_f32 v104, v80, v81, v82
    v_max3_f32 v105, v84, v85, v86
    v_max3_f32 v104, v104, v83, v87
    v_max3_f32 v105, v105, v88, v89
    v_max_f32 v104, v104, v105
    v_mov_b32 v105, v104
    ds_read_b128 v[64:67], v0 offset:4096
    ds_read_b128 v[68:71], v0 offset:5120
    v_permlane16_swap_b32 v104, v105
    v_max_f32 v104, v104, v105
    v_mov_b32 v105, v104
    ds_read_b128 v[72:75], v0 offset:6144
    ds_read_b128 v[76:79], v0 offset:7168
    v_permlane32_swap_b32 v104, v105
    v_max_f32 v104, v104, v105
    v_mul_f32 v104, s10, v104
    v_pk_fma_f32 v[80:81], v[80:81], s[8:9], v[104:105] op_sel_hi:[1,1,0]
    v_pk_fma_f32 v[82:83], v[82:83], s[8:9], v[104:105] op_sel_hi:[1,1,0]
    v_pk_fma_f32 v[84:85], v[84:85], s[8:9], v[104:105] op_sel_hi:[1,1,0]
    v_pk_fma_f32 v[86:87], v[86:87], s[8:9], v[104:105] op_sel_hi:[1,1,0]
    v_pk_fma_f32 v[88:89], v[88:89], s[8:9], v[104:105] op_sel_hi:[1,1,0]
    v_exp_f32 v80, v80
    v_exp_f32 v81, v81
    v_exp_f32 v82, v82
    v_exp_f32 v83, v83
    v_exp_f32 v84, v84
    v_exp_f32 v85, v85
    v_exp_f32 v86, v86
    v_exp_f32 v87, v87
    v_cvt_pk_bf16_f32 v28, v80, v81
    v_cvt_pk_bf16_f32 v29, v82, v83
    v_cvt_pk_bf16_f32 v30, v84, v85
    v_exp_f32 v88, v88
    v_cvt_pk_bf16_f32 v31, v86, v87
    v_exp_f32 v89, v89
    s_waitcnt lgkmcnt(10)
    v_mfma_f32_16x16x32_bf16 v[36:39], v[16:19], v[28:31], 0
    v_cvt_pk_bf16_f32 v24, v88, v89
    v_mfma_f32_16x16x32_bf16 v[32:35], v[96:99], v[28:31], 0
    ds_read_b128 v[80:83], v0 offset:8192
    v_mfma_f32_16x16x32_bf16 v[36:39], v[16:19], v[24:27], v[36:39]
    ds_read_b128 v[84:87], v0 offset:9216
    v_mfma_f32_16x16x32_bf16 v[32:35], v[20:23], v[24:27], v[32:35]
    v_mov_b64 v[88:89], 0
    v_mov_b64 v[90:91], 0
    v_mov_b64 v[92:93], 0
    v_rcp_f32 v106, v36
    v_mov_b64 v[94:95], 0
    v_mov_b64 v[96:97], 0
    v_mov_b64 v[98:99], 0
    s_nop 0
    v_pk_mul_f32 v[32:33], v[32:33], v[106:107] op_sel_hi:[1,0]
    v_pk_mul_f32 v[34:35], v[34:35], v[106:107] op_sel_hi:[1,0]
    v_cvt_pk_bf16_f32 v104, v32, v33
    v_cvt_pk_bf16_f32 v105, v34, v35
    ds_write_b64 v6, v[104:105]
    v_bfe_u32 v24, v2, 7, 1
    v_lshlrev_b32 v24, 5, v24
    v_xor_b32 v24, v24, v2
    v_mov_b64 v[28:29], 0
    v_mov_b64 v[30:31], 0
    v_mov_b64 v[32:33], 0
    v_mov_b64 v[34:35], 0
    v_mov_b64 v[36:37], 0
    v_mov_b64 v[38:39], 0
    v_mov_b64 v[40:41], 0
    v_mov_b64 v[42:43], 0
    v_mov_b64 v[44:45], 0
    v_mov_b64 v[46:47], 0
    s_waitcnt lgkmcnt(0)
    s_barrier
    ds_read_b128 v[104:107], v24 offset:15360
    v_lshrrev_b32 v108, 2, v2
    buffer_store_dwordx4 v[100:103], v2, s[40:43], s23 offen sc1
    buffer_store_dword v20, v108, s[40:43], s24 offen sc1
    s_add_u32 s72, s11, s14
    v_mov_b64 v[108:109], 0
    v_mov_b64 v[110:111], 0
    v_mov_b64 v[100:101], 0
    v_mov_b64 v[102:103], 0
    s_waitcnt lgkmcnt(0)
    v_smfmac_f32_16x16x64_bf16 v[28:31], v[104:107], v[48:55], v1
    ds_read_b128 v[48:51], v0 offset:10240
    ds_read_b128 v[52:55], v0 offset:11264
    v_smfmac_f32_16x16x64_bf16 v[32:35], v[104:107], v[56:63], v1
    ds_read_b128 v[56:59], v0 offset:12288
    ds_read_b128 v[60:63], v0 offset:13312
    v_smfmac_f32_16x16x64_bf16 v[36:39], v[104:107], v[64:71], v1
    ds_read_b128 v[64:67], v0 offset:14336
    ds_read_b128 v[68:71], v0 offset:15360
    v_add_f32 v28, v28, v30
    v_add_f32 v29, v29, v31
    v_smfmac_f32_16x16x64_bf16 v[40:43], v[104:107], v[72:79], v1
    ds_read_b128 v[72:75], v0 offset:16384
    ds_read_b128 v[76:79], v0 offset:17408
    v_add_f32 v32, v32, v34
    v_add_f32 v33, v33, v35
    v_cvt_pk_bf16_f32 v28, v28, v29
    v_smfmac_f32_16x16x64_bf16 v[44:47], v[104:107], v[80:87], v1
    ds_read_b128 v[80:83], v0 offset:18432
    ds_read_b128 v[84:87], v0 offset:19456
    v_add_f32 v36, v36, v38
    v_add_f32 v37, v37, v39
    v_cvt_pk_bf16_f32 v29, v32, v33
    buffer_store_dwordx2 v[28:29], v7, s[40:43], s72 offen
    s_add_u32 s72, s72, 0x10000
    s_waitcnt lgkmcnt(8)
    v_smfmac_f32_16x16x64_bf16 v[88:91], v[104:107], v[48:55], v1
    v_add_f32 v40, v40, v42
    v_add_f32 v41, v41, v43
    v_cvt_pk_bf16_f32 v30, v36, v37
    s_waitcnt lgkmcnt(6)
    v_smfmac_f32_16x16x64_bf16 v[92:95], v[104:107], v[56:63], v1
    v_add_f32 v44, v44, v46
    v_add_f32 v45, v45, v47
    v_cvt_pk_bf16_f32 v31, v40, v41
    buffer_store_dwordx2 v[30:31], v7, s[40:43], s72 offen
    s_add_u32 s72, s72, 0x10000
    s_waitcnt lgkmcnt(4)
    v_smfmac_f32_16x16x64_bf16 v[96:99], v[104:107], v[64:71], v1
    v_add_f32 v88, v88, v90
    v_add_f32 v89, v89, v91
    v_cvt_pk_bf16_f32 v32, v44, v45
    s_waitcnt lgkmcnt(2)
    v_smfmac_f32_16x16x64_bf16 v[100:103], v[104:107], v[72:79], v1
    v_add_f32 v92, v92, v94
    v_add_f32 v93, v93, v95
    v_cvt_pk_bf16_f32 v33, v88, v89
    buffer_store_dwordx2 v[32:33], v7, s[40:43], s72 offen
    s_add_u32 s72, s72, 0x10000
    s_waitcnt lgkmcnt(0)
    v_smfmac_f32_16x16x64_bf16 v[108:111], v[104:107], v[80:87], v1
    v_add_f32 v96, v96, v98
    v_add_f32 v97, v97, v99
    v_cvt_pk_bf16_f32 v34, v92, v93
    v_add_f32 v100, v100, v102
    v_add_f32 v101, v101, v103
    v_cvt_pk_bf16_f32 v35, v96, v97
    buffer_store_dwordx2 v[34:35], v7, s[40:43], s72 offen
    s_add_u32 s72, s72, 0x10000
    v_add_f32 v108, v108, v110
    v_add_f32 v109, v109, v111
    v_cvt_pk_bf16_f32 v36, v100, v101
    v_cvt_pk_bf16_f32 v37, v108, v109
    buffer_store_dwordx2 v[36:37], v7, s[40:43], s72 offen
    s_cmp_lg_u32 s54, 0
    s_cbranch_scc1 CLS_30
    s_mov_b32 s38, 262144
PL_31:
    buffer_load_dword v108, off, s[44:47], 0 offset:8 sc1
    s_waitcnt vmcnt(0)
    v_cmp_eq_u32 vcc, 0, v108
    s_cbranch_vccnz PN_32
    s_branch PO_33
PN_32:
    s_sub_u32 s38, s38, 1
    s_cbranch_scc0 PL_31
    s_mov_b32 s68, 10
    s_branch FAIL
PO_33:
    v_readfirstlane_b32 s54, v108
    s_cmp_eq_u32 s54, 2
    s_cselect_b32 s69, 0x2000, 0
    s_add_u32 s17, s17, s69
    s_add_u32 s19, s19, s69
    s_add_u32 s29, s29, s69
CLS_30:
    s_add_u32 s55, s13, s14
    s_add_u32 s64, s17, s15
    s_add_u32 s62, s19, s15
    s_add_u32 s63, s29, s15
    s_lshr_b32 s73, s15, 1
    s_add_u32 s65, s73, s18
    s_add_u32 s60, s73, s20
    s_add_u32 s61, s73, s12
    s_add_u32 s69, s15, 0x20000
    s_and_b32 s69, s69, 0x30000
    s_add_u32 s48, s69, s17
    s_lshr_b32 s69, s69, 1
    s_add_u32 s49, s69, s18
    s_cmp_eq_u32 s16, 0
    s_cselect_b32 s48, 0x40000000, s48
    s_cselect_b32 s49, 0x40000000, s49
    s_add_u32 s50, s14, s7
    s_add_u32 s51, s14, s31
    s_add_u32 s23, s23, 0x20000
    s_add_u32 s24, s24, 0x10000
    s_add_u32 s21, s21, 0x40000
    s_add_u32 s22, s22, 0x40000
    s_xor_b32 s28, s28, 0xc000
    v_xor_b32 v3, 0xc000, v3
    s_xor_b32 s14, s14, 0x50000
    s_add_u32 s15, s15, 0x10000
    s_and_b32 s15, s15, 0x30000
    s_add_u32 s4, s4, 1
    s_lshl_b32 s69, s34, 11
    s_add_u32 s52, s69, s28
    s_add_u32 s53, s30, s28
    s_mov_b32 s38, 262144
    v_lshrrev_b32 v109, 1, v2
    v_add_u32 v110, s32, v2
    v_add_u32 v111, s39, v109
    v_mov_b32 v24, s4
    s_cmp_ge_u32 s4, 60
    s_cselect_b32 s67, s25, 0x40000000
    s_cmp_gt_u32 s4, 62
    s_cselect_b32 s67, 0x40000000, s67
    v_mov_b64 v[28:29], 0
    v_mov_b64 v[30:31], 0
    v_mov_b64 v[32:33], 0
    v_mov_b64 v[34:35], 0
    v_mov_b64 v[36:37], 0
    v_mov_b64 v[38:39], 0
    v_mov_b64 v[40:41], 0
    v_mov_b64 v[42:43], 0
    v_mov_b64 v[44:45], 0
    v_mov_b64 v[46:47], 0
    s_waitcnt vmcnt(1)
    s_cmp_eq_u32 s16, 0
    s_cbranch_scc1 NRED_29
H1RT_35:
    buffer_load_dwordx4 v[48:51], v2, s[40:43], s55 offen offset:0 sc1
    buffer_load_dwordx4 v[52:55], v2, s[40:43], s55 offen offset:1024 sc1
    buffer_load_dwordx4 v[56:59], v2, s[40:43], s55 offen offset:2048 sc1
    buffer_load_dwordx4 v[60:63], v2, s[40:43], s55 offen offset:3072 sc1
    s_waitcnt vmcnt(3)
    v_mfma_f32_16x16x32_bf16 v[64:67], v[48:51], v[10:13], 0
    v_max3_u32 v68, v48, v49, v50
    v_max_u32 v68, v68, v51
    s_waitcnt vmcnt(2)
    v_mfma_f32_16x16x32_bf16 v[64:67], v[52:55], v[10:13], v[64:67]
    v_max3_u32 v68, v68, v52, v53
    v_max3_u32 v68, v68, v54, v55
    s_waitcnt vmcnt(1)
    v_mfma_f32_16x16x32_bf16 v[64:67], v[56:59], v[10:13], v[64:67]
    v_max3_u32 v68, v68, v56, v57
    v_max3_u32 v68, v68, v58, v59
    s_waitcnt vmcnt(0)
    v_mfma_f32_16x16x32_bf16 v[64:67], v[60:63], v[10:13], v[64:67]
    v_max3_u32 v68, v68, v60, v61
    v_max3_u32 v68, v68, v62, v63
    v_cmp_eq_u32 vcc, -1, v68
    s_cbranch_vccz H1GO_36
    s_sub_u32 s38, s38, 1
    s_cbranch_scc0 H1RT_35
    s_mov_b32 s68, 12
    s_branch FAIL
H1GO_36:
    s_nop 3
    v_permlane32_swap_b32 v64, v66
    v_permlane32_swap_b32 v65, v67
    v_add_f32 v64, v64, v66
    v_add_f32 v65, v65, v67
    v_cvt_pk_bf16_f32 v69, v64, v65
    buffer_store_dword v69, v8, s[40:43], s65 offen
    buffer_store_dword v69, v8, s[40:43], s64 offen sc1
    s_waitcnt vmcnt(1)
    s_branch K3_37
NRED_29:
    s_cmp_lg_u32 s34, 3
    s_cbranch_scc1 K3_37
    s_add_u32 s69, s4, 2
    s_min_u32 s69, s69, 64
    s_cmp_ge_u32 s27, s69
    s_cbranch_scc1 KVOK_38
    s_sleep 3
    s_mov_b32 s38, 262144
PL_39:
    buffer_load_dwordx2 v[48:49], off, s[40:43], s26 sc1
    s_waitcnt vmcnt(0)
    v_min_u32 v48, v48, v49
    s_nop 0
    v_readfirstlane_b32 s27, v48
    s_cmp_lt_u32 s27, s69
    s_cbranch_scc1 PN_40
    s_branch PO_41
PN_40:
    s_sub_u32 s38, s38, 1
    s_cbranch_scc0 PL_39
    s_mov_b32 s68, 11
    s_branch FAIL
PO_41:
KVOK_38:
    s_mov_b32 s38, 262144
K3_37:
    s_barrier
    buffer_load_dwordx4 v[48:51], v2, s[40:43], s60 offen sc1
    buffer_load_dwordx4 v[52:55], v2, s[40:43], s60 offen offset:1024 sc1
    buffer_load_dwordx2 v[56:57], v109, s[40:43], s61 offen sc1
    s_waitcnt vmcnt(2)
    buffer_load_dwordx4 v[58:61], v2, s[40:43], s62 offen sc1
    buffer_load_dwordx4 v[62:65], v2, s[40:43], s62 offen offset:1024 sc1
    buffer_load_dwordx2 v[66:67], v109, s[40:43], s63 offen sc1
    buffer_store_dword v24, off, s[40:43], s67 sc1
    s_waitcnt vmcnt(4)
    v_mfma_f32_16x16x16_bf16 v[68:71], v[14:15], v[48:49], 0
    v_max3_u32 v108, v48, v49, v50
    v_mfma_f32_16x16x16_bf16 v[72:75], v[14:15], v[50:51], 0
    v_max3_u32 v108, v108, v51, v52
    v_mfma_f32_16x16x16_bf16 v[76:79], v[14:15], v[52:53], 0
    v_max3_u32 v108, v108, v53, v54
    v_mfma_f32_16x16x16_bf16 v[80:83], v[14:15], v[54:55], 0
    v_max3_u32 v108, v108, v55, v56
    v_mfma_f32_16x16x16_bf16 v[84:87], v[14:15], v[56:57], 0
    v_max_u32 v108, v108, v57
    v_cmp_eq_u32 vcc, -1, v108
    s_cbranch_vccnz XLRT_42
    s_waitcnt vmcnt(1)
    v_mfma_f32_16x16x16_bf16 v[88:91], v[14:15], v[58:59], v[68:71]
    v_max3_u32 v108, v58, v59, v60
    v_mfma_f32_16x16x16_bf16 v[92:95], v[14:15], v[60:61], v[72:75]
    v_max3_u32 v108, v108, v61, v62
    v_mfma_f32_16x16x16_bf16 v[96:99], v[14:15], v[62:63], v[76:79]
    v_max3_u32 v108, v108, v63, v64
    v_mfma_f32_16x16x16_bf16 v[100:103], v[14:15], v[64:65], v[80:83]
    v_max3_u32 v108, v108, v65, v66
    v_mfma_f32_16x16x16_bf16 v[104:107], v[14:15], v[66:67], v[84:87]
    v_max_u32 v108, v108, v67
    v_cmp_eq_u32 vcc, -1, v108
    s_cbranch_vccz XRGO_45
    s_branch XRRT_43
XLRT_42:
    buffer_load_dwordx4 v[48:51], v2, s[40:43], s60 offen sc1
    buffer_load_dwordx4 v[52:55], v2, s[40:43], s60 offen offset:1024 sc1
    buffer_load_dwordx2 v[56:57], v109, s[40:43], s61 offen sc1
    s_waitcnt vmcnt(0)
    v_mfma_f32_16x16x16_bf16 v[68:71], v[14:15], v[48:49], 0
    v_max3_u32 v108, v48, v49, v50
    v_mfma_f32_16x16x16_bf16 v[72:75], v[14:15], v[50:51], 0
    v_max3_u32 v108, v108, v51, v52
    v_mfma_f32_16x16x16_bf16 v[76:79], v[14:15], v[52:53], 0
    v_max3_u32 v108, v108, v53, v54
    v_mfma_f32_16x16x16_bf16 v[80:83], v[14:15], v[54:55], 0
    v_max3_u32 v108, v108, v55, v56
    v_mfma_f32_16x16x16_bf16 v[84:87], v[14:15], v[56:57], 0
    v_max_u32 v108, v108, v57
    v_cmp_eq_u32 vcc, -1, v108
    s_cbranch_vccz XRCK_44
    s_sub_u32 s38, s38, 1
    s_cbranch_scc0 XLRT_42
    s_mov_b32 s68, 13
    s_branch FAIL
XRRT_43:
    buffer_load_dwordx4 v[58:61], v2, s[40:43], s62 offen sc1
    buffer_load_dwordx4 v[62:65], v2, s[40:43], s62 offen offset:1024 sc1
    buffer_load_dwordx2 v[66:67], v109, s[40:43], s63 offen sc1
XRCK_44:
    s_waitcnt vmcnt(0)
    v_mfma_f32_16x16x16_bf16 v[88:91], v[14:15], v[58:59], v[68:71]
    v_max3_u32 v108, v58, v59, v60
    v_mfma_f32_16x16x16_bf16 v[92:95], v[14:15], v[60:61], v[72:75]
    v_max3_u32 v108, v108, v61, v62
    v_mfma_f32_16x16x16_bf16 v[96:99], v[14:15], v[62:63], v[76:79]
    v_max3_u32 v108, v108, v63, v64
    v_mfma_f32_16x16x16_bf16 v[100:103], v[14:15], v[64:65], v[80:83]
    v_max3_u32 v108, v108, v65, v66
    v_mfma_f32_16x16x16_bf16 v[104:107], v[14:15], v[66:67], v[84:87]
    v_max_u32 v108, v108, v67
    v_cmp_eq_u32 vcc, -1, v108
    s_cbranch_vccz XRGO_45
    s_sub_u32 s38, s38, 1
    s_cbranch_scc0 XRRT_43
    s_mov_b32 s68, 14
    s_branch FAIL
XRGO_45:
DRY_34:
    s_cmp_lt_u32 s4, 63
    s_cbranch_scc1 CH_LOOP_fast
    s_cmp_ge_u32 s34, 2
    s_cbranch_scc1 ZfastW2_48
    s_cmp_eq_u32 s34, 1
    s_cbranch_scc1 ZfastW1_47
ZfastW0_46:
    v_cvt_pk_bf16_f32 v48, v88, v89
    v_cvt_pk_bf16_f32 v49, v90, v91
    v_cvt_pk_bf16_f32 v50, v92, v93
    v_cvt_pk_bf16_f32 v51, v94, v95
    ds_write_b128 v110, v[48:51] offset:0
    v_cvt_pk_bf16_f32 v52, v96, v97
    v_cvt_pk_bf16_f32 v53, v98, v99
    v_cvt_pk_bf16_f32 v54, v100, v101
    v_cvt_pk_bf16_f32 v55, v102, v103
    v_smfmac_f32_16x16x64_bf16 v[36:39], v[48:51], a[160:167], v1
    ds_write_b128 v110, v[52:55] offset:1024
    v_cvt_pk_bf16_f32 v56, v104, v105
    v_cvt_pk_bf16_f32 v57, v106, v107
    v_smfmac_f32_16x16x64_bf16 v[40:43], v[48:51], a[240:247], v1
    ds_write_b64 v111, v[56:57] offset:0
    v_smfmac_f32_16x16x64_bf16 v[36:39], v[52:55], a[168:175], v1
    v_smfmac_f32_16x16x64_bf16 v[40:43], v[52:55], a[248:255], v1
    s_waitcnt lgkmcnt(0)
    s_barrier
    ds_read_b128 v[56:59], v2 offset:2048
    ds_read_b128 v[60:63], v2 offset:3072
    s_waitcnt lgkmcnt(1)
    v_smfmac_f32_16x16x64_bf16 v[36:39], v[56:59], a[176:183], v1
    ds_read_b128 v[64:67], v2 offset:4096
    v_smfmac_f32_16x16x64_bf16 v[40:43], v[56:59], v[112:119], v1
    ds_read_b128 v[68:71], v2 offset:5120
    s_waitcnt lgkmcnt(2)
    v_smfmac_f32_16x16x64_bf16 v[36:39], v[60:63], a[184:191], v1
    ds_read_b128 v[72:75], v2 offset:6144
    v_smfmac_f32_16x16x64_bf16 v[40:43], v[60:63], v[120:127], v1
    ds_read_b128 v[76:79], v2 offset:7168
    s_waitcnt lgkmcnt(3)
    v_smfmac_f32_16x16x64_bf16 v[36:39], v[64:67], a[192:199], v1
    ds_read_b128 v[80:83], v2 offset:8192
    v_smfmac_f32_16x16x64_bf16 v[40:43], v[64:67], v[128:135], v1
    ds_read_b128 v[84:87], v2 offset:9216
    s_waitcnt lgkmcnt(4)
    v_smfmac_f32_16x16x64_bf16 v[36:39], v[68:71], a[200:207], v1
    v_smfmac_f32_16x16x64_bf16 v[40:43], v[68:71], v[136:143], v1
    s_waitcnt lgkmcnt(3)
    v_smfmac_f32_16x16x64_bf16 v[36:39], v[72:75], a[208:215], v1
    v_smfmac_f32_16x16x64_bf16 v[40:43], v[72:75], v[144:151], v1
    s_waitcnt lgkmcnt(2)
    v_smfmac_f32_16x16x64_bf16 v[36:39], v[76:79], a[216:223], v1
    v_smfmac_f32_16x16x64_bf16 v[40:43], v[76:79], v[152:159], v1
    s_waitcnt lgkmcnt(0)
    v_smfmac_f32_16x16x64_bf16 v[36:39], v[80:83], a[224:231], v1
    v_smfmac_f32_16x16x64_bf16 v[40:43], v[80:83], v[160:167], v1
    v_smfmac_f32_16x16x64_bf16 v[36:39], v[84:87], a[232:239], v1
    v_smfmac_f32_16x16x64_bf16 v[40:43], v[84:87], v[168:175], v1
    v_smfmac_f32_16x16x64_bf16 v[44:47], v[48:51], v[176:183], v1
    v_smfmac_f32_16x16x64_bf16 v[44:47], v[52:55], v[184:191], v1
    v_add_f32 v36, v36, v38
    v_add_f32 v37, v37, v39
    v_add_f32 v40, v40, v42
    v_add_f32 v41, v41, v43
    v_cvt_pk_bf16_f32 v92, v36, v37
    v_cvt_pk_bf16_f32 v94, v40, v41
    ds_write_b64 v4, v[92:93]
    ds_write_b64 v4, v[94:95] offset:640
    v_smfmac_f32_16x16x64_bf16 v[44:47], v[56:59], v[192:199], v1
    v_smfmac_f32_16x16x64_bf16 v[44:47], v[60:63], v[200:207], v1
    v_smfmac_f32_16x16x64_bf16 v[44:47], v[64:67], v[208:215], v1
    s_waitcnt lgkmcnt(0)
    s_barrier
    v_mov_b32 v104, 63
    buffer_store_dword v104, off, s[40:43], s25 sc1
    ds_read_b64_tr_b16 v[100:101], v9 offset:0
    ds_read_b64_tr_b16 v[102:103], v9 offset:320
    v_smfmac_f32_16x16x64_bf16 v[44:47], v[68:71], v[216:223], v1
    v_smfmac_f32_16x16x64_bf16 v[44:47], v[72:75], v[224:231], v1
    v_smfmac_f32_16x16x64_bf16 v[44:47], v[76:79], v[232:239], v1
    v_smfmac_f32_16x16x64_bf16 v[44:47], v[80:83], v[240:247], v1
    v_smfmac_f32_16x16x64_bf16 v[44:47], v[84:87], v[248:255], v1
    s_branch ZfastE_50
ZfastW1_47:
    v_cvt_pk_bf16_f32 v48, v88, v89
    v_cvt_pk_bf16_f32 v49, v90, v91
    v_cvt_pk_bf16_f32 v50, v92, v93
    v_cvt_pk_bf16_f32 v51, v94, v95
    ds_write_b128 v110, v[48:51] offset:0
    v_cvt_pk_bf16_f32 v52, v96, v97
    v_cvt_pk_bf16_f32 v53, v98, v99
    v_cvt_pk_bf16_f32 v54, v100, v101
    v_cvt_pk_bf16_f32 v55, v102, v103
    v_smfmac_f32_16x16x64_bf16 v[36:39], v[48:51], a[176:183], v1
    ds_write_b128 v110, v[52:55] offset:1024
    v_cvt_pk_bf16_f32 v56, v104, v105
    v_cvt_pk_bf16_f32 v57, v106, v107
    v_smfmac_f32_16x16x64_bf16 v[40:43], v[48:51], v[112:119], v1
    ds_write_b64 v111, v[56:57] offset:0
    v_smfmac_f32_16x16x64_bf16 v[36:39], v[52:55], a[184:191], v1
    v_smfmac_f32_16x16x64_bf16 v[40:43], v[52:55], v[120:127], v1
    s_waitcnt lgkmcnt(0)
    s_barrier
    ds_read_b128 v[56:59], v2 offset:4096
    ds_read_b128 v[60:63], v2 offset:5120
    s_waitcnt lgkmcnt(1)
    v_smfmac_f32_16x16x64_bf16 v[36:39], v[56:59], a[192:199], v1
    ds_read_b128 v[64:67], v2 offset:6144
    v_smfmac_f32_16x16x64_bf16 v[40:43], v[56:59], v[128:135], v1
    ds_read_b128 v[68:71], v2 offset:7168
    s_waitcnt lgkmcnt(2)
    v_smfmac_f32_16x16x64_bf16 v[36:39], v[60:63], a[200:207], v1
    ds_read_b128 v[72:75], v2 offset:8192
    v_smfmac_f32_16x16x64_bf16 v[40:43], v[60:63], v[136:143], v1
    ds_read_b128 v[76:79], v2 offset:9216
    s_waitcnt lgkmcnt(3)
    v_smfmac_f32_16x16x64_bf16 v[36:39], v[64:67], a[208:215], v1
    ds_read_b128 v[80:83], v2 offset:0
    v_smfmac_f32_16x16x64_bf16 v[40:43], v[64:67], v[144:151], v1
    ds_read_b128 v[84:87], v2 offset:1024
    s_waitcnt lgkmcnt(4)
    v_smfmac_f32_16x16x64_bf16 v[36:39], v[68:71], a[216:223], v1
    v_smfmac_f32_16x16x64_bf16 v[40:43], v[68:71], v[152:159], v1
    s_waitcnt lgkmcnt(3)
    v_smfmac_f32_16x16x64_bf16 v[36:39], v[72:75], a[224:231], v1
    v_smfmac_f32_16x16x64_bf16 v[40:43], v[72:75], v[160:167], v1
    s_waitcnt lgkmcnt(2)
    v_smfmac_f32_16x16x64_bf16 v[36:39], v[76:79], a[232:239], v1
    v_smfmac_f32_16x16x64_bf16 v[40:43], v[76:79], v[168:175], v1
    s_waitcnt lgkmcnt(0)
    v_smfmac_f32_16x16x64_bf16 v[36:39], v[80:83], a[160:167], v1
    v_smfmac_f32_16x16x64_bf16 v[40:43], v[80:83], a[240:247], v1
    v_smfmac_f32_16x16x64_bf16 v[36:39], v[84:87], a[168:175], v1
    v_smfmac_f32_16x16x64_bf16 v[40:43], v[84:87], a[248:255], v1
    v_smfmac_f32_16x16x64_bf16 v[44:47], v[48:51], v[192:199], v1
    v_smfmac_f32_16x16x64_bf16 v[44:47], v[52:55], v[200:207], v1
    v_add_f32 v36, v36, v38
    v_add_f32 v37, v37, v39
    v_add_f32 v40, v40, v42
    v_add_f32 v41, v41, v43
    v_cvt_pk_bf16_f32 v92, v36, v37
    v_cvt_pk_bf16_f32 v94, v40, v41
    ds_write_b64 v4, v[92:93]
    ds_write_b64 v4, v[94:95] offset:640
    v_smfmac_f32_16x16x64_bf16 v[44:47], v[56:59], v[208:215], v1
    v_smfmac_f32_16x16x64_bf16 v[44:47], v[60:63], v[216:223], v1
    v_smfmac_f32_16x16x64_bf16 v[44:47], v[64:67], v[224:231], v1
    s_waitcnt lgkmcnt(0)
    s_barrier
    v_mov_b32 v104, 63
    buffer_store_dword v104, off, s[40:43], s25 sc1
    ds_read_b64_tr_b16 v[100:101], v9 offset:0
    ds_read_b64_tr_b16 v[102:103], v9 offset:320
    v_smfmac_f32_16x16x64_bf16 v[44:47], v[68:71], v[232:239], v1
    v_smfmac_f32_16x16x64_bf16 v[44:47], v[72:75], v[240:247], v1
    v_smfmac_f32_16x16x64_bf16 v[44:47], v[76:79], v[248:255], v1
    v_smfmac_f32_16x16x64_bf16 v[44:47], v[80:83], v[176:183], v1
    v_smfmac_f32_16x16x64_bf16 v[44:47], v[84:87], v[184:191], v1
    s_branch ZfastE_50
ZfastW2_48:
    s_cmp_eq_u32 s34, 3
    s_cbranch_scc1 ZfastW3_49
    v_cvt_pk_bf16_f32 v48, v88, v89
    v_cvt_pk_bf16_f32 v49, v90, v91
    v_cvt_pk_bf16_f32 v50, v92, v93
    v_cvt_pk_bf16_f32 v51, v94, v95
    ds_write_b128 v110, v[48:51] offset:0
    v_cvt_pk_bf16_f32 v52, v96, v97
    v_cvt_pk_bf16_f32 v53, v98, v99
    v_cvt_pk_bf16_f32 v54, v100, v101
    v_cvt_pk_bf16_f32 v55, v102, v103
    v_smfmac_f32_16x16x64_bf16 v[36:39], v[48:51], a[192:199], v1
    ds_write_b128 v110, v[52:55] offset:1024
    v_cvt_pk_bf16_f32 v56, v104, v105
    v_cvt_pk_bf16_f32 v57, v106, v107
    v_smfmac_f32_16x16x64_bf16 v[40:43], v[48:51], v[128:135], v1
    ds_write_b64 v111, v[56:57] offset:0
    v_smfmac_f32_16x16x64_bf16 v[36:39], v[52:55], a[200:207], v1
    v_smfmac_f32_16x16x64_bf16 v[40:43], v[52:55], v[136:143], v1
    s_waitcnt lgkmcnt(0)
    s_barrier
    ds_read_b128 v[56:59], v2 offset:6144
    ds_read_b128 v[60:63], v2 offset:7168
    s_waitcnt lgkmcnt(1)
    v_smfmac_f32_16x16x64_bf16 v[36:39], v[56:59], a[208:215], v1
    ds_read_b128 v[64:67], v2 offset:8192
    v_smfmac_f32_16x16x64_bf16 v[40:43], v[56:59], v[144:151], v1
    ds_read_b128 v[68:71], v2 offset:9216
    s_waitcnt lgkmcnt(2)
    v_smfmac_f32_16x16x64_bf16 v[36:39], v[60:63], a[216:223], v1
    ds_read_b128 v[72:75], v2 offset:0
    v_smfmac_f32_16x16x64_bf16 v[40:43], v[60:63], v[152:159], v1
    ds_read_b128 v[76:79], v2 offset:1024
    s_waitcnt lgkmcnt(3)
    v_smfmac_f32_16x16x64_bf16 v[36:39], v[64:67], a[224:231], v1
    ds_read_b128 v[80:83], v2 offset:2048
    v_smfmac_f32_16x16x64_bf16 v[40:43], v[64:67], v[160:167], v1
    ds_read_b128 v[84:87], v2 offset:3072
    s_waitcnt lgkmcnt(4)
    v_smfmac_f32_16x16x64_bf16 v[36:39], v[68:71], a[232:239], v1
    v_smfmac_f32_16x16x64_bf16 v[40:43], v[68:71], v[168:175], v1
    s_waitcnt lgkmcnt(3)
    v_smfmac_f32_16x16x64_bf16 v[36:39], v[72:75], a[160:167], v1
    v_smfmac_f32_16x16x64_bf16 v[40:43], v[72:75], a[240:247], v1
    s_waitcnt lgkmcnt(2)
    v_smfmac_f32_16x16x64_bf16 v[36:39], v[76:79], a[168:175], v1
    v_smfmac_f32_16x16x64_bf16 v[40:43], v[76:79], a[248:255], v1
    s_waitcnt lgkmcnt(0)
    v_smfmac_f32_16x16x64_bf16 v[36:39], v[80:83], a[176:183], v1
    v_smfmac_f32_16x16x64_bf16 v[40:43], v[80:83], v[112:119], v1
    v_smfmac_f32_16x16x64_bf16 v[36:39], v[84:87], a[184:191], v1
    v_smfmac_f32_16x16x64_bf16 v[40:43], v[84:87], v[120:127], v1
    v_smfmac_f32_16x16x64_bf16 v[44:47], v[48:51], v[208:215], v1
    v_smfmac_f32_16x16x64_bf16 v[44:47], v[52:55], v[216:223], v1
    v_add_f32 v36, v36, v38
    v_add_f32 v37, v37, v39
    v_add_f32 v40, v40, v42
    v_add_f32 v41, v41, v43
    v_cvt_pk_bf16_f32 v92, v36, v37
    v_cvt_pk_bf16_f32 v94, v40, v41
    ds_write_b64 v4, v[92:93]
    ds_write_b64 v4, v[94:95] offset:640
    v_smfmac_f32_16x16x64_bf16 v[44:47], v[56:59], v[224:231], v1
    v_smfmac_f32_16x16x64_bf16 v[44:47], v[60:63], v[232:239], v1
    v_smfmac_f32_16x16x64_bf16 v[44:47], v[64:67], v[240:247], v1
    s_waitcnt lgkmcnt(0)
    s_barrier
    v_mov_b32 v104, 63
    buffer_store_dword v104, off, s[40:43], s25 sc1
    ds_read_b64_tr_b16 v[100:101], v9 offset:0
    ds_read_b64_tr_b16 v[102:103], v9 offset:320
    v_smfmac_f32_16x16x64_bf16 v[44:47], v[68:71], v[248:255], v1
    v_smfmac_f32_16x16x64_bf16 v[44:47], v[72:75], v[176:183], v1
    v_smfmac_f32_16x16x64_bf16 v[44:47], v[76:79], v[184:191], v1
    v_smfmac_f32_16x16x64_bf16 v[44:47], v[80:83], v[192:199], v1
    v_smfmac_f32_16x16x64_bf16 v[44:47], v[84:87], v[200:207], v1
    s_branch ZfastE_50
ZfastW3_49:
    v_cvt_pk_bf16_f32 v48, v88, v89
    v_cvt_pk_bf16_f32 v49, v90, v91
    v_cvt_pk_bf16_f32 v50, v92, v93
    v_cvt_pk_bf16_f32 v51, v94, v95
    ds_write_b128 v110, v[48:51] offset:0
    v_cvt_pk_bf16_f32 v52, v96, v97
    v_cvt_pk_bf16_f32 v53, v98, v99
    v_cvt_pk_bf16_f32 v54, v100, v101
    v_cvt_pk_bf16_f32 v55, v102, v103
    v_smfmac_f32_16x16x64_bf16 v[36:39], v[48:51], a[208:215], v1
    ds_write_b128 v110, v[52:55] offset:1024
    v_cvt_pk_bf16_f32 v56, v104, v105
    v_cvt_pk_bf16_f32 v57, v106, v107
    v_smfmac_f32_16x16x64_bf16 v[40:43], v[48:51], v[144:151], v1
    ds_write_b64 v111, v[56:57] offset:0
    v_smfmac_f32_16x16x64_bf16 v[36:39], v[52:55], a[216:223], v1
    v_smfmac_f32_16x16x64_bf16 v[40:43], v[52:55], v[152:159], v1
    s_waitcnt lgkmcnt(0)
    s_barrier
    ds_read_b128 v[56:59], v2 offset:8192
    ds_read_b128 v[60:63], v2 offset:9216
    s_waitcnt lgkmcnt(1)
    v_smfmac_f32_16x16x64_bf16 v[36:39], v[56:59], a[224:231], v1
    ds_read_b128 v[64:67], v2 offset:0
    v_smfmac_f32_16x16x64_bf16 v[40:43], v[56:59], v[160:167], v1
    ds_read_b128 v[68:71], v2 offset:1024
    s_waitcnt lgkmcnt(2)
    v_smfmac_f32_16x16x64_bf16 v[36:39], v[60:63], a[232:239], v1
    ds_read_b128 v[72:75], v2 offset:2048
    v_smfmac_f32_16x16x64_bf16 v[40:43], v[60:63], v[168:175], v1
    ds_read_b128 v[76:79], v2 offset:3072
    s_waitcnt lgkmcnt(3)
    v_smfmac_f32_16x16x64_bf16 v[36:39], v[64:67], a[160:167], v1
    ds_read_b128 v[80:83], v2 offset:4096
    v_smfmac_f32_16x16x64_bf16 v[40:43], v[64:67], a[240:247], v1
    ds_read_b128 v[84:87], v2 offset:5120
    s_waitcnt lgkmcnt(4)
    v_smfmac_f32_16x16x64_bf16 v[36:39], v[68:71], a[168:175], v1
    v_smfmac_f32_16x16x64_bf16 v[40:43], v[68:71], a[248:255], v1
    s_waitcnt lgkmcnt(3)
    v_smfmac_f32_16x16x64_bf16 v[36:39], v[72:75], a[176:183], v1
    v_smfmac_f32_16x16x64_bf16 v[40:43], v[72:75], v[112:119], v1
    s_waitcnt lgkmcnt(2)
    v_smfmac_f32_16x16x64_bf16 v[36:39], v[76:79], a[184:191], v1
    v_smfmac_f32_16x16x64_bf16 v[40:43], v[76:79], v[120:127], v1
    s_waitcnt lgkmcnt(0)
    v_smfmac_f32_16x16x64_bf16 v[36:39], v[80:83], a[192:199], v1
    v_smfmac_f32_16x16x64_bf16 v[40:43], v[80:83], v[128:135], v1
    v_smfmac_f32_16x16x64_bf16 v[36:39], v[84:87], a[200:207], v1
    v_smfmac_f32_16x16x64_bf16 v[40:43], v[84:87], v[136:143], v1
    v_smfmac_f32_16x16x64_bf16 v[44:47], v[48:51], v[224:231], v1
    v_smfmac_f32_16x16x64_bf16 v[44:47], v[52:55], v[232:239], v1
    v_add_f32 v36, v36, v38
    v_add_f32 v37, v37, v39
    v_add_f32 v40, v40, v42
    v_add_f32 v41, v41, v43
    v_cvt_pk_bf16_f32 v92, v36, v37
    v_cvt_pk_bf16_f32 v94, v40, v41
    ds_write_b64 v4, v[92:93]
    ds_write_b64 v4, v[94:95] offset:640
    v_smfmac_f32_16x16x64_bf16 v[44:47], v[56:59], v[240:247], v1
    v_smfmac_f32_16x16x64_bf16 v[44:47], v[60:63], v[248:255], v1
    v_smfmac_f32_16x16x64_bf16 v[44:47], v[64:67], v[176:183], v1
    s_waitcnt lgkmcnt(0)
    s_barrier
    v_mov_b32 v104, 63
    buffer_store_dword v104, off, s[40:43], s25 sc1
    ds_read_b64_tr_b16 v[100:101], v9 offset:0
    ds_read_b64_tr_b16 v[102:103], v9 offset:320
    v_smfmac_f32_16x16x64_bf16 v[44:47], v[68:71], v[184:191], v1
    v_smfmac_f32_16x16x64_bf16 v[44:47], v[72:75], v[192:199], v1
    v_smfmac_f32_16x16x64_bf16 v[44:47], v[76:79], v[200:207], v1
    v_smfmac_f32_16x16x64_bf16 v[44:47], v[80:83], v[208:215], v1
    v_smfmac_f32_16x16x64_bf16 v[44:47], v[84:87], v[216:223], v1
ZfastE_50:
    s_nop 7
    v_add_f32 v44, v44, v46
    v_add_f32 v45, v45, v47
    v_cvt_pk_bf16_f32 v20, v44, v45
    s_waitcnt lgkmcnt(0)
    v_lshrrev_b32 v92, 2, v2
    buffer_store_dwordx4 v[100:103], v2, s[40:43], s23 offen sc1
    buffer_store_dword v20, v92, s[40:43], s24 offen sc1
    s_waitcnt vmcnt(0)
    s_barrier
    v_mov_b32 v104, 64
    buffer_store_dword v104, off, s[40:43], s25 sc1
    s_branch END
.p2align 6
    s_nop 0
    s_nop 0
CH_LOOP_safe:
    s_cmp_ge_u32 s34, 2
    s_cbranch_scc1 PsafeW2_53
    s_cmp_eq_u32 s34, 1
    s_cbranch_scc1 PsafeW1_52
PsafeW0_51:
    v_cvt_pk_bf16_f32 v48, v88, v89
    v_cvt_pk_bf16_f32 v49, v90, v91
    v_cvt_pk_bf16_f32 v50, v92, v93
    v_cvt_pk_bf16_f32 v51, v94, v95
    ds_write_b128 v110, v[48:51] offset:0
    v_cvt_pk_bf16_f32 v52, v96, v97
    v_cvt_pk_bf16_f32 v53, v98, v99
    v_cvt_pk_bf16_f32 v54, v100, v101
    v_cvt_pk_bf16_f32 v55, v102, v103
    v_smfmac_f32_16x16x64_bf16 v[28:31], v[48:51], a[0:7], v1
    ds_write_b128 v110, v[52:55] offset:1024
    v_cvt_pk_bf16_f32 v56, v104, v105
    v_cvt_pk_bf16_f32 v57, v106, v107
    v_smfmac_f32_16x16x64_bf16 v[32:35], v[48:51], a[80:87], v1
    ds_write_b64 v111, v[56:57] offset:0
    v_smfmac_f32_16x16x64_bf16 v[28:31], v[52:55], a[8:15], v1
    v_mov_b64 v[100:101], -1
    v_mov_b64 v[102:103], -1
    v_smfmac_f32_16x16x64_bf16 v[32:35], v[52:55], a[88:95], v1
    s_waitcnt lgkmcnt(0)
    s_barrier
    ds_read_b128 v[56:59], v2 offset:2048
    ds_read_b128 v[60:63], v2 offset:3072
    v_smfmac_f32_16x16x64_bf16 v[36:39], v[48:51], a[160:167], v1
    ds_read_b128 v[64:67], v2 offset:4096
    s_mov_b32 m0, s52
    v_smfmac_f32_16x16x64_bf16 v[40:43], v[48:51], a[240:247], v1
    ds_read_b128 v[68:71], v2 offset:5120
    buffer_load_dwordx4 v2, s[40:43], s21 offen sc1 lds
    v_smfmac_f32_16x16x64_bf16 v[36:39], v[52:55], a[168:175], v1
    ds_read_b128 v[72:75], v2 offset:6144
    v_smfmac_f32_16x16x64_bf16 v[40:43], v[52:55], a[248:255], v1
    ds_read_b128 v[76:79], v2 offset:7168
    s_waitcnt lgkmcnt(5)
    v_smfmac_f32_16x16x64_bf16 v[28:31], v[56:59], a[16:23], v1
    ds_read_b128 v[80:83], v2 offset:8192
    buffer_load_dwordx4 v2, s[40:43], s21 offen offset:1024 sc1 lds
    v_smfmac_f32_16x16x64_bf16 v[32:35], v[56:59], a[96:103], v1
    ds_read_b128 v[84:87], v2 offset:9216
    s_waitcnt lgkmcnt(6)
    v_smfmac_f32_16x16x64_bf16 v[28:31], v[60:63], a[24:31], v1
    s_mov_b32 m0, s53
    v_smfmac_f32_16x16x64_bf16 v[32:35], v[60:63], a[104:111], v1
    s_waitcnt lgkmcnt(5)
    buffer_load_dwordx4 v2, s[40:43], s22 offen sc1 lds
    v_smfmac_f32_16x16x64_bf16 v[28:31], v[64:67], a[32:39], v1
    v_smfmac_f32_16x16x64_bf16 v[32:35], v[64:67], a[112:119], v1
    s_waitcnt lgkmcnt(4)
    buffer_store_dwordx4 v[100:103], v2, s[40:43], s50 offen sc1
    v_smfmac_f32_16x16x64_bf16 v[28:31], v[68:71], a[40:47], v1
    v_smfmac_f32_16x16x64_bf16 v[32:35], v[68:71], a[120:127], v1
    s_waitcnt lgkmcnt(3)
    v_smfmac_f32_16x16x64_bf16 v[28:31], v[72:75], a[48:55], v1
    buffer_store_dwordx4 v[100:103], v2, s[40:43], s50 offen offset:1024 sc1
    v_smfmac_f32_16x16x64_bf16 v[32:35], v[72:75], a[128:135], v1
    s_waitcnt lgkmcnt(2)
    v_smfmac_f32_16x16x64_bf16 v[28:31], v[76:79], a[56:63], v1
    v_smfmac_f32_16x16x64_bf16 v[32:35], v[76:79], a[136:143], v1
    s_waitcnt lgkmcnt(0)
    buffer_store_dwordx4 v[100:103], v2, s[40:43], s51 offen sc1
    v_smfmac_f32_16x16x64_bf16 v[28:31], v[80:83], a[64:71], v1
    v_smfmac_f32_16x16x64_bf16 v[32:35], v[80:83], a[144:151], v1
    v_smfmac_f32_16x16x64_bf16 v[28:31], v[84:87], a[72:79], v1
    buffer_store_dword v100, v8, s[40:43], s49 offen sc1
    v_smfmac_f32_16x16x64_bf16 v[32:35], v[84:87], a[152:159], v1
    v_smfmac_f32_16x16x64_bf16 v[36:39], v[56:59], a[176:183], v1
    buffer_store_dword v100, v8, s[40:43], s48 offen sc1
    v_smfmac_f32_16x16x64_bf16 v[40:43], v[56:59], v[112:119], v1
    v_smfmac_f32_16x16x64_bf16 v[36:39], v[60:63], a[184:191], v1
    v_add_f32 v28, v28, v30
    v_add_f32 v29, v29, v31
    v_smfmac_f32_16x16x64_bf16 v[40:43], v[60:63], v[120:127], v1
    v_add_f32 v32, v32, v34
    v_add_f32 v33, v33, v35
    v_smfmac_f32_16x16x64_bf16 v[36:39], v[64:67], a[192:199], v1
    v_cvt_pk_bf16_f32 v93, v28, v29
    v_smfmac_f32_16x16x64_bf16 v[40:43], v[64:67], v[128:135], v1
    v_cvt_pk_bf16_f32 v95, v32, v33
    v_smfmac_f32_16x16x64_bf16 v[36:39], v[68:71], a[200:207], v1
    v_mov_b32 v92, s4
    v_smfmac_f32_16x16x64_bf16 v[40:43], v[68:71], v[136:143], v1
    buffer_store_dword v92, off, s[40:43], s25 sc1
    v_smfmac_f32_16x16x64_bf16 v[36:39], v[72:75], a[208:215], v1
    ds_read_b128 v[108:111], v3 offset:0
    v_smfmac_f32_16x16x64_bf16 v[40:43], v[72:75], v[144:151], v1
    v_smfmac_f32_16x16x64_bf16 v[36:39], v[76:79], a[216:223], v1
    ds_read_b128 v[104:107], v3 offset:4096
    v_smfmac_f32_16x16x64_bf16 v[40:43], v[76:79], v[152:159], v1
    v_smfmac_f32_16x16x64_bf16 v[36:39], v[80:83], a[224:231], v1
    ds_read_b128 v[96:99], v3 offset:1024
    v_smfmac_f32_16x16x64_bf16 v[40:43], v[80:83], v[160:167], v1
    v_smfmac_f32_16x16x64_bf16 v[36:39], v[84:87], a[232:239], v1
    ds_read_b128 v[100:103], v3 offset:5120
    v_smfmac_f32_16x16x64_bf16 v[40:43], v[84:87], v[168:175], v1
    v_smfmac_f32_16x16x64_bf16 v[44:47], v[48:51], v[176:183], v1
    v_smfmac_f32_16x16x64_bf16 v[44:47], v[52:55], v[184:191], v1
    v_add_f32 v36, v36, v38
    v_add_f32 v37, v37, v39
    v_add_f32 v40, v40, v42
    v_add_f32 v41, v41, v43
    v_cvt_pk_bf16_f32 v92, v36, v37
    v_cvt_pk_bf16_f32 v94, v40, v41
    ds_write_b64 v4, v[92:93]
    ds_write_b64 v4, v[94:95] offset:640
    v_smfmac_f32_16x16x64_bf16 v[44:47], v[56:59], v[192:199], v1
    v_smfmac_f32_16x16x64_bf16 v[44:47], v[60:63], v[200:207], v1
    v_smfmac_f32_16x16x64_bf16 v[44:47], v[64:67], v[208:215], v1
    s_waitcnt lgkmcnt(0)
    s_barrier
    ds_read_b64_tr_b16 v[48:49], v5 offset:0
    ds_read_b64_tr_b16 v[50:51], v5 offset:320
    v_smfmac_f32_16x16x64_bf16 v[44:47], v[68:71], v[216:223], v1
    ds_read_b64_tr_b16 v[52:53], v5 offset:1280
    v_smfmac_f32_16x16x64_bf16 v[44:47], v[72:75], v[224:231], v1
    ds_read_b64_tr_b16 v[54:55], v5 offset:1600
    v_smfmac_f32_16x16x64_bf16 v[44:47], v[76:79], v[232:239], v1
    ds_read_b64_tr_b16 v[56:57], v5 offset:2560
    v_smfmac_f32_16x16x64_bf16 v[44:47], v[80:83], v[240:247], v1
    ds_read_b64_tr_b16 v[58:59], v5 offset:2880
    v_smfmac_f32_16x16x64_bf16 v[44:47], v[84:87], v[248:255], v1
    ds_read_b64_tr_b16 v[60:61], v5 offset:3840
    s_branch PsafeE_55
PsafeW1_52:
    v_cvt_pk_bf16_f32 v48, v88, v89
    v_cvt_pk_bf16_f32 v49, v90, v91
    v_cvt_pk_bf16_f32 v50, v92, v93
    v_cvt_pk_bf16_f32 v51, v94, v95
    ds_write_b128 v110, v[48:51] offset:0
    v_cvt_pk_bf16_f32 v52, v96, v97
    v_cvt_pk_bf16_f32 v53, v98, v99
    v_cvt_pk_bf16_f32 v54, v100, v101
    v_cvt_pk_bf16_f32 v55, v102, v103
    v_smfmac_f32_16x16x64_bf16 v[28:31], v[48:51], a[16:23], v1
    ds_write_b128 v110, v[52:55] offset:1024
    v_cvt_pk_bf16_f32 v56, v104, v105
    v_cvt_pk_bf16_f32 v57, v106, v107
    v_smfmac_f32_16x16x64_bf16 v[32:35], v[48:51], a[96:103], v1
    ds_write_b64 v111, v[56:57] offset:0
    v_smfmac_f32_16x16x64_bf16 v[28:31], v[52:55], a[24:31], v1
    v_mov_b64 v[100:101], -1
    v_mov_b64 v[102:103], -1
    v_smfmac_f32_16x16x64_bf16 v[32:35], v[52:55], a[104:111], v1
    s_waitcnt lgkmcnt(0)
    s_barrier
    ds_read_b128 v[56:59], v2 offset:4096
    ds_read_b128 v[60:63], v2 offset:5120
    v_smfmac_f32_16x16x64_bf16 v[36:39], v[48:51], a[176:183], v1
    ds_read_b128 v[64:67], v2 offset:6144
    s_mov_b32 m0, s52
    v_smfmac_f32_16x16x64_bf16 v[40:43], v[48:51], v[112:119], v1
    ds_read_b128 v[68:71], v2 offset:7168
    buffer_load_dwordx4 v2, s[40:43], s21 offen sc1 lds
    v_smfmac_f32_16x16x64_bf16 v[36:39], v[52:55], a[184:191], v1
    ds_read_b128 v[72:75], v2 offset:8192
    v_smfmac_f32_16x16x64_bf16 v[40:43], v[52:55], v[120:127], v1
    ds_read_b128 v[76:79], v2 offset:9216
    s_waitcnt lgkmcnt(5)
    v_smfmac_f32_16x16x64_bf16 v[28:31], v[56:59], a[32:39], v1
    ds_read_b128 v[80:83], v2 offset:0
    buffer_load_dwordx4 v2, s[40:43], s21 offen offset:1024 sc1 lds
    v_smfmac_f32_16x16x64_bf16 v[32:35], v[56:59], a[112:119], v1
    ds_read_b128 v[84:87], v2 offset:1024
    s_waitcnt lgkmcnt(6)
    v_smfmac_f32_16x16x64_bf16 v[28:31], v[60:63], a[40:47], v1
    s_mov_b32 m0, s53
    v_smfmac_f32_16x16x64_bf16 v[32:35], v[60:63], a[120:127], v1
    s_waitcnt lgkmcnt(5)
    buffer_load_dwordx4 v2, s[40:43], s22 offen sc1 lds
    v_smfmac_f32_16x16x64_bf16 v[28:31], v[64:67], a[48:55], v1
    v_smfmac_f32_16x16x64_bf16 v[32:35], v[64:67], a[128:135], v1
    s_waitcnt lgkmcnt(4)
    buffer_store_dwordx4 v[100:103], v2, s[40:43], s50 offen sc1
    v_smfmac_f32_16x16x64_bf16 v[28:31], v[68:71], a[56:63], v1
    v_smfmac_f32_16x16x64_bf16 v[32:35], v[68:71], a[136:143], v1
    s_waitcnt lgkmcnt(3)
    v_smfmac_f32_16x16x64_bf16 v[28:31], v[72:75], a[64:71], v1
    buffer_store_dwordx4 v[100:103], v2, s[40:43], s50 offen offset:1024 sc1
    v_smfmac_f32_16x16x64_bf16 v[32:35], v[72:75], a[144:151], v1
    s_waitcnt lgkmcnt(2)
    v_smfmac_f32_16x16x64_bf16 v[28:31], v[76:79], a[72:79], v1
    v_smfmac_f32_16x16x64_bf16 v[32:35], v[76:79], a[152:159], v1
    s_waitcnt lgkmcnt(0)
    buffer_store_dwordx4 v[100:103], v2, s[40:43], s51 offen sc1
    v_smfmac_f32_16x16x64_bf16 v[28:31], v[80:83], a[0:7], v1
    v_smfmac_f32_16x16x64_bf16 v[32:35], v[80:83], a[80:87], v1
    v_smfmac_f32_16x16x64_bf16 v[28:31], v[84:87], a[8:15], v1
    buffer_store_dword v100, v8, s[40:43], s49 offen sc1
    v_smfmac_f32_16x16x64_bf16 v[32:35], v[84:87], a[88:95], v1
    v_smfmac_f32_16x16x64_bf16 v[36:39], v[56:59], a[192:199], v1
    buffer_store_dword v100, v8, s[40:43], s48 offen sc1
    v_smfmac_f32_16x16x64_bf16 v[40:43], v[56:59], v[128:135], v1
    v_smfmac_f32_16x16x64_bf16 v[36:39], v[60:63], a[200:207], v1
    v_add_f32 v28, v28, v30
    v_add_f32 v29, v29, v31
    v_smfmac_f32_16x16x64_bf16 v[40:43], v[60:63], v[136:143], v1
    v_add_f32 v32, v32, v34
    v_add_f32 v33, v33, v35
    v_smfmac_f32_16x16x64_bf16 v[36:39], v[64:67], a[208:215], v1
    v_cvt_pk_bf16_f32 v93, v28, v29
    v_smfmac_f32_16x16x64_bf16 v[40:43], v[64:67], v[144:151], v1
    v_cvt_pk_bf16_f32 v95, v32, v33
    v_smfmac_f32_16x16x64_bf16 v[36:39], v[68:71], a[216:223], v1
    v_mov_b32 v92, s4
    v_smfmac_f32_16x16x64_bf16 v[40:43], v[68:71], v[152:159], v1
    buffer_store_dword v92, off, s[40:43], s25 sc1
    v_smfmac_f32_16x16x64_bf16 v[36:39], v[72:75], a[224:231], v1
    ds_read_b128 v[108:111], v3 offset:0
    v_smfmac_f32_16x16x64_bf16 v[40:43], v[72:75], v[160:167], v1
    v_smfmac_f32_16x16x64_bf16 v[36:39], v[76:79], a[232:239], v1
    ds_read_b128 v[104:107], v3 offset:4096
    v_smfmac_f32_16x16x64_bf16 v[40:43], v[76:79], v[168:175], v1
    v_smfmac_f32_16x16x64_bf16 v[36:39], v[80:83], a[160:167], v1
    ds_read_b128 v[96:99], v3 offset:1024
    v_smfmac_f32_16x16x64_bf16 v[40:43], v[80:83], a[240:247], v1
    v_smfmac_f32_16x16x64_bf16 v[36:39], v[84:87], a[168:175], v1
    ds_read_b128 v[100:103], v3 offset:5120
    v_smfmac_f32_16x16x64_bf16 v[40:43], v[84:87], a[248:255], v1
    v_smfmac_f32_16x16x64_bf16 v[44:47], v[48:51], v[192:199], v1
    v_smfmac_f32_16x16x64_bf16 v[44:47], v[52:55], v[200:207], v1
    v_add_f32 v36, v36, v38
    v_add_f32 v37, v37, v39
    v_add_f32 v40, v40, v42
    v_add_f32 v41, v41, v43
    v_cvt_pk_bf16_f32 v92, v36, v37
    v_cvt_pk_bf16_f32 v94, v40, v41
    ds_write_b64 v4, v[92:93]
    ds_write_b64 v4, v[94:95] offset:640
    v_smfmac_f32_16x16x64_bf16 v[44:47], v[56:59], v[208:215], v1
    v_smfmac_f32_16x16x64_bf16 v[44:47], v[60:63], v[216:223], v1
    v_smfmac_f32_16x16x64_bf16 v[44:47], v[64:67], v[224:231], v1
    s_waitcnt lgkmcnt(0)
    s_barrier
    ds_read_b64_tr_b16 v[48:49], v5 offset:0
    ds_read_b64_tr_b16 v[50:51], v5 offset:320
    v_smfmac_f32_16x16x64_bf16 v[44:47], v[68:71], v[232:239], v1
    ds_read_b64_tr_b16 v[52:53], v5 offset:1280
    v_smfmac_f32_16x16x64_bf16 v[44:47], v[72:75], v[240:247], v1
    ds_read_b64_tr_b16 v[54:55], v5 offset:1600
    v_smfmac_f32_16x16x64_bf16 v[44:47], v[76:79], v[248:255], v1
    ds_read_b64_tr_b16 v[56:57], v5 offset:2560
    v_smfmac_f32_16x16x64_bf16 v[44:47], v[80:83], v[176:183], v1
    ds_read_b64_tr_b16 v[58:59], v5 offset:2880
    v_smfmac_f32_16x16x64_bf16 v[44:47], v[84:87], v[184:191], v1
    ds_read_b64_tr_b16 v[60:61], v5 offset:3840
    s_branch PsafeE_55
PsafeW2_53:
    s_cmp_eq_u32 s34, 3
    s_cbranch_scc1 PsafeW3_54
    v_cvt_pk_bf16_f32 v48, v88, v89
    v_cvt_pk_bf16_f32 v49, v90, v91
    v_cvt_pk_bf16_f32 v50, v92, v93
    v_cvt_pk_bf16_f32 v51, v94, v95
    ds_write_b128 v110, v[48:51] offset:0
    v_cvt_pk_bf16_f32 v52, v96, v97
    v_cvt_pk_bf16_f32 v53, v98, v99
    v_cvt_pk_bf16_f32 v54, v100, v101
    v_cvt_pk_bf16_f32 v55, v102, v103
    v_smfmac_f32_16x16x64_bf16 v[28:31], v[48:51], a[32:39], v1
    ds_write_b128 v110, v[52:55] offset:1024
    v_cvt_pk_bf16_f32 v56, v104, v105
    v_cvt_pk_bf16_f32 v57, v106, v107
    v_smfmac_f32_16x16x64_bf16 v[32:35], v[48:51], a[112:119], v1
    ds_write_b64 v111, v[56:57] offset:0
    v_smfmac_f32_16x16x64_bf16 v[28:31], v[52:55], a[40:47], v1
    v_mov_b64 v[100:101], -1
    v_mov_b64 v[102:103], -1
    v_smfmac_f32_16x16x64_bf16 v[32:35], v[52:55], a[120:127], v1
    s_waitcnt lgkmcnt(0)
    s_barrier
    ds_read_b128 v[56:59], v2 offset:6144
    ds_read_b128 v[60:63], v2 offset:7168
    v_smfmac_f32_16x16x64_bf16 v[36:39], v[48:51], a[192:199], v1
    ds_read_b128 v[64:67], v2 offset:8192
    s_mov_b32 m0, s52
    v_smfmac_f32_16x16x64_bf16 v[40:43], v[48:51], v[128:135], v1
    ds_read_b128 v[68:71], v2 offset:9216
    buffer_load_dwordx4 v2, s[40:43], s21 offen sc1 lds
    v_smfmac_f32_16x16x64_bf16 v[36:39], v[52:55], a[200:207], v1
    ds_read_b128 v[72:75], v2 offset:0
    v_smfmac_f32_16x16x64_bf16 v[40:43], v[52:55], v[136:143], v1
    ds_read_b128 v[76:79], v2 offset:1024
    s_waitcnt lgkmcnt(5)
    v_smfmac_f32_16x16x64_bf16 v[28:31], v[56:59], a[48:55], v1
    ds_read_b128 v[80:83], v2 offset:2048
    buffer_load_dwordx4 v2, s[40:43], s21 offen offset:1024 sc1 lds
    v_smfmac_f32_16x16x64_bf16 v[32:35], v[56:59], a[128:135], v1
    ds_read_b128 v[84:87], v2 offset:3072
    s_waitcnt lgkmcnt(6)
    v_smfmac_f32_16x16x64_bf16 v[28:31], v[60:63], a[56:63], v1
    s_mov_b32 m0, s53
    v_smfmac_f32_16x16x64_bf16 v[32:35], v[60:63], a[136:143], v1
    s_waitcnt lgkmcnt(5)
    buffer_load_dwordx4 v2, s[40:43], s22 offen sc1 lds
    v_smfmac_f32_16x16x64_bf16 v[28:31], v[64:67], a[64:71], v1
    v_smfmac_f32_16x16x64_bf16 v[32:35], v[64:67], a[144:151], v1
    s_waitcnt lgkmcnt(4)
    buffer_store_dwordx4 v[100:103], v2, s[40:43], s50 offen sc1
    v_smfmac_f32_16x16x64_bf16 v[28:31], v[68:71], a[72:79], v1
    v_smfmac_f32_16x16x64_bf16 v[32:35], v[68:71], a[152:159], v1
    s_waitcnt lgkmcnt(3)
    v_smfmac_f32_16x16x64_bf16 v[28:31], v[72:75], a[0:7], v1
    buffer_store_dwordx4 v[100:103], v2, s[40:43], s50 offen offset:1024 sc1
    v_smfmac_f32_16x16x64_bf16 v[32:35], v[72:75], a[80:87], v1
    s_waitcnt lgkmcnt(2)
    v_smfmac_f32_16x16x64_bf16 v[28:31], v[76:79], a[8:15], v1
    v_smfmac_f32_16x16x64_bf16 v[32:35], v[76:79], a[88:95], v1
    s_waitcnt lgkmcnt(0)
    buffer_store_dwordx4 v[100:103], v2, s[40:43], s51 offen sc1
    v_smfmac_f32_16x16x64_bf16 v[28:31], v[80:83], a[16:23], v1
    v_smfmac_f32_16x16x64_bf16 v[32:35], v[80:83], a[96:103], v1
    v_smfmac_f32_16x16x64_bf16 v[28:31], v[84:87], a[24:31], v1
    buffer_store_dword v100, v8, s[40:43], s49 offen sc1
    v_smfmac_f32_16x16x64_bf16 v[32:35], v[84:87], a[104:111], v1
    v_smfmac_f32_16x16x64_bf16 v[36:39], v[56:59], a[208:215], v1
    buffer_store_dword v100, v8, s[40:43], s48 offen sc1
    v_smfmac_f32_16x16x64_bf16 v[40:43], v[56:59], v[144:151], v1
    v_smfmac_f32_16x16x64_bf16 v[36:39], v[60:63], a[216:223], v1
    v_add_f32 v28, v28, v30
    v_add_f32 v29, v29, v31
    v_smfmac_f32_16x16x64_bf16 v[40:43], v[60:63], v[152:159], v1
    v_add_f32 v32, v32, v34
    v_add_f32 v33, v33, v35
    v_smfmac_f32_16x16x64_bf16 v[36:39], v[64:67], a[224:231], v1
    v_cvt_pk_bf16_f32 v93, v28, v29
    v_smfmac_f32_16x16x64_bf16 v[40:43], v[64:67], v[160:167], v1
    v_cvt_pk_bf16_f32 v95, v32, v33
    v_smfmac_f32_16x16x64_bf16 v[36:39], v[68:71], a[232:239], v1
    v_mov_b32 v92, s4
    v_smfmac_f32_16x16x64_bf16 v[40:43], v[68:71], v[168:175], v1
    buffer_store_dword v92, off, s[40:43], s25 sc1
    v_smfmac_f32_16x16x64_bf16 v[36:39], v[72:75], a[160:167], v1
    ds_read_b128 v[108:111], v3 offset:0
    v_smfmac_f32_16x16x64_bf16 v[40:43], v[72:75], a[240:247], v1
    v_smfmac_f32_16x16x64_bf16 v[36:39], v[76:79], a[168:175], v1
    ds_read_b128 v[104:107], v3 offset:4096
    v_smfmac_f32_16x16x64_bf16 v[40:43], v[76:79], a[248:255], v1
    v_smfmac_f32_16x16x64_bf16 v[36:39], v[80:83], a[176:183], v1
    ds_read_b128 v[96:99], v3 offset:1024
    v_smfmac_f32_16x16x64_bf16 v[40:43], v[80:83], v[112:119], v1
    v_smfmac_f32_16x16x64_bf16 v[36:39], v[84:87], a[184:191], v1
    ds_read_b128 v[100:103], v3 offset:5120
    v_smfmac_f32_16x16x64_bf16 v[40:43], v[84:87], v[120:127], v1
    v_smfmac_f32_16x16x64_bf16 v[44:47], v[48:51], v[208:215], v1
    v_smfmac_f32_16x16x64_bf16 v[44:47], v[52:55], v[216:223], v1
    v_add_f32 v36, v36, v38
    v_add_f32 v37, v37, v39
    v_add_f32 v40, v40, v42
    v_add_f32 v41, v41, v43
    v_cvt_pk_bf16_f32 v92, v36, v37
    v_cvt_pk_bf16_f32 v94, v40, v41
    ds_write_b64 v4, v[92:93]
    ds_write_b64 v4, v[94:95] offset:640
    v_smfmac_f32_16x16x64_bf16 v[44:47], v[56:59], v[224:231], v1
    v_smfmac_f32_16x16x64_bf16 v[44:47], v[60:63], v[232:239], v1
    v_smfmac_f32_16x16x64_bf16 v[44:47], v[64:67], v[240:247], v1
    s_waitcnt lgkmcnt(0)
    s_barrier
    ds_read_b64_tr_b16 v[48:49], v5 offset:0
    ds_read_b64_tr_b16 v[50:51], v5 offset:320
    v_smfmac_f32_16x16x64_bf16 v[44:47], v[68:71], v[248:255], v1
    ds_read_b64_tr_b16 v[52:53], v5 offset:1280
    v_smfmac_f32_16x16x64_bf16 v[44:47], v[72:75], v[176:183], v1
    ds_read_b64_tr_b16 v[54:55], v5 offset:1600
    v_smfmac_f32_16x16x64_bf16 v[44:47], v[76:79], v[184:191], v1
    ds_read_b64_tr_b16 v[56:57], v5 offset:2560
    v_smfmac_f32_16x16x64_bf16 v[44:47], v[80:83], v[192:199], v1
    ds_read_b64_tr_b16 v[58:59], v5 offset:2880
    v_smfmac_f32_16x16x64_bf16 v[44:47], v[84:87], v[200:207], v1
    ds_read_b64_tr_b16 v[60:61], v5 offset:3840
    s_branch PsafeE_55
PsafeW3_54:
    v_cvt_pk_bf16_f32 v48, v88, v89
    v_cvt_pk_bf16_f32 v49, v90, v91
    v_cvt_pk_bf16_f32 v50, v92, v93
    v_cvt_pk_bf16_f32 v51, v94, v95
    ds_write_b128 v110, v[48:51] offset:0
    v_cvt_pk_bf16_f32 v52, v96, v97
    v_cvt_pk_bf16_f32 v53, v98, v99
    v_cvt_pk_bf16_f32 v54, v100, v101
    v_cvt_pk_bf16_f32 v55, v102, v103
    v_smfmac_f32_16x16x64_bf16 v[28:31], v[48:51], a[48:55], v1
    ds_write_b128 v110, v[52:55] offset:1024
    v_cvt_pk_bf16_f32 v56, v104, v105
    v_cvt_pk_bf16_f32 v57, v106, v107
    v_smfmac_f32_16x16x64_bf16 v[32:35], v[48:51], a[128:135], v1
    ds_write_b64 v111, v[56:57] offset:0
    v_smfmac_f32_16x16x64_bf16 v[28:31], v[52:55], a[56:63], v1
    v_mov_b64 v[100:101], -1
    v_mov_b64 v[102:103], -1
    v_smfmac_f32_16x16x64_bf16 v[32:35], v[52:55], a[136:143], v1
    s_waitcnt lgkmcnt(0)
    s_barrier
    ds_read_b128 v[56:59], v2 offset:8192
    ds_read_b128 v[60:63], v2 offset:9216
    v_smfmac_f32_16x16x64_bf16 v[36:39], v[48:51], a[208:215], v1
    ds_read_b128 v[64:67], v2 offset:0
    s_mov_b32 m0, s52
    v_smfmac_f32_16x16x64_bf16 v[40:43], v[48:51], v[144:151], v1
    ds_read_b128 v[68:71], v2 offset:1024
    buffer_load_dwordx4 v2, s[40:43], s21 offen sc1 lds
    v_smfmac_f32_16x16x64_bf16 v[36:39], v[52:55], a[216:223], v1
    ds_read_b128 v[72:75], v2 offset:2048
    v_smfmac_f32_16x16x64_bf16 v[40:43], v[52:55], v[152:159], v1
    ds_read_b128 v[76:79], v2 offset:3072
    s_waitcnt lgkmcnt(5)
    v_smfmac_f32_16x16x64_bf16 v[28:31], v[56:59], a[64:71], v1
    ds_read_b128 v[80:83], v2 offset:4096
    buffer_load_dwordx4 v2, s[40:43], s21 offen offset:1024 sc1 lds
    v_smfmac_f32_16x16x64_bf16 v[32:35], v[56:59], a[144:151], v1
    ds_read_b128 v[84:87], v2 offset:5120
    s_waitcnt lgkmcnt(6)
    v_smfmac_f32_16x16x64_bf16 v[28:31], v[60:63], a[72:79], v1
    s_mov_b32 m0, s53
    v_smfmac_f32_16x16x64_bf16 v[32:35], v[60:63], a[152:159], v1
    s_waitcnt lgkmcnt(5)
    buffer_load_dwordx4 v2, s[40:43], s22 offen sc1 lds
    v_smfmac_f32_16x16x64_bf16 v[28:31], v[64:67], a[0:7], v1
    v_smfmac_f32_16x16x64_bf16 v[32:35], v[64:67], a[80:87], v1
    s_waitcnt lgkmcnt(4)
    buffer_store_dwordx4 v[100:103], v2, s[40:43], s50 offen sc1
    v_smfmac_f32_16x16x64_bf16 v[28:31], v[68:71], a[8:15], v1
    v_smfmac_f32_16x16x64_bf16 v[32:35], v[68:71], a[88:95], v1
    s_waitcnt lgkmcnt(3)
    v_smfmac_f32_16x16x64_bf16 v[28:31], v[72:75], a[16:23], v1
    buffer_store_dwordx4 v[100:103], v2, s[40:43], s50 offen offset:1024 sc1
    v_smfmac_f32_16x16x64_bf16 v[32:35], v[72:75], a[96:103], v1
    s_waitcnt lgkmcnt(2)
    v_smfmac_f32_16x16x64_bf16 v[28:31], v[76:79], a[24:31], v1
    v_smfmac_f32_16x16x64_bf16 v[32:35], v[76:79], a[104:111], v1
    s_waitcnt lgkmcnt(0)
    buffer_store_dwordx4 v[100:103], v2, s[40:43], s51 offen sc1
    v_smfmac_f32_16x16x64_bf16 v[28:31], v[80:83], a[32:39], v1
    v_smfmac_f32_16x16x64_bf16 v[32:35], v[80:83], a[112:119], v1
    v_smfmac_f32_16x16x64_bf16 v[28:31], v[84:87], a[40:47], v1
    buffer_store_dword v100, v8, s[40:43], s49 offen sc1
    v_smfmac_f32_16x16x64_bf16 v[32:35], v[84:87], a[120:127], v1
    v_smfmac_f32_16x16x64_bf16 v[36:39], v[56:59], a[224:231], v1
    buffer_store_dword v100, v8, s[40:43], s48 offen sc1
    v_smfmac_f32_16x16x64_bf16 v[40:43], v[56:59], v[160:167], v1
    v_smfmac_f32_16x16x64_bf16 v[36:39], v[60:63], a[232:239], v1
    v_add_f32 v28, v28, v30
    v_add_f32 v29, v29, v31
    v_smfmac_f32_16x16x64_bf16 v[40:43], v[60:63], v[168:175], v1
    v_add_f32 v32, v32, v34
    v_add_f32 v33, v33, v35
    v_smfmac_f32_16x16x64_bf16 v[36:39], v[64:67], a[160:167], v1
    v_cvt_pk_bf16_f32 v93, v28, v29
    v_smfmac_f32_16x16x64_bf16 v[40:43], v[64:67], a[240:247], v1
    v_cvt_pk_bf16_f32 v95, v32, v33
    v_smfmac_f32_16x16x64_bf16 v[36:39], v[68:71], a[168:175], v1
    v_mov_b32 v92, s4
    v_smfmac_f32_16x16x64_bf16 v[40:43], v[68:71], a[248:255], v1
    buffer_store_dword v92, off, s[40:43], s25 sc1
    v_smfmac_f32_16x16x64_bf16 v[36:39], v[72:75], a[176:183], v1
    ds_read_b128 v[108:111], v3 offset:0
    v_smfmac_f32_16x16x64_bf16 v[40:43], v[72:75], v[112:119], v1
    v_smfmac_f32_16x16x64_bf16 v[36:39], v[76:79], a[184:191], v1
    ds_read_b128 v[104:107], v3 offset:4096
    v_smfmac_f32_16x16x64_bf16 v[40:43], v[76:79], v[120:127], v1
    v_smfmac_f32_16x16x64_bf16 v[36:39], v[80:83], a[192:199], v1
    ds_read_b128 v[96:99], v3 offset:1024
    v_smfmac_f32_16x16x64_bf16 v[40:43], v[80:83], v[128:135], v1
    v_smfmac_f32_16x16x64_bf16 v[36:39], v[84:87], a[200:207], v1
    ds_read_b128 v[100:103], v3 offset:5120
    v_smfmac_f32_16x16x64_bf16 v[40:43], v[84:87], v[136:143], v1
    v_smfmac_f32_16x16x64_bf16 v[44:47], v[48:51], v[224:231], v1
    v_smfmac_f32_16x16x64_bf16 v[44:47], v[52:55], v[232:239], v1
    v_add_f32 v36, v36, v38
    v_add_f32 v37, v37, v39
    v_add_f32 v40, v40, v42
    v_add_f32 v41, v41, v43
    v_cvt_pk_bf16_f32 v92, v36, v37
    v_cvt_pk_bf16_f32 v94, v40, v41
    ds_write_b64 v4, v[92:93]
    ds_write_b64 v4, v[94:95] offset:640
    v_smfmac_f32_16x16x64_bf16 v[44:47], v[56:59], v[240:247], v1
    v_smfmac_f32_16x16x64_bf16 v[44:47], v[60:63], v[248:255], v1
    v_smfmac_f32_16x16x64_bf16 v[44:47], v[64:67], v[176:183], v1
    s_waitcnt lgkmcnt(0)
    s_barrier
    ds_read_b64_tr_b16 v[48:49], v5 offset:0
    ds_read_b64_tr_b16 v[50:51], v5 offset:320
    v_smfmac_f32_16x16x64_bf16 v[44:47], v[68:71], v[184:191], v1
    ds_read_b64_tr_b16 v[52:53], v5 offset:1280
    v_smfmac_f32_16x16x64_bf16 v[44:47], v[72:75], v[192:199], v1
    ds_read_b64_tr_b16 v[54:55], v5 offset:1600
    v_smfmac_f32_16x16x64_bf16 v[44:47], v[76:79], v[200:207], v1
    ds_read_b64_tr_b16 v[56:57], v5 offset:2560
    v_smfmac_f32_16x16x64_bf16 v[44:47], v[80:83], v[208:215], v1
    ds_read_b64_tr_b16 v[58:59], v5 offset:2880
    v_smfmac_f32_16x16x64_bf16 v[44:47], v[84:87], v[216:223], v1
    ds_read_b64_tr_b16 v[60:61], v5 offset:3840
PsafeE_55:
    s_waitcnt lgkmcnt(5)
    v_mfma_f32_16x16x32_bf16 v[80:83], v[108:111], v[48:51], 0
    ds_read_b64_tr_b16 v[62:63], v5 offset:4160
    ds_read_b128 v[108:111], v3 offset:2048
    v_mfma_f32_16x16x32_bf16 v[84:87], v[104:107], v[48:51], 0
    ds_read_b128 v[104:107], v3 offset:6144
    v_mfma_f32_16x16x32_bf16 v[88:91], v[48:51], v[48:51], 0
    s_waitcnt lgkmcnt(6)
    v_mfma_f32_16x16x32_bf16 v[80:83], v[96:99], v[52:55], v[80:83]
    ds_read_b128 v[96:99], v3 offset:3072
    v_mfma_f32_16x16x32_bf16 v[84:87], v[100:103], v[52:55], v[84:87]
    ds_read_b128 v[100:103], v3 offset:7168
    v_mfma_f32_16x16x32_bf16 v[88:91], v[52:55], v[52:55], v[88:91]
    v_add_f32 v44, v44, v46
    v_add_f32 v45, v45, v47
    v_cvt_pk_bf16_f32 v20, v44, v45
    s_waitcnt lgkmcnt(6)
    s_waitcnt lgkmcnt(3)
    v_mfma_f32_16x16x32_bf16 v[80:83], v[108:111], v[56:59], v[80:83]
    s_waitcnt lgkmcnt(2)
    v_mfma_f32_16x16x32_bf16 v[84:87], v[104:107], v[56:59], v[84:87]
    v_add_u32 v93, s30, v3
    v_mfma_f32_16x16x32_bf16 v[88:91], v[56:59], v[56:59], v[88:91]
    s_waitcnt lgkmcnt(1)
    v_mfma_f32_16x16x32_bf16 v[80:83], v[96:99], v[60:63], v[80:83]
    ds_read_b128 v[96:99], v93
    s_waitcnt lgkmcnt(1)
    v_mfma_f32_16x16x32_bf16 v[84:87], v[100:103], v[60:63], v[84:87]
    ds_read_b64_tr_b16 v[100:101], v9 offset:0
    v_mfma_f32_16x16x32_bf16 v[88:91], v[60:63], v[60:63], v[88:91]
    ds_read_b64_tr_b16 v[102:103], v9 offset:320
    ds_read_b128 v[48:51], v0 offset:0
    ds_read_b128 v[52:55], v0 offset:1024
    ds_read_b128 v[56:59], v0 offset:2048
    ds_read_b128 v[60:63], v0 offset:3072
    v_max3_f32 v104, v80, v81, v82
    v_max3_f32 v105, v84, v85, v86
    v_max3_f32 v104, v104, v83, v87
    v_max3_f32 v105, v105, v88, v89
    v_max_f32 v104, v104, v105
    v_mov_b32 v105, v104
    ds_read_b128 v[64:67], v0 offset:4096
    ds_read_b128 v[68:71], v0 offset:5120
    v_permlane16_swap_b32 v104, v105
    v_max_f32 v104, v104, v105
    v_mov_b32 v105, v104
    ds_read_b128 v[72:75], v0 offset:6144
    ds_read_b128 v[76:79], v0 offset:7168
    v_permlane32_swap_b32 v104, v105
    v_max_f32 v104, v104, v105
    v_mul_f32 v104, s10, v104
    v_pk_fma_f32 v[80:81], v[80:81], s[8:9], v[104:105] op_sel_hi:[1,1,0]
    v_pk_fma_f32 v[82:83], v[82:83], s[8:9], v[104:105] op_sel_hi:[1,1,0]
    v_pk_fma_f32 v[84:85], v[84:85], s[8:9], v[104:105] op_sel_hi:[1,1,0]
    v_pk_fma_f32 v[86:87], v[86:87], s[8:9], v[104:105] op_sel_hi:[1,1,0]
    v_pk_fma_f32 v[88:89], v[88:89], s[8:9], v[104:105] op_sel_hi:[1,1,0]
    v_exp_f32 v80, v80
    v_exp_f32 v81, v81
    v_exp_f32 v82, v82
    v_exp_f32 v83, v83
    v_exp_f32 v84, v84
    v_exp_f32 v85, v85
    v_exp_f32 v86, v86
    v_exp_f32 v87, v87
    v_cvt_pk_bf16_f32 v28, v80, v81
    v_cvt_pk_bf16_f32 v29, v82, v83
    v_cvt_pk_bf16_f32 v30, v84, v85
    v_exp_f32 v88, v88
    v_cvt_pk_bf16_f32 v31, v86, v87
    v_exp_f32 v89, v89
    s_waitcnt lgkmcnt(10)
    v_mfma_f32_16x16x32_bf16 v[36:39], v[16:19], v[28:31], 0
    v_cvt_pk_bf16_f32 v24, v88, v89
    v_mfma_f32_16x16x32_bf16 v[32:35], v[96:99], v[28:31], 0
    ds_read_b128 v[80:83], v0 offset:8192
    v_mfma_f32_16x16x32_bf16 v[36:39], v[16:19], v[24:27], v[36:39]
    ds_read_b128 v[84:87], v0 offset:9216
    v_mfma_f32_16x16x32_bf16 v[32:35], v[20:23], v[24:27], v[32:35]
    v_mov_b64 v[88:89], 0
    v_mov_b64 v[90:91], 0
    v_mov_b64 v[92:93], 0
    v_rcp_f32 v106, v36
    v_mov_b64 v[94:95], 0
    v_mov_b64 v[96:97], 0
    v_mov_b64 v[98:99], 0
    s_nop 0
    v_pk_mul_f32 v[32:33], v[32:33], v[106:107] op_sel_hi:[1,0]
    v_pk_mul_f32 v[34:35], v[34:35], v[106:107] op_sel_hi:[1,0]
    v_cvt_pk_bf16_f32 v104, v32, v33
    v_cvt_pk_bf16_f32 v105, v34, v35
    ds_write_b64 v6, v[104:105]
    v_bfe_u32 v24, v2, 7, 1
    v_lshlrev_b32 v24, 5, v24
    v_xor_b32 v24, v24, v2
    v_mov_b64 v[28:29], 0
    v_mov_b64 v[30:31], 0
    v_mov_b64 v[32:33], 0
    v_mov_b64 v[34:35], 0
    v_mov_b64 v[36:37], 0
    v_mov_b64 v[38:39], 0
    v_mov_b64 v[40:41], 0
    v_mov_b64 v[42:43], 0
    v_mov_b64 v[44:45], 0
    v_mov_b64 v[46:47], 0
    s_waitcnt lgkmcnt(0)
    s_barrier
    ds_read_b128 v[104:107], v24 offset:15360
    v_lshrrev_b32 v108, 2, v2
    buffer_store_dwordx4 v[100:103], v2, s[40:43], s23 offen sc1
    buffer_store_dword v20, v108, s[40:43], s24 offen sc1
    s_add_u32 s72, s11, s14
    v_mov_b64 v[108:109], 0
    v_mov_b64 v[110:111], 0
    v_mov_b64 v[100:101], 0
    v_mov_b64 v[102:103], 0
    s_waitcnt lgkmcnt(0)
    v_smfmac_f32_16x16x64_bf16 v[28:31], v[104:107], v[48:55], v1
    ds_read_b128 v[48:51], v0 offset:10240
    ds_read_b128 v[52:55], v0 offset:11264
    v_smfmac_f32_16x16x64_bf16 v[32:35], v[104:107], v[56:63], v1
    ds_read_b128 v[56:59], v0 offset:12288
    ds_read_b128 v[60:63], v0 offset:13312
    v_smfmac_f32_16x16x64_bf16 v[36:39], v[104:107], v[64:71], v1
    ds_read_b128 v[64:67], v0 offset:14336
    ds_read_b128 v[68:71], v0 offset:15360
    v_add_f32 v28, v28, v30
    v_add_f32 v29, v29, v31
    v_smfmac_f32_16x16x64_bf16 v[40:43], v[104:107], v[72:79], v1
    ds_read_b128 v[72:75], v0 offset:16384
    ds_read_b128 v[76:79], v0 offset:17408
    v_add_f32 v32, v32, v34
    v_add_f32 v33, v33, v35
    v_cvt_pk_bf16_f32 v28, v28, v29
    v_smfmac_f32_16x16x64_bf16 v[44:47], v[104:107], v[80:87], v1
    ds_read_b128 v[80:83], v0 offset:18432
    ds_read_b128 v[84:87], v0 offset:19456
    v_add_f32 v36, v36, v38
    v_add_f32 v37, v37, v39
    v_cvt_pk_bf16_f32 v29, v32, v33
    buffer_store_dwordx2 v[28:29], v7, s[40:43], s72 offen sc1
    s_add_u32 s72, s72, 0x10000
    s_waitcnt lgkmcnt(8)
    v_smfmac_f32_16x16x64_bf16 v[88:91], v[104:107], v[48:55], v1
    v_add_f32 v40, v40, v42
    v_add_f32 v41, v41, v43
    v_cvt_pk_bf16_f32 v30, v36, v37
    s_waitcnt lgkmcnt(6)
    v_smfmac_f32_16x16x64_bf16 v[92:95], v[104:107], v[56:63], v1
    v_add_f32 v44, v44, v46
    v_add_f32 v45, v45, v47
    v_cvt_pk_bf16_f32 v31, v40, v41
    buffer_store_dwordx2 v[30:31], v7, s[40:43], s72 offen sc1
    s_add_u32 s72, s72, 0x10000
    s_waitcnt lgkmcnt(4)
    v_smfmac_f32_16x16x64_bf16 v[96:99], v[104:107], v[64:71], v1
    v_add_f32 v88, v88, v90
    v_add_f32 v89, v89, v91
    v_cvt_pk_bf16_f32 v32, v44, v45
    s_waitcnt lgkmcnt(2)
    v_smfmac_f32_16x16x64_bf16 v[100:103], v[104:107], v[72:79], v1
    v_add_f32 v92, v92, v94
    v_add_f32 v93, v93, v95
    v_cvt_pk_bf16_f32 v33, v88, v89
    buffer_store_dwordx2 v[32:33], v7, s[40:43], s72 offen sc1
    s_add_u32 s72, s72, 0x10000
    s_waitcnt lgkmcnt(0)
    v_smfmac_f32_16x16x64_bf16 v[108:111], v[104:107], v[80:87], v1
    v_add_f32 v96, v96, v98
    v_add_f32 v97, v97, v99
    v_cvt_pk_bf16_f32 v34, v92, v93
    v_add_f32 v100, v100, v102
    v_add_f32 v101, v101, v103
    v_cvt_pk_bf16_f32 v35, v96, v97
    buffer_store_dwordx2 v[34:35], v7, s[40:43], s72 offen sc1
    s_add_u32 s72, s72, 0x10000
    v_add_f32 v108, v108, v110
    v_add_f32 v109, v109, v111
    v_cvt_pk_bf16_f32 v36, v100, v101
    v_cvt_pk_bf16_f32 v37, v108, v109
    buffer_store_dwordx2 v[36:37], v7, s[40:43], s72 offen sc1
    s_cmp_lg_u32 s54, 0
    s_cbranch_scc1 CLS_57
    s_mov_b32 s38, 262144
PL_58:
    buffer_load_dword v108, off, s[44:47], 0 offset:8 sc1
    s_waitcnt vmcnt(0)
    v_cmp_eq_u32 vcc, 0, v108
    s_cbranch_vccnz PN_59
    s_branch PO_60
PN_59:
    s_sub_u32 s38, s38, 1
    s_cbranch_scc0 PL_58
    s_mov_b32 s68, 10
    s_branch FAIL
PO_60:
    v_readfirstlane_b32 s54, v108
    s_cmp_eq_u32 s54, 2
    s_cselect_b32 s69, 0x2000, 0
    s_add_u32 s17, s17, s69
    s_add_u32 s19, s19, s69
    s_add_u32 s29, s29, s69
CLS_57:
    s_add_u32 s55, s13, s14
    s_add_u32 s64, s17, s15
    s_add_u32 s62, s19, s15
    s_add_u32 s63, s29, s15
    s_lshr_b32 s73, s15, 1
    s_add_u32 s65, s73, s18
    s_add_u32 s60, s73, s20
    s_add_u32 s61, s73, s12
    s_add_u32 s69, s15, 0x20000
    s_and_b32 s69, s69, 0x30000
    s_add_u32 s48, s69, s17
    s_lshr_b32 s69, s69, 1
    s_add_u32 s49, s69, s18
    s_cmp_eq_u32 s16, 0
    s_cselect_b32 s48, 0x40000000, s48
    s_cselect_b32 s49, 0x40000000, s49
    s_add_u32 s50, s14, s7
    s_add_u32 s51, s14, s31
    s_add_u32 s23, s23, 0x20000
    s_add_u32 s24, s24, 0x10000
    s_add_u32 s21, s21, 0x40000
    s_add_u32 s22, s22, 0x40000
    s_xor_b32 s28, s28, 0xc000
    v_xor_b32 v3, 0xc000, v3
    s_xor_b32 s14, s14, 0x50000
    s_add_u32 s15, s15, 0x10000
    s_and_b32 s15, s15, 0x30000
    s_add_u32 s4, s4, 1
    s_lshl_b32 s69, s34, 11
    s_add_u32 s52, s69, s28
    s_add_u32 s53, s30, s28
    s_mov_b32 s38, 262144
    v_lshrrev_b32 v109, 1, v2
    v_add_u32 v110, s32, v2
    v_add_u32 v111, s39, v109
    v_mov_b32 v24, s4
    s_cmp_ge_u32 s4, 60
    s_cselect_b32 s67, s25, 0x40000000
    s_cmp_gt_u32 s4, 62
    s_cselect_b32 s67, 0x40000000, s67
    v_mov_b64 v[28:29], 0
    v_mov_b64 v[30:31], 0
    v_mov_b64 v[32:33], 0
    v_mov_b64 v[34:35], 0
    v_mov_b64 v[36:37], 0
    v_mov_b64 v[38:39], 0
    v_mov_b64 v[40:41], 0
    v_mov_b64 v[42:43], 0
    v_mov_b64 v[44:45], 0
    v_mov_b64 v[46:47], 0
    s_waitcnt vmcnt(1)
    s_cmp_eq_u32 s16, 0
    s_cbranch_scc1 NRED_56
H1RT_62:
    buffer_load_dwordx4 v[48:51], v2, s[40:43], s55 offen offset:0 sc1
    buffer_load_dwordx4 v[52:55], v2, s[40:43], s55 offen offset:1024 sc1
    buffer_load_dwordx4 v[56:59], v2, s[40:43], s55 offen offset:2048 sc1
    buffer_load_dwordx4 v[60:63], v2, s[40:43], s55 offen offset:3072 sc1
    s_waitcnt vmcnt(3)
    v_mfma_f32_16x16x32_bf16 v[64:67], v[48:51], v[10:13], 0
    v_max3_u32 v68, v48, v49, v50
    v_max_u32 v68, v68, v51
    s_waitcnt vmcnt(2)
    v_mfma_f32_16x16x32_bf16 v[64:67], v[52:55], v[10:13], v[64:67]
    v_max3_u32 v68, v68, v52, v53
    v_max3_u32 v68, v68, v54, v55
    s_waitcnt vmcnt(1)
    v_mfma_f32_16x16x32_bf16 v[64:67], v[56:59], v[10:13], v[64:67]
    v_max3_u32 v68, v68, v56, v57
    v_max3_u32 v68, v68, v58, v59
    s_waitcnt vmcnt(0)
    v_mfma_f32_16x16x32_bf16 v[64:67], v[60:63], v[10:13], v[64:67]
    v_max3_u32 v68, v68, v60, v61
    v_max3_u32 v68, v68, v62, v63
    v_cmp_eq_u32 vcc, -1, v68
    s_cbranch_vccz H1GO_63
    s_sub_u32 s38, s38, 1
    s_cbranch_scc0 H1RT_62
    s_mov_b32 s68, 12
    s_branch FAIL
H1GO_63:
    s_nop 3
    v_permlane32_swap_b32 v64, v66
    v_permlane32_swap_b32 v65, v67
    v_add_f32 v64, v64, v66
    v_add_f32 v65, v65, v67
    v_cvt_pk_bf16_f32 v69, v64, v65
    buffer_store_dword v69, v8, s[40:43], s65 offen sc1
    buffer_store_dword v69, v8, s[40:43], s64 offen sc1
    s_waitcnt vmcnt(1)
    s_branch K3_64
NRED_56:
    s_cmp_lg_u32 s34, 3
    s_cbranch_scc1 K3_64
    s_add_u32 s69, s4, 2
    s_min_u32 s69, s69, 64
    s_cmp_ge_u32 s27, s69
    s_cbranch_scc1 KVOK_65
    s_sleep 3
    s_mov_b32 s38, 262144
PL_66:
    buffer_load_dwordx2 v[48:49], off, s[40:43], s26 sc1
    s_waitcnt vmcnt(0)
    v_min_u32 v48, v48, v49
    s_nop 0
    v_readfirstlane_b32 s27, v48
    s_cmp_lt_u32 s27, s69
    s_cbranch_scc1 PN_67
    s_branch PO_68
PN_67:
    s_sub_u32 s38, s38, 1
    s_cbranch_scc0 PL_66
    s_mov_b32 s68, 11
    s_branch FAIL
PO_68:
KVOK_65:
    s_mov_b32 s38, 262144
K3_64:
    s_barrier
    buffer_load_dwordx4 v[48:51], v2, s[40:43], s60 offen sc1
    buffer_load_dwordx4 v[52:55], v2, s[40:43], s60 offen offset:1024 sc1
    buffer_load_dwordx2 v[56:57], v109, s[40:43], s61 offen sc1
    s_waitcnt vmcnt(2)
    buffer_load_dwordx4 v[58:61], v2, s[40:43], s62 offen sc1
    buffer_load_dwordx4 v[62:65], v2, s[40:43], s62 offen offset:1024 sc1
    buffer_load_dwordx2 v[66:67], v109, s[40:43], s63 offen sc1
    buffer_store_dword v24, off, s[40:43], s67 sc1
    s_waitcnt vmcnt(4)
    v_mfma_f32_16x16x16_bf16 v[68:71], v[14:15], v[48:49], 0
    v_max3_u32 v108, v48, v49, v50
    v_mfma_f32_16x16x16_bf16 v[72:75], v[14:15], v[50:51], 0
    v_max3_u32 v108, v108, v51, v52
    v_mfma_f32_16x16x16_bf16 v[76:79], v[14:15], v[52:53], 0
    v_max3_u32 v108, v108, v53, v54
    v_mfma_f32_16x16x16_bf16 v[80:83], v[14:15], v[54:55], 0
    v_max3_u32 v108, v108, v55, v56
    v_mfma_f32_16x16x16_bf16 v[84:87], v[14:15], v[56:57], 0
    v_max_u32 v108, v108, v57
    v_cmp_eq_u32 vcc, -1, v108
    s_cbranch_vccnz XLRT_69
    s_waitcnt vmcnt(1)
    v_mfma_f32_16x16x16_bf16 v[88:91], v[14:15], v[58:59], v[68:71]
    v_max3_u32 v108, v58, v59, v60
    v_mfma_f32_16x16x16_bf16 v[92:95], v[14:15], v[60:61], v[72:75]
    v_max3_u32 v108, v108, v61, v62
    v_mfma_f32_16x16x16_bf16 v[96:99], v[14:15], v[62:63], v[76:79]
    v_max3_u32 v108, v108, v63, v64
    v_mfma_f32_16x16x16_bf16 v[100:103], v[14:15], v[64:65], v[80:83]
    v_max3_u32 v108, v108, v65, v66
    v_mfma_f32_16x16x16_bf16 v[104:107], v[14:15], v[66:67], v[84:87]
    v_max_u32 v108, v108, v67
    v_cmp_eq_u32 vcc, -1, v108
    s_cbranch_vccz XRGO_72
    s_branch XRRT_70
XLRT_69:
    buffer_load_dwordx4 v[48:51], v2, s[40:43], s60 offen sc1
    buffer_load_dwordx4 v[52:55], v2, s[40:43], s60 offen offset:1024 sc1
    buffer_load_dwordx2 v[56:57], v109, s[40:43], s61 offen sc1
    s_waitcnt vmcnt(0)
    v_mfma_f32_16x16x16_bf16 v[68:71], v[14:15], v[48:49], 0
    v_max3_u32 v108, v48, v49, v50
    v_mfma_f32_16x16x16_bf16 v[72:75], v[14:15], v[50:51], 0
    v_max3_u32 v108, v108, v51, v52
    v_mfma_f32_16x16x16_bf16 v[76:79], v[14:15], v[52:53], 0
    v_max3_u32 v108, v108, v53, v54
    v_mfma_f32_16x16x16_bf16 v[80:83], v[14:15], v[54:55], 0
    v_max3_u32 v108, v108, v55, v56
    v_mfma_f32_16x16x16_bf16 v[84:87], v[14:15], v[56:57], 0
    v_max_u32 v108, v108, v57
    v_cmp_eq_u32 vcc, -1, v108
    s_cbranch_vccz XRCK_71
    s_sub_u32 s38, s38, 1
    s_cbranch_scc0 XLRT_69
    s_mov_b32 s68, 13
    s_branch FAIL
XRRT_70:
    buffer_load_dwordx4 v[58:61], v2, s[40:43], s62 offen sc1
    buffer_load_dwordx4 v[62:65], v2, s[40:43], s62 offen offset:1024 sc1
    buffer_load_dwordx2 v[66:67], v109, s[40:43], s63 offen sc1
XRCK_71:
    s_waitcnt vmcnt(0)
    v_mfma_f32_16x16x16_bf16 v[88:91], v[14:15], v[58:59], v[68:71]
    v_max3_u32 v108, v58, v59, v60
    v_mfma_f32_16x16x16_bf16 v[92:95], v[14:15], v[60:61], v[72:75]
    v_max3_u32 v108, v108, v61, v62
    v_mfma_f32_16x16x16_bf16 v[96:99], v[14:15], v[62:63], v[76:79]
    v_max3_u32 v108, v108, v63, v64
    v_mfma_f32_16x16x16_bf16 v[100:103], v[14:15], v[64:65], v[80:83]
    v_max3_u32 v108, v108, v65, v66
    v_mfma_f32_16x16x16_bf16 v[104:107], v[14:15], v[66:67], v[84:87]
    v_max_u32 v108, v108, v67
    v_cmp_eq_u32 vcc, -1, v108
    s_cbranch_vccz XRGO_72
    s_sub_u32 s38, s38, 1
    s_cbranch_scc0 XRRT_70
    s_mov_b32 s68, 14
    s_branch FAIL
XRGO_72:
DRY_61:
    s_cmp_lt_u32 s4, 63
    s_cbranch_scc1 CH_LOOP_safe
    s_cmp_ge_u32 s34, 2
    s_cbranch_scc1 ZsafeW2_75
    s_cmp_eq_u32 s34, 1
    s_cbranch_scc1 ZsafeW1_74
ZsafeW0_73:
    v_cvt_pk_bf16_f32 v48, v88, v89
    v_cvt_pk_bf16_f32 v49, v90, v91
    v_cvt_pk_bf16_f32 v50, v92, v93
    v_cvt_pk_bf16_f32 v51, v94, v95
    ds_write_b128 v110, v[48:51] offset:0
    v_cvt_pk_bf16_f32 v52, v96, v97
    v_cvt_pk_bf16_f32 v53, v98, v99
    v_cvt_pk_bf16_f32 v54, v100, v101
    v_cvt_pk_bf16_f32 v55, v102, v103
    v_smfmac_f32_16x16x64_bf16 v[36:39], v[48:51], a[160:167], v1
    ds_write_b128 v110, v[52:55] offset:1024
    v_cvt_pk_bf16_f32 v56, v104, v105
    v_cvt_pk_bf16_f32 v57, v106, v107
    v_smfmac_f32_16x16x64_bf16 v[40:43], v[48:51], a[240:247], v1
    ds_write_b64 v111, v[56:57] offset:0
    v_smfmac_f32_16x16x64_bf16 v[36:39], v[52:55], a[168:175], v1
    v_smfmac_f32_16x16x64_bf16 v[40:43], v[52:55], a[248:255], v1
    s_waitcnt lgkmcnt(0)
    s_barrier
    ds_read_b128 v[56:59], v2 offset:2048
    ds_read_b128 v[60:63], v2 offset:3072
    s_waitcnt lgkmcnt(1)
    v_smfmac_f32_16x16x64_bf16 v[36:39], v[56:59], a[176:183], v1
    ds_read_b128 v[64:67], v2 offset:4096
    v_smfmac_f32_16x16x64_bf16 v[40:43], v[56:59], v[112:119], v1
    ds_read_b128 v[68:71], v2 offset:5120
    s_waitcnt lgkmcnt(2)
    v_smfmac_f32_16x16x64_bf16 v[36:39], v[60:63], a[184:191], v1
    ds_read_b128 v[72:75], v2 offset:6144
    v_smfmac_f32_16x16x64_bf16 v[40:43], v[60:63], v[120:127], v1
    ds_read_b128 v[76:79], v2 offset:7168
    s_waitcnt lgkmcnt(3)
    v_smfmac_f32_16x16x64_bf16 v[36:39], v[64:67], a[192:199], v1
    ds_read_b128 v[80:83], v2 offset:8192
    v_smfmac_f32_16x16x64_bf16 v[40:43], v[64:67], v[128:135], v1
    ds_read_b128 v[84:87], v2 offset:9216
    s_waitcnt lgkmcnt(4)
    v_smfmac_f32_16x16x64_bf16 v[36:39], v[68:71], a[200:207], v1
    v_smfmac_f32_16x16x64_bf16 v[40:43], v[68:71], v[136:143], v1
    s_waitcnt lgkmcnt(3)
    v_smfmac_f32_16x16x64_bf16 v[36:39], v[72:75], a[208:215], v1
    v_smfmac_f32_16x16x64_bf16 v[40:43], v[72:75], v[144:151], v1
    s_waitcnt lgkmcnt(2)
    v_smfmac_f32_16x16x64_bf16 v[36:39], v[76:79], a[216:223], v1
    v_smfmac_f32_16x16x64_bf16 v[40:43], v[76:79], v[152:159], v1
    s_waitcnt lgkmcnt(0)
    v_smfmac_f32_16x16x64_bf16 v[36:39], v[80:83], a[224:231], v1
    v_smfmac_f32_16x16x64_bf16 v[40:43], v[80:83], v[160:167], v1
    v_smfmac_f32_16x16x64_bf16 v[36:39], v[84:87], a[232:239], v1
    v_smfmac_f32_16x16x64_bf16 v[40:43], v[84:87], v[168:175], v1
    v_smfmac_f32_16x16x64_bf16 v[44:47], v[48:51], v[176:183], v1
    v_smfmac_f32_16x16x64_bf16 v[44:47], v[52:55], v[184:191], v1
    v_add_f32 v36, v36, v38
    v_add_f32 v37, v37, v39
    v_add_f32 v40, v40, v42
    v_add_f32 v41, v41, v43
    v_cvt_pk_bf16_f32 v92, v36, v37
    v_cvt_pk_bf16_f32 v94, v40, v41
    ds_write_b64 v4, v[92:93]
    ds_write_b64 v4, v[94:95] offset:640
    v_smfmac_f32_16x16x64_bf16 v[44:47], v[56:59], v[192:199], v1
    v_smfmac_f32_16x16x64_bf16 v[44:47], v[60:63], v[200:207], v1
    v_smfmac_f32_16x16x64_bf16 v[44:47], v[64:67], v[208:215], v1
    s_waitcnt lgkmcnt(0)
    s_barrier
    v_mov_b32 v104, 63
    buffer_store_dword v104, off, s[40:43], s25 sc1
    ds_read_b64_tr_b16 v[100:101], v9 offset:0
    ds_read_b64_tr_b16 v[102:103], v9 offset:320
    v_smfmac_f32_16x16x64_bf16 v[44:47], v[68:71], v[216:223], v1
    v_smfmac_f32_16x16x64_bf16 v[44:47], v[72:75], v[224:231], v1
    v_smfmac_f32_16x16x64_bf16 v[44:47], v[76:79], v[232:239], v1
    v_smfmac_f32_16x16x64_bf16 v[44:47], v[80:83], v[240:247], v1
    v_smfmac_f32_16x16x64_bf16 v[44:47], v[84:87], v[248:255], v1
    s_branch ZsafeE_77
ZsafeW1_74:
    v_cvt_pk_bf16_f32 v48, v88, v89
    v_cvt_pk_bf16_f32 v49, v90, v91
    v_cvt_pk_bf16_f32 v50, v92, v93
    v_cvt_pk_bf16_f32 v51, v94, v95
    ds_write_b128 v110, v[48:51] offset:0
    v_cvt_pk_bf16_f32 v52, v96, v97
    v_cvt_pk_bf16_f32 v53, v98, v99
    v_cvt_pk_bf16_f32 v54, v100, v101
    v_cvt_pk_bf16_f32 v55, v102, v103
    v_smfmac_f32_16x16x64_bf16 v[36:39], v[48:51], a[176:183], v1
    ds_write_b128 v110, v[52:55] offset:1024
    v_cvt_pk_bf16_f32 v56, v104, v105
    v_cvt_pk_bf16_f32 v57, v106, v107
    v_smfmac_f32_16x16x64_bf16 v[40:43], v[48:51], v[112:119], v1
    ds_write_b64 v111, v[56:57] offset:0
    v_smfmac_f32_16x16x64_bf16 v[36:39], v[52:55], a[184:191], v1
    v_smfmac_f32_16x16x64_bf16 v[40:43], v[52:55], v[120:127], v1
    s_waitcnt lgkmcnt(0)
    s_barrier
    ds_read_b128 v[56:59], v2 offset:4096
    ds_read_b128 v[60:63], v2 offset:5120
    s_waitcnt lgkmcnt(1)
    v_smfmac_f32_16x16x64_bf16 v[36:39], v[56:59], a[192:199], v1
    ds_read_b128 v[64:67], v2 offset:6144
    v_smfmac_f32_16x16x64_bf16 v[40:43], v[56:59], v[128:135], v1
    ds_read_b128 v[68:71], v2 offset:7168
    s_waitcnt lgkmcnt(2)
    v_smfmac_f32_16x16x64_bf16 v[36:39], v[60:63], a[200:207], v1
    ds_read_b128 v[72:75], v2 offset:8192
    v_smfmac_f32_16x16x64_bf16 v[40:43], v[60:63], v[136:143], v1
    ds_read_b128 v[76:79], v2 offset:9216
    s_waitcnt lgkmcnt(3)
    v_smfmac_f32_16x16x64_bf16 v[36:39], v[64:67], a[208:215], v1
    ds_read_b128 v[80:83], v2 offset:0
    v_smfmac_f32_16x16x64_bf16 v[40:43], v[64:67], v[144:151], v1
    ds_read_b128 v[84:87], v2 offset:1024
    s_waitcnt lgkmcnt(4)
    v_smfmac_f32_16x16x64_bf16 v[36:39], v[68:71], a[216:223], v1
    v_smfmac_f32_16x16x64_bf16 v[40:43], v[68:71], v[152:159], v1
    s_waitcnt lgkmcnt(3)
    v_smfmac_f32_16x16x64_bf16 v[36:39], v[72:75], a[224:231], v1
    v_smfmac_f32_16x16x64_bf16 v[40:43], v[72:75], v[160:167], v1
    s_waitcnt lgkmcnt(2)
    v_smfmac_f32_16x16x64_bf16 v[36:39], v[76:79], a[232:239], v1
    v_smfmac_f32_16x16x64_bf16 v[40:43], v[76:79], v[168:175], v1
    s_waitcnt lgkmcnt(0)
    v_smfmac_f32_16x16x64_bf16 v[36:39], v[80:83], a[160:167], v1
    v_smfmac_f32_16x16x64_bf16 v[40:43], v[80:83], a[240:247], v1
    v_smfmac_f32_16x16x64_bf16 v[36:39], v[84:87], a[168:175], v1
    v_smfmac_f32_16x16x64_bf16 v[40:43], v[84:87], a[248:255], v1
    v_smfmac_f32_16x16x64_bf16 v[44:47], v[48:51], v[192:199], v1
    v_smfmac_f32_16x16x64_bf16 v[44:47], v[52:55], v[200:207], v1
    v_add_f32 v36, v36, v38
    v_add_f32 v37, v37, v39
    v_add_f32 v40, v40, v42
    v_add_f32 v41, v41, v43
    v_cvt_pk_bf16_f32 v92, v36, v37
    v_cvt_pk_bf16_f32 v94, v40, v41
    ds_write_b64 v4, v[92:93]
    ds_write_b64 v4, v[94:95] offset:640
    v_smfmac_f32_16x16x64_bf16 v[44:47], v[56:59], v[208:215], v1
    v_smfmac_f32_16x16x64_bf16 v[44:47], v[60:63], v[216:223], v1
    v_smfmac_f32_16x16x64_bf16 v[44:47], v[64:67], v[224:231], v1
    s_waitcnt lgkmcnt(0)
    s_barrier
    v_mov_b32 v104, 63
    buffer_store_dword v104, off, s[40:43], s25 sc1
    ds_read_b64_tr_b16 v[100:101], v9 offset:0
    ds_read_b64_tr_b16 v[102:103], v9 offset:320
    v_smfmac_f32_16x16x64_bf16 v[44:47], v[68:71], v[232:239], v1
    v_smfmac_f32_16x16x64_bf16 v[44:47], v[72:75], v[240:247], v1
    v_smfmac_f32_16x16x64_bf16 v[44:47], v[76:79], v[248:255], v1
    v_smfmac_f32_16x16x64_bf16 v[44:47], v[80:83], v[176:183], v1
    v_smfmac_f32_16x16x64_bf16 v[44:47], v[84:87], v[184:191], v1
    s_branch ZsafeE_77
ZsafeW2_75:
    s_cmp_eq_u32 s34, 3
    s_cbranch_scc1 ZsafeW3_76
    v_cvt_pk_bf16_f32 v48, v88, v89
    v_cvt_pk_bf16_f32 v49, v90, v91
    v_cvt_pk_bf16_f32 v50, v92, v93
    v_cvt_pk_bf16_f32 v51, v94, v95
    ds_write_b128 v110, v[48:51] offset:0
    v_cvt_pk_bf16_f32 v52, v96, v97
    v_cvt_pk_bf16_f32 v53, v98, v99
    v_cvt_pk_bf16_f32 v54, v100, v101
    v_cvt_pk_bf16_f32 v55, v102, v103
    v_smfmac_f32_16x16x64_bf16 v[36:39], v[48:51], a[192:199], v1
    ds_write_b128 v110, v[52:55] offset:1024
    v_cvt_pk_bf16_f32 v56, v104, v105
    v_cvt_pk_bf16_f32 v57, v106, v107
    v_smfmac_f32_16x16x64_bf16 v[40:43], v[48:51], v[128:135], v1
    ds_write_b64 v111, v[56:57] offset:0
    v_smfmac_f32_16x16x64_bf16 v[36:39], v[52:55], a[200:207], v1
    v_smfmac_f32_16x16x64_bf16 v[40:43], v[52:55], v[136:143], v1
    s_waitcnt lgkmcnt(0)
    s_barrier
    ds_read_b128 v[56:59], v2 offset:6144
    ds_read_b128 v[60:63], v2 offset:7168
    s_waitcnt lgkmcnt(1)
    v_smfmac_f32_16x16x64_bf16 v[36:39], v[56:59], a[208:215], v1
    ds_read_b128 v[64:67], v2 offset:8192
    v_smfmac_f32_16x16x64_bf16 v[40:43], v[56:59], v[144:151], v1
    ds_read_b128 v[68:71], v2 offset:9216
    s_waitcnt lgkmcnt(2)
    v_smfmac_f32_16x16x64_bf16 v[36:39], v[60:63], a[216:223], v1
    ds_read_b128 v[72:75], v2 offset:0
    v_smfmac_f32_16x16x64_bf16 v[40:43], v[60:63], v[152:159], v1
    ds_read_b128 v[76:79], v2 offset:1024
    s_waitcnt lgkmcnt(3)
    v_smfmac_f32_16x16x64_bf16 v[36:39], v[64:67], a[224:231], v1
    ds_read_b128 v[80:83], v2 offset:2048
    v_smfmac_f32_16x16x64_bf16 v[40:43], v[64:67], v[160:167], v1
    ds_read_b128 v[84:87], v2 offset:3072
    s_waitcnt lgkmcnt(4)
    v_smfmac_f32_16x16x64_bf16 v[36:39], v[68:71], a[232:239], v1
    v_smfmac_f32_16x16x64_bf16 v[40:43], v[68:71], v[168:175], v1
    s_waitcnt lgkmcnt(3)
    v_smfmac_f32_16x16x64_bf16 v[36:39], v[72:75], a[160:167], v1
    v_smfmac_f32_16x16x64_bf16 v[40:43], v[72:75], a[240:247], v1
    s_waitcnt lgkmcnt(2)
    v_smfmac_f32_16x16x64_bf16 v[36:39], v[76:79], a[168:175], v1
    v_smfmac_f32_16x16x64_bf16 v[40:43], v[76:79], a[248:255], v1
    s_waitcnt lgkmcnt(0)
    v_smfmac_f32_16x16x64_bf16 v[36:39], v[80:83], a[176:183], v1
    v_smfmac_f32_16x16x64_bf16 v[40:43], v[80:83], v[112:119], v1
    v_smfmac_f32_16x16x64_bf16 v[36:39], v[84:87], a[184:191], v1
    v_smfmac_f32_16x16x64_bf16 v[40:43], v[84:87], v[120:127], v1
    v_smfmac_f32_16x16x64_bf16 v[44:47], v[48:51], v[208:215], v1
    v_smfmac_f32_16x16x64_bf16 v[44:47], v[52:55], v[216:223], v1
    v_add_f32 v36, v36, v38
    v_add_f32 v37, v37, v39
    v_add_f32 v40, v40, v42
    v_add_f32 v41, v41, v43
    v_cvt_pk_bf16_f32 v92, v36, v37
    v_cvt_pk_bf16_f32 v94, v40, v41
    ds_write_b64 v4, v[92:93]
    ds_write_b64 v4, v[94:95] offset:640
    v_smfmac_f32_16x16x64_bf16 v[44:47], v[56:59], v[224:231], v1
    v_smfmac_f32_16x16x64_bf16 v[44:47], v[60:63], v[232:239], v1
    v_smfmac_f32_16x16x64_bf16 v[44:47], v[64:67], v[240:247], v1
    s_waitcnt lgkmcnt(0)
    s_barrier
    v_mov_b32 v104, 63
    buffer_store_dword v104, off, s[40:43], s25 sc1
    ds_read_b64_tr_b16 v[100:101], v9 offset:0
    ds_read_b64_tr_b16 v[102:103], v9 offset:320
    v_smfmac_f32_16x16x64_bf16 v[44:47], v[68:71], v[248:255], v1
    v_smfmac_f32_16x16x64_bf16 v[44:47], v[72:75], v[176:183], v1
    v_smfmac_f32_16x16x64_bf16 v[44:47], v[76:79], v[184:191], v1
    v_smfmac_f32_16x16x64_bf16 v[44:47], v[80:83], v[192:199], v1
    v_smfmac_f32_16x16x64_bf16 v[44:47], v[84:87], v[200:207], v1
    s_branch ZsafeE_77
ZsafeW3_76:
    v_cvt_pk_bf16_f32 v48, v88, v89
    v_cvt_pk_bf16_f32 v49, v90, v91
    v_cvt_pk_bf16_f32 v50, v92, v93
    v_cvt_pk_bf16_f32 v51, v94, v95
    ds_write_b128 v110, v[48:51] offset:0
    v_cvt_pk_bf16_f32 v52, v96, v97
    v_cvt_pk_bf16_f32 v53, v98, v99
    v_cvt_pk_bf16_f32 v54, v100, v101
    v_cvt_pk_bf16_f32 v55, v102, v103
    v_smfmac_f32_16x16x64_bf16 v[36:39], v[48:51], a[208:215], v1
    ds_write_b128 v110, v[52:55] offset:1024
    v_cvt_pk_bf16_f32 v56, v104, v105
    v_cvt_pk_bf16_f32 v57, v106, v107
    v_smfmac_f32_16x16x64_bf16 v[40:43], v[48:51], v[144:151], v1
    ds_write_b64 v111, v[56:57] offset:0
    v_smfmac_f32_16x16x64_bf16 v[36:39], v[52:55], a[216:223], v1
    v_smfmac_f32_16x16x64_bf16 v[40:43], v[52:55], v[152:159], v1
    s_waitcnt lgkmcnt(0)
    s_barrier
    ds_read_b128 v[56:59], v2 offset:8192
    ds_read_b128 v[60:63], v2 offset:9216
    s_waitcnt lgkmcnt(1)
    v_smfmac_f32_16x16x64_bf16 v[36:39], v[56:59], a[224:231], v1
    ds_read_b128 v[64:67], v2 offset:0
    v_smfmac_f32_16x16x64_bf16 v[40:43], v[56:59], v[160:167], v1
    ds_read_b128 v[68:71], v2 offset:1024
    s_waitcnt lgkmcnt(2)
    v_smfmac_f32_16x16x64_bf16 v[36:39], v[60:63], a[232:239], v1
    ds_read_b128 v[72:75], v2 offset:2048
    v_smfmac_f32_16x16x64_bf16 v[40:43], v[60:63], v[168:175], v1
    ds_read_b128 v[76:79], v2 offset:3072
    s_waitcnt lgkmcnt(3)
    v_smfmac_f32_16x16x64_bf16 v[36:39], v[64:67], a[160:167], v1
    ds_read_b128 v[80:83], v2 offset:4096
    v_smfmac_f32_16x16x64_bf16 v[40:43], v[64:67], a[240:247], v1
    ds_read_b128 v[84:87], v2 offset:5120
    s_waitcnt lgkmcnt(4)
    v_smfmac_f32_16x16x64_bf16 v[36:39], v[68:71], a[168:175], v1
    v_smfmac_f32_16x16x64_bf16 v[40:43], v[68:71], a[248:255], v1
    s_waitcnt lgkmcnt(3)
    v_smfmac_f32_16x16x64_bf16 v[36:39], v[72:75], a[176:183], v1
    v_smfmac_f32_16x16x64_bf16 v[40:43], v[72:75], v[112:119], v1
    s_waitcnt lgkmcnt(2)
    v_smfmac_f32_16x16x64_bf16 v[36:39], v[76:79], a[184:191], v1
    v_smfmac_f32_16x16x64_bf16 v[40:43], v[76:79], v[120:127], v1
    s_waitcnt lgkmcnt(0)
    v_smfmac_f32_16x16x64_bf16 v[36:39], v[80:83], a[192:199], v1
    v_smfmac_f32_16x16x64_bf16 v[40:43], v[80:83], v[128:135], v1
    v_smfmac_f32_16x16x64_bf16 v[36:39], v[84:87], a[200:207], v1
    v_smfmac_f32_16x16x64_bf16 v[40:43], v[84:87], v[136:143], v1
    v_smfmac_f32_16x16x64_bf16 v[44:47], v[48:51], v[224:231], v1
    v_smfmac_f32_16x16x64_bf16 v[44:47], v[52:55], v[232:239], v1
    v_add_f32 v36, v36, v38
    v_add_f32 v37, v37, v39
    v_add_f32 v40, v40, v42
    v_add_f32 v41, v41, v43
    v_cvt_pk_bf16_f32 v92, v36, v37
    v_cvt_pk_bf16_f32 v94, v40, v41
    ds_write_b64 v4, v[92:93]
    ds_write_b64 v4, v[94:95] offset:640
    v_smfmac_f32_16x16x64_bf16 v[44:47], v[56:59], v[240:247], v1
    v_smfmac_f32_16x16x64_bf16 v[44:47], v[60:63], v[248:255], v1
    v_smfmac_f32_16x16x64_bf16 v[44:47], v[64:67], v[176:183], v1
    s_waitcnt lgkmcnt(0)
    s_barrier
    v_mov_b32 v104, 63
    buffer_store_dword v104, off, s[40:43], s25 sc1
    ds_read_b64_tr_b16 v[100:101], v9 offset:0
    ds_read_b64_tr_b16 v[102:103], v9 offset:320
    v_smfmac_f32_16x16x64_bf16 v[44:47], v[68:71], v[184:191], v1
    v_smfmac_f32_16x16x64_bf16 v[44:47], v[72:75], v[192:199], v1
    v_smfmac_f32_16x16x64_bf16 v[44:47], v[76:79], v[200:207], v1
    v_smfmac_f32_16x16x64_bf16 v[44:47], v[80:83], v[208:215], v1
    v_smfmac_f32_16x16x64_bf16 v[44:47], v[84:87], v[216:223], v1
ZsafeE_77:
    s_nop 7
    v_add_f32 v44, v44, v46
    v_add_f32 v45, v45, v47
    v_cvt_pk_bf16_f32 v20, v44, v45
    s_waitcnt lgkmcnt(0)
    v_lshrrev_b32 v92, 2, v2
    buffer_store_dwordx4 v[100:103], v2, s[40:43], s23 offen sc1
    buffer_store_dword v20, v92, s[40:43], s24 offen sc1
    s_waitcnt vmcnt(0)
    s_barrier
    v_mov_b32 v104, 64
    buffer_store_dword v104, off, s[40:43], s25 sc1
    s_branch END
ROLE_QAO:
    s_and_b32 s80, s36, 1
    s_lshl_b32 s80, s80, 5
    s_add_u32 s80, s80, s35
    s_add_u32 s80, s80, 0
    s_mov_b32 s64, s4
    s_mov_b32 s65, s5
    s_mov_b32 s66, 0x280000
    s_mov_b32 s67, 0x20000
    v_bfe_u32 v2, v0, 4, 4
    s_mov_b32 s75, 1280
    v_mul_u32_u24 v1, s75, v2
    v_bfe_u32 v2, v0, 0, 4
    v_lshl_add_u32 v1, v2, 4, v1
    s_mul_i32 s69, s80, 20480
    buffer_load_dwordx4 v[8:11], v1, s[64:67], s69 offen offset:0
    buffer_load_dwordx4 v[12:15], v1, s[64:67], s69 offen offset:256
    buffer_load_dwordx4 v[16:19], v1, s[64:67], s69 offen offset:512
    buffer_load_dwordx4 v[20:23], v1, s[64:67], s69 offen offset:768
    buffer_load_dwordx4 v[24:27], v1, s[64:67], s69 offen offset:1024
    v_bfe_u32 v2, v0, 1, 3
    v_lshlrev_b32 v3, 10, v2
    v_bfe_u32 v2, v0, 0, 1
    v_lshl_add_u32 v3, v2, 9, v3
    v_bfe_u32 v2, v0, 4, 4
    v_lshl_add_u32 v3, v2, 4, v3
    s_lshr_b32 s70, s80, 1
    s_mul_i32 s70, s70, 40960
    s_and_b32 s71, s80, 1
    s_lshl_b32 s71, s71, 8
    s_add_u32 s70, s70, s71
    s_add_u32 s70, s70, 0x100000
    s_waitcnt vmcnt(0)
    s_cmp_lg_u32 s34, 1
    s_cbranch_scc1 CI_78
    s_cmp_eq_u32 s101, 0
    s_cbranch_scc1 CI_78
    s_waitcnt vmcnt(0)
    s_lshl_b32 s68, s33, 5
    s_add_u32 s68, s68, 16
    v_mov_b32 v30, 1
    s_mov_b64 exec, 1
    buffer_atomic_add v30, off, s[44:47], s68
    s_mov_b64 exec, -1
CI_78:
    s_mov_b32 s60, s8
    s_mov_b32 s61, s9
    s_mov_b32 s62, 0x500000
    s_mov_b32 s63, 0x20000
    s_mul_i32 s72, s80, 40960
    v_bfe_u32 v2, v0, 0, 6
    v_lshlrev_b32 v29, 7, v2
    s_lshl_b32 s73, s34, 13
    s_add_u32 s73, s73, s72
    s_add_u32 s74, s73, 0
    buffer_load_dword v255, v29, s[60:63], s74 offen
    s_cmp_lg_u32 s34, 3
    s_cbranch_scc1 TT_79
    s_add_u32 s74, s72, 32768
    buffer_load_dword v255, v29, s[60:63], s74 offen
TT_79:
    v_lshlrev_b32 v32, 16, v8
    v_and_b32 v33, 0xffff0000, v8
    v_lshlrev_b32 v34, 16, v9
    v_and_b32 v35, 0xffff0000, v9
    v_lshlrev_b32 v36, 16, v10
    v_and_b32 v37, 0xffff0000, v10
    v_lshlrev_b32 v38, 16, v11
    v_and_b32 v39, 0xffff0000, v11
    v_lshlrev_b32 v40, 16, v12
    v_and_b32 v41, 0xffff0000, v12
    v_lshlrev_b32 v42, 16, v13
    v_and_b32 v43, 0xffff0000, v13
    v_lshlrev_b32 v44, 16, v14
    v_and_b32 v45, 0xffff0000, v14
    v_lshlrev_b32 v46, 16, v15
    v_and_b32 v47, 0xffff0000, v15
    v_lshlrev_b32 v48, 16, v16
    v_and_b32 v49, 0xffff0000, v16
    v_lshlrev_b32 v50, 16, v17
    v_and_b32 v51, 0xffff0000, v17
    v_lshlrev_b32 v52, 16, v18
    v_and_b32 v53, 0xffff0000, v18
    v_lshlrev_b32 v54, 16, v19
    v_and_b32 v55, 0xffff0000, v19
    v_lshlrev_b32 v56, 16, v20
    v_and_b32 v57, 0xffff0000, v20
    v_lshlrev_b32 v58, 16, v21
    v_and_b32 v59, 0xffff0000, v21
    v_lshlrev_b32 v60, 16, v22
    v_and_b32 v61, 0xffff0000, v22
    v_lshlrev_b32 v62, 16, v23
    v_and_b32 v63, 0xffff0000, v23
    v_lshlrev_b32 v64, 16, v24
    v_and_b32 v65, 0xffff0000, v24
    v_lshlrev_b32 v66, 16, v25
    v_and_b32 v67, 0xffff0000, v25
    v_lshlrev_b32 v68, 16, v26
    v_and_b32 v69, 0xffff0000, v26
    v_lshlrev_b32 v70, 16, v27
    v_and_b32 v71, 0xffff0000, v27
    v_pk_add_f32 v[4:5], v[32:33], v[34:35]
    v_pk_add_f32 v[4:5], v[4:5], v[36:37]
    v_pk_add_f32 v[4:5], v[4:5], v[38:39]
    v_pk_add_f32 v[4:5], v[4:5], v[40:41]
    v_pk_add_f32 v[4:5], v[4:5], v[42:43]
    v_pk_add_f32 v[4:5], v[4:5], v[44:45]
    v_pk_add_f32 v[4:5], v[4:5], v[46:47]
    v_pk_add_f32 v[4:5], v[4:5], v[48:49]
    v_pk_add_f32 v[4:5], v[4:5], v[50:51]
    v_pk_add_f32 v[4:5], v[4:5], v[52:53]
    v_pk_add_f32 v[4:5], v[4:5], v[54:55]
    v_pk_add_f32 v[4:5], v[4:5], v[56:57]
    v_pk_add_f32 v[4:5], v[4:5], v[58:59]
    v_pk_add_f32 v[4:5], v[4:5], v[60:61]
    v_pk_add_f32 v[4:5], v[4:5], v[62:63]
    v_pk_add_f32 v[4:5], v[4:5], v[64:65]
    v_pk_add_f32 v[4:5], v[4:5], v[66:67]
    v_pk_add_f32 v[4:5], v[4:5], v[68:69]
    v_pk_add_f32 v[4:5], v[4:5], v[70:71]
    v_add_f32 v4, v4, v5
    s_nop 1
    v_add_f32_dpp v4, v4, v4 row_ror:8 row_mask:0xf bank_mask:0xf
    s_nop 1
    v_add_f32_dpp v4, v4, v4 row_ror:4 row_mask:0xf bank_mask:0xf
    s_nop 1
    v_add_f32_dpp v4, v4, v4 row_ror:2 row_mask:0xf bank_mask:0xf
    s_nop 1
    v_add_f32_dpp v4, v4, v4 row_ror:1 row_mask:0xf bank_mask:0xf
    v_mul_f32 v4, 0x3acccccd, v4
    v_mov_b32 v5, 0
    v_mov_b32 v6, 0
    v_sub_f32 v7, v32, v4
    v_sub_f32 v28, v33, v4
    v_fmac_f32 v5, v7, v7
    v_fmac_f32 v6, v28, v28
    v_sub_f32 v7, v34, v4
    v_sub_f32 v28, v35, v4
    v_fmac_f32 v5, v7, v7
    v_fmac_f32 v6, v28, v28
    v_sub_f32 v7, v36, v4
    v_sub_f32 v28, v37, v4
    v_fmac_f32 v5, v7, v7
    v_fmac_f32 v6, v28, v28
    v_sub_f32 v7, v38, v4
    v_sub_f32 v28, v39, v4
    v_fmac_f32 v5, v7, v7
    v_fmac_f32 v6, v28, v28
    v_sub_f32 v7, v40, v4
    v_sub_f32 v28, v41, v4
    v_fmac_f32 v5, v7, v7
    v_fmac_f32 v6, v28, v28
    v_sub_f32 v7, v42, v4
    v_sub_f32 v28, v43, v4
    v_fmac_f32 v5, v7, v7
    v_fmac_f32 v6, v28, v28
    v_sub_f32 v7, v44, v4
    v_sub_f32 v28, v45, v4
    v_fmac_f32 v5, v7, v7
    v_fmac_f32 v6, v28, v28
    v_sub_f32 v7, v46, v4
    v_sub_f32 v28, v47, v4
    v_fmac_f32 v5, v7, v7
    v_fmac_f32 v6, v28, v28
    v_sub_f32 v7, v48, v4
    v_sub_f32 v28, v49, v4
    v_fmac_f32 v5, v7, v7
    v_fmac_f32 v6, v28, v28
    v_sub_f32 v7, v50, v4
    v_sub_f32 v28, v51, v4
    v_fmac_f32 v5, v7, v7
    v_fmac_f32 v6, v28, v28
    v_sub_f32 v7, v52, v4
    v_sub_f32 v28, v53, v4
    v_fmac_f32 v5, v7, v7
    v_fmac_f32 v6, v28, v28
    v_sub_f32 v7, v54, v4
    v_sub_f32 v28, v55, v4
    v_fmac_f32 v5, v7, v7
    v_fmac_f32 v6, v28, v28
    v_sub_f32 v7, v56, v4
    v_sub_f32 v28, v57, v4
    v_fmac_f32 v5, v7, v7
    v_fmac_f32 v6, v28, v28
    v_sub_f32 v7, v58, v4
    v_sub_f32 v28, v59, v4
    v_fmac_f32 v5, v7, v7
    v_fmac_f32 v6, v28, v28
    v_sub_f32 v7, v60, v4
    v_sub_f32 v28, v61, v4
    v_fmac_f32 v5, v7, v7
    v_fmac_f32 v6, v28, v28
    v_sub_f32 v7, v62, v4
    v_sub_f32 v28, v63, v4
    v_fmac_f32 v5, v7, v7
    v_fmac_f32 v6, v28, v28
    v_sub_f32 v7, v64, v4
    v_sub_f32 v28, v65, v4
    v_fmac_f32 v5, v7, v7
    v_fmac_f32 v6, v28, v28
    v_sub_f32 v7, v66, v4
    v_sub_f32 v28, v67, v4
    v_fmac_f32 v5, v7, v7
    v_fmac_f32 v6, v28, v28
    v_sub_f32 v7, v68, v4
    v_sub_f32 v28, v69, v4
    v_fmac_f32 v5, v7, v7
    v_fmac_f32 v6, v28, v28
    v_sub_f32 v7, v70, v4
    v_sub_f32 v28, v71, v4
    v_fmac_f32 v5, v7, v7
    v_fmac_f32 v6, v28, v28
    v_add_f32 v5, v5, v6
    s_nop 1
    v_add_f32_dpp v5, v5, v5 row_ror:8 row_mask:0xf bank_mask:0xf
    s_nop 1
    v_add_f32_dpp v5, v5, v5 row_ror:4 row_mask:0xf bank_mask:0xf
    s_nop 1
    v_add_f32_dpp v5, v5, v5 row_ror:2 row_mask:0xf bank_mask:0xf
    s_nop 1
    v_add_f32_dpp v5, v5, v5 row_ror:1 row_mask:0xf bank_mask:0xf
    v_mul_f32 v5, 0x3acccccd, v5
    v_cvt_pk_bf16_f32 v4, v4, v4
    v_lshlrev_b32 v4, 16, v4
    v_cvt_pk_bf16_f32 v5, v5, v5
    v_lshlrev_b32 v5, 16, v5
    v_add_f32 v5, 0x3727c5ac, v5
    v_cvt_pk_bf16_f32 v5, v5, v5
    v_lshlrev_b32 v5, 16, v5
    v_sqrt_f32 v5, v5
    s_nop 0
    v_cvt_pk_bf16_f32 v5, v5, v5
    v_lshlrev_b32 v5, 16, v5
    v_rcp_f32 v5, v5
    v_sub_f32 v32, v32, v4
    v_sub_f32 v33, v33, v4
    v_cvt_pk_bf16_f32 v7, v32, v33
    v_lshlrev_b32 v28, 16, v7
    v_and_b32 v7, 0xffff0000, v7
    v_mul_f32 v28, v28, v5
    v_mul_f32 v7, v7, v5
    v_cvt_pk_bf16_f32 v8, v28, v7
    v_sub_f32 v34, v34, v4
    v_sub_f32 v35, v35, v4
    v_cvt_pk_bf16_f32 v7, v34, v35
    v_lshlrev_b32 v28, 16, v7
    v_and_b32 v7, 0xffff0000, v7
    v_mul_f32 v28, v28, v5
    v_mul_f32 v7, v7, v5
    v_cvt_pk_bf16_f32 v9, v28, v7
    v_sub_f32 v36, v36, v4
    v_sub_f32 v37, v37, v4
    v_cvt_pk_bf16_f32 v7, v36, v37
    v_lshlrev_b32 v28, 16, v7
    v_and_b32 v7, 0xffff0000, v7
    v_mul_f32 v28, v28, v5
    v_mul_f32 v7, v7, v5
    v_cvt_pk_bf16_f32 v10, v28, v7
    v_sub_f32 v38, v38, v4
    v_sub_f32 v39, v39, v4
    v_cvt_pk_bf16_f32 v7, v38, v39
    v_lshlrev_b32 v28, 16, v7
    v_and_b32 v7, 0xffff0000, v7
    v_mul_f32 v28, v28, v5
    v_mul_f32 v7, v7, v5
    v_cvt_pk_bf16_f32 v11, v28, v7
    v_sub_f32 v40, v40, v4
    v_sub_f32 v41, v41, v4
    v_cvt_pk_bf16_f32 v7, v40, v41
    v_lshlrev_b32 v28, 16, v7
    v_and_b32 v7, 0xffff0000, v7
    v_mul_f32 v28, v28, v5
    v_mul_f32 v7, v7, v5
    v_cvt_pk_bf16_f32 v12, v28, v7
    v_sub_f32 v42, v42, v4
    v_sub_f32 v43, v43, v4
    v_cvt_pk_bf16_f32 v7, v42, v43
    v_lshlrev_b32 v28, 16, v7
    v_and_b32 v7, 0xffff0000, v7
    v_mul_f32 v28, v28, v5
    v_mul_f32 v7, v7, v5
    v_cvt_pk_bf16_f32 v13, v28, v7
    v_sub_f32 v44, v44, v4
    v_sub_f32 v45, v45, v4
    v_cvt_pk_bf16_f32 v7, v44, v45
    v_lshlrev_b32 v28, 16, v7
    v_and_b32 v7, 0xffff0000, v7
    v_mul_f32 v28, v28, v5
    v_mul_f32 v7, v7, v5
    v_cvt_pk_bf16_f32 v14, v28, v7
    v_sub_f32 v46, v46, v4
    v_sub_f32 v47, v47, v4
    v_cvt_pk_bf16_f32 v7, v46, v47
    v_lshlrev_b32 v28, 16, v7
    v_and_b32 v7, 0xffff0000, v7
    v_mul_f32 v28, v28, v5
    v_mul_f32 v7, v7, v5
    v_cvt_pk_bf16_f32 v15, v28, v7
    v_sub_f32 v48, v48, v4
    v_sub_f32 v49, v49, v4
    v_cvt_pk_bf16_f32 v7, v48, v49
    v_lshlrev_b32 v28, 16, v7
    v_and_b32 v7, 0xffff0000, v7
    v_mul_f32 v28, v28, v5
    v_mul_f32 v7, v7, v5
    v_cvt_pk_bf16_f32 v16, v28, v7
    v_sub_f32 v50, v50, v4
    v_sub_f32 v51, v51, v4
    v_cvt_pk_bf16_f32 v7, v50, v51
    v_lshlrev_b32 v28, 16, v7
    v_and_b32 v7, 0xffff0000, v7
    v_mul_f32 v28, v28, v5
    v_mul_f32 v7, v7, v5
    v_cvt_pk_bf16_f32 v17, v28, v7
    v_sub_f32 v52, v52, v4
    v_sub_f32 v53, v53, v4
    v_cvt_pk_bf16_f32 v7, v52, v53
    v_lshlrev_b32 v28, 16, v7
    v_and_b32 v7, 0xffff0000, v7
    v_mul_f32 v28, v28, v5
    v_mul_f32 v7, v7, v5
    v_cvt_pk_bf16_f32 v18, v28, v7
    v_sub_f32 v54, v54, v4
    v_sub_f32 v55, v55, v4
    v_cvt_pk_bf16_f32 v7, v54, v55
    v_lshlrev_b32 v28, 16, v7
    v_and_b32 v7, 0xffff0000, v7
    v_mul_f32 v28, v28, v5
    v_mul_f32 v7, v7, v5
    v_cvt_pk_bf16_f32 v19, v28, v7
    v_sub_f32 v56, v56, v4
    v_sub_f32 v57, v57, v4
    v_cvt_pk_bf16_f32 v7, v56, v57
    v_lshlrev_b32 v28, 16, v7
    v_and_b32 v7, 0xffff0000, v7
    v_mul_f32 v28, v28, v5
    v_mul_f32 v7, v7, v5
    v_cvt_pk_bf16_f32 v20, v28, v7
    v_sub_f32 v58, v58, v4
    v_sub_f32 v59, v59, v4
    v_cvt_pk_bf16_f32 v7, v58, v59
    v_lshlrev_b32 v28, 16, v7
    v_and_b32 v7, 0xffff0000, v7
    v_mul_f32 v28, v28, v5
    v_mul_f32 v7, v7, v5
    v_cvt_pk_bf16_f32 v21, v28, v7
    v_sub_f32 v60, v60, v4
    v_sub_f32 v61, v61, v4
    v_cvt_pk_bf16_f32 v7, v60, v61
    v_lshlrev_b32 v28, 16, v7
    v_and_b32 v7, 0xffff0000, v7
    v_mul_f32 v28, v28, v5
    v_mul_f32 v7, v7, v5
    v_cvt_pk_bf16_f32 v22, v28, v7
    v_sub_f32 v62, v62, v4
    v_sub_f32 v63, v63, v4
    v_cvt_pk_bf16_f32 v7, v62, v63
    v_lshlrev_b32 v28, 16, v7
    v_and_b32 v7, 0xffff0000, v7
    v_mul_f32 v28, v28, v5
    v_mul_f32 v7, v7, v5
    v_cvt_pk_bf16_f32 v23, v28, v7
    v_sub_f32 v64, v64, v4
    v_sub_f32 v65, v65, v4
    v_cvt_pk_bf16_f32 v7, v64, v65
    v_lshlrev_b32 v28, 16, v7
    v_and_b32 v7, 0xffff0000, v7
    v_mul_f32 v28, v28, v5
    v_mul_f32 v7, v7, v5
    v_cvt_pk_bf16_f32 v24, v28, v7
    v_sub_f32 v66, v66, v4
    v_sub_f32 v67, v67, v4
    v_cvt_pk_bf16_f32 v7, v66, v67
    v_lshlrev_b32 v28, 16, v7
    v_and_b32 v7, 0xffff0000, v7
    v_mul_f32 v28, v28, v5
    v_mul_f32 v7, v7, v5
    v_cvt_pk_bf16_f32 v25, v28, v7
    v_sub_f32 v68, v68, v4
    v_sub_f32 v69, v69, v4
    v_cvt_pk_bf16_f32 v7, v68, v69
    v_lshlrev_b32 v28, 16, v7
    v_and_b32 v7, 0xffff0000, v7
    v_mul_f32 v28, v28, v5
    v_mul_f32 v7, v7, v5
    v_cvt_pk_bf16_f32 v26, v28, v7
    v_sub_f32 v70, v70, v4
    v_sub_f32 v71, v71, v4
    v_cvt_pk_bf16_f32 v7, v70, v71
    v_lshlrev_b32 v28, 16, v7
    v_and_b32 v7, 0xffff0000, v7
    v_mul_f32 v28, v28, v5
    v_mul_f32 v7, v7, v5
    v_cvt_pk_bf16_f32 v27, v28, v7
    buffer_store_dwordx4 v[8:11], v3, s[40:43], s70 offen sc1
    s_add_u32 s70, s70, 8192
    buffer_store_dwordx4 v[12:15], v3, s[40:43], s70 offen sc1
    s_add_u32 s70, s70, 8192
    buffer_store_dwordx4 v[16:19], v3, s[40:43], s70 offen sc1
    s_add_u32 s70, s70, 8192
    buffer_store_dwordx4 v[20:23], v3, s[40:43], s70 offen sc1
    s_add_u32 s70, s70, 8192
    buffer_store_dwordx4 v[24:27], v3, s[40:43], s70 offen sc1
    s_waitcnt vmcnt(0)
    s_barrier
    v_mov_b32 v1, 0x4
    v_bfe_u32 v2, v0, 0, 3
    v_lshl_add_u32 v1, v2, 5, v1
    v_bfe_u32 v2, v0, 3, 1
    s_mov_b32 s75, 12
    v_mad_u32_u24 v1, v2, s75, v1
    s_mov_b32 s38, 262144
PL_80:
    buffer_load_dword v2, v1, s[44:47], 0 offen sc1
    s_waitcnt vmcnt(0)
    v_and_b32 v3, 8, v0
    v_cmp_ne_u32 vcc, 0, v3
    s_nop 1
    v_cndmask_b32 v3, 0, v2, vcc
    s_nop 1
    v_add_u32_dpp v3, v3, v3 row_ror:8 row_mask:0xf bank_mask:0xf
    s_nop 1
    v_add_u32_dpp v3, v3, v3 row_ror:4 row_mask:0xf bank_mask:0xf
    s_nop 1
    v_add_u32_dpp v3, v3, v3 quad_perm:[2,3,0,1] row_mask:0xf bank_mask:0xf
    s_nop 1
    v_add_u32_dpp v3, v3, v3 quad_perm:[1,0,3,2] row_mask:0xf bank_mask:0xf
    v_cmp_gt_u32 vcc, 0x100, v3
    s_cbranch_vccnz PN_81
    s_branch PO_82
PN_81:
    s_sleep 1
    s_sub_u32 s38, s38, 1
    s_cbranch_scc0 PL_80
    s_mov_b32 s68, 2
    s_branch FAIL
PO_82:
    s_cmp_eq_u32 s101, 0
    s_cbranch_scc1 VOK_83
    v_and_b32 v3, 8, v0
    v_cmp_ne_u32 vcc, 0, v3
    v_mov_b32 v3, -1
    s_nop 0
    v_cndmask_b32 v3, v3, 32, vcc
    v_cmp_ne_u32 vcc, v3, v2
    s_cbranch_vccz VOK_83
    s_branch RESPEC
VOK_83:
    s_cmp_lg_u32 s34, 0
    s_cbranch_scc1 W0_84
    s_lshl_b32 s69, s80, 2
    s_add_u32 s69, s69, 0x0
    v_mov_b32 v1, 1
    s_mov_b64 exec, 1
    buffer_store_dword v1, off, s[40:43], s69 sc1
    s_mov_b64 exec, -1
W0_84:
    s_mov_b32 s60, s14
    s_mov_b32 s61, s15
    s_mov_b32 s62, 0x500000
    s_mov_b32 s63, 0x20000
    s_mul_i32 s69, s80, 40960
    v_bfe_u32 v2, v0, 0, 6
    v_lshlrev_b32 v1, 7, v2
    s_lshl_b32 s71, s34, 13
    s_add_u32 s71, s71, s69
    s_add_u32 s74, s71, 0
    buffer_load_dword v255, v1, s[60:63], s74 offen
    s_cmp_lg_u32 s34, 0
    s_cbranch_scc1 W0_85
    s_add_u32 s74, s69, 32768
    buffer_load_dword v255, v1, s[60:63], s74 offen
W0_85:
    s_cmp_lg_u32 s36, 2
    s_cbranch_scc1 NOCAL_86
    s_cmp_ge_u32 s35, 2
    s_cbranch_scc1 NOCAL_86
    s_cmp_lg_u32 s34, 0
    s_cbranch_scc1 W0_87
    s_lshl_b32 s69, s35, 13
    s_add_u32 s69, s69, 0x440000
    s_mov_b32 s70, 0x3c00
    s_mov_b64 exec, 1
    v_mov_b32 v2, 0
    buffer_atomic_add v2, off, s[40:43], s69 sc0
    s_waitcnt vmcnt(0)
    v_mov_b32 v2, 1
    buffer_atomic_add v2, off, s[40:43], s70
    s_mov_b32 s38, 262144
PL_88:
    buffer_load_dword v2, off, s[40:43], s70 sc1
    s_waitcnt vmcnt(0)
    v_cmp_gt_u32 vcc, 2, v2
    s_cbranch_vccnz PN_89
    s_branch PO_90
PN_89:
    s_sub_u32 s38, s38, 1
    s_cbranch_scc0 PL_88
    s_mov_b32 s68, 20
    s_branch FAIL
PO_90:
    v_mov_b32 v2, 0
    buffer_atomic_add v2, off, s[40:43], s69 sc0
    s_waitcnt vmcnt(0)
    v_mov_b32 v2, 0
    buffer_atomic_add v2, off, s[40:43], s69 sc0
    s_waitcnt vmcnt(0)
    v_mov_b32 v2, 0
    buffer_atomic_add v2, off, s[40:43], s69 sc0
    s_waitcnt vmcnt(0)
    v_mov_b32 v2, 0
    buffer_atomic_add v2, off, s[40:43], s69 sc0
    s_waitcnt vmcnt(0)
    v_mov_b32 v2, 0
    buffer_atomic_add v2, off, s[40:43], s69 sc0
    s_waitcnt vmcnt(0)
    v_mov_b32 v2, 1
    buffer_atomic_add v2, off, s[40:43], s70 offset:128 sc0
    s_waitcnt vmcnt(0)
    v_add_u32 v2, 1, v2
    s_cmp_lg_u32 s35, 0
    s_cbranch_scc1 NOCAL_86_x
    buffer_store_dword v2, off, s[44:47], 0 offset:8 sc1
NOCAL_86_x:
    s_mov_b64 exec, -1
W0_87:
    s_barrier
NOCAL_86:
    s_mov_b32 s48, s8
    s_mov_b32 s49, s9
    s_mov_b32 s50, 0x500000
    s_mov_b32 s51, 0x20000
    s_mov_b32 s52, s14
    s_mov_b32 s53, s15
    s_mov_b32 s54, 0x500000
    s_mov_b32 s55, 0x20000
    s_cmp_lg_u32 s37, 0
    s_cbranch_scc1 GATE_91
    s_cmp_lg_u32 s34, 0
    s_cbranch_scc1 W0_92
    s_lshl_b32 s69, s35, 7
    s_add_u32 s69, s69, 0x2000
    s_mov_b32 s38, 262144
PL_93:
    buffer_load_dword v2, off, s[40:43], s69 sc1
    s_waitcnt vmcnt(0)
    v_cmp_gt_u32 vcc, 2, v2
    s_cbranch_vccnz PN_94
    s_branch PO_95
PN_94:
    s_sleep 8
    s_sub_u32 s38, s38, 1
    s_cbranch_scc0 PL_93
    s_mov_b32 s68, 50
    s_branch FAIL
PO_95:
W0_92:
GATE_91:
    s_barrier
    v_bfe_u32 v2, v0, 0, 4
    v_lshlrev_b32 v8, 4, v2
    v_bfe_u32 v2, v0, 4, 2
    v_lshlrev_b32 v2, 6, v2
    v_xor_b32 v8, v2, v8
    v_bfe_u32 v2, v0, 4, 2
    s_mov_b32 s75, 8192
    v_mad_u32_u24 v8, v2, s75, v8
    v_bfe_u32 v2, v0, 6, 2
    v_lshlrev_b32 v16, 6, v2
    v_bfe_u32 v2, v0, 0, 1
    v_lshl_add_u32 v16, v2, 5, v16
    v_bfe_u32 v2, v0, 4, 1
    v_lshl_add_u32 v16, v2, 4, v16
    v_bfe_u32 v2, v0, 1, 1
    v_lshl_add_u32 v16, v2, 3, v16
    v_bfe_u32 v2, v0, 2, 2
    v_lshlrev_b32 v2, 6, v2
    v_xor_b32 v16, v2, v16
    v_bfe_u32 v2, v0, 2, 2
    v_lshl_add_u32 v16, v2, 8, v16
    v_bfe_u32 v2, v0, 5, 1
    v_lshl_add_u32 v16, v2, 11, v16
    v_add_u32 v17, 0x10000, v16
    v_add_u32 v18, 0x20000, v16
    s_lshl_b32 s71, s35, 8
    s_lshl_b32 s69, s34, 17
    s_add_u32 s71, s71, s69
    s_add_u32 s72, s71, 0
    s_lshl_b32 s70, s34, 12
    s_add_u32 m0, s70, 0
    s_nop 0
    buffer_load_dwordx4 v8, s[48:51], s72 offen  lds
    s_add_u32 s69, s72, 32768
    s_lshl_b32 s70, s34, 12
    s_add_u32 m0, s70, 1024
    s_nop 0
    buffer_load_dwordx4 v8, s[48:51], s69 offen  lds
    s_add_u32 s69, s72, 65536
    s_lshl_b32 s70, s34, 12
    s_add_u32 m0, s70, 2048
    s_nop 0
    buffer_load_dwordx4 v8, s[48:51], s69 offen  lds
    s_add_u32 s69, s72, 98304
    s_lshl_b32 s70, s34, 12
    s_add_u32 m0, s70, 3072
    s_nop 0
    buffer_load_dwordx4 v8, s[48:51], s69 offen  lds
    s_add_u32 s72, s71, 524288
    s_lshl_b32 s70, s34, 12
    s_add_u32 m0, s70, 16384
    s_nop 0
    buffer_load_dwordx4 v8, s[48:51], s72 offen  lds
    s_add_u32 s69, s72, 32768
    s_lshl_b32 s70, s34, 12
    s_add_u32 m0, s70, 17408
    s_nop 0
    buffer_load_dwordx4 v8, s[48:51], s69 offen  lds
    s_add_u32 s69, s72, 65536
    s_lshl_b32 s70, s34, 12
    s_add_u32 m0, s70, 18432
    s_nop 0
    buffer_load_dwordx4 v8, s[48:51], s69 offen  lds
    s_add_u32 s69, s72, 98304
    s_lshl_b32 s70, s34, 12
    s_add_u32 m0, s70, 19456
    s_nop 0
    buffer_load_dwordx4 v8, s[48:51], s69 offen  lds
    s_add_u32 s72, s71, 1048576
    s_lshl_b32 s70, s34, 12
    s_add_u32 m0, s70, 32768
    s_nop 0
    buffer_load_dwordx4 v8, s[48:51], s72 offen  lds
    s_add_u32 s69, s72, 32768
    s_lshl_b32 s70, s34, 12
    s_add_u32 m0, s70, 33792
    s_nop 0
    buffer_load_dwordx4 v8, s[48:51], s69 offen  lds
    s_add_u32 s69, s72, 65536
    s_lshl_b32 s70, s34, 12
    s_add_u32 m0, s70, 34816
    s_nop 0
    buffer_load_dwordx4 v8, s[48:51], s69 offen  lds
    s_add_u32 s69, s72, 98304
    s_lshl_b32 s70, s34, 12
    s_add_u32 m0, s70, 35840
    s_nop 0
    buffer_load_dwordx4 v8, s[48:51], s69 offen  lds
    s_add_u32 s72, s71, 1572864
    s_lshl_b32 s70, s34, 12
    s_add_u32 m0, s70, 49152
    s_nop 0
    buffer_load_dwordx4 v8, s[48:51], s72 offen  lds
    s_add_u32 s69, s72, 32768
    s_lshl_b32 s70, s34, 12
    s_add_u32 m0, s70, 50176
    s_nop 0
    buffer_load_dwordx4 v8, s[48:51], s69 offen  lds
    s_add_u32 s69, s72, 65536
    s_lshl_b32 s70, s34, 12
    s_add_u32 m0, s70, 51200
    s_nop 0
    buffer_load_dwordx4 v8, s[48:51], s69 offen  lds
    s_add_u32 s69, s72, 98304
    s_lshl_b32 s70, s34, 12
    s_add_u32 m0, s70, 52224
    s_nop 0
    buffer_load_dwordx4 v8, s[48:51], s69 offen  lds
    s_add_u32 s72, s71, 2097152
    s_lshl_b32 s70, s34, 12
    s_add_u32 m0, s70, 65536
    s_nop 0
    buffer_load_dwordx4 v8, s[48:51], s72 offen  lds
    s_add_u32 s69, s72, 32768
    s_lshl_b32 s70, s34, 12
    s_add_u32 m0, s70, 66560
    s_nop 0
    buffer_load_dwordx4 v8, s[48:51], s69 offen  lds
    s_add_u32 s69, s72, 65536
    s_lshl_b32 s70, s34, 12
    s_add_u32 m0, s70, 67584
    s_nop 0
    buffer_load_dwordx4 v8, s[48:51], s69 offen  lds
    s_add_u32 s69, s72, 98304
    s_lshl_b32 s70, s34, 12
    s_add_u32 m0, s70, 68608
    s_nop 0
    buffer_load_dwordx4 v8, s[48:51], s69 offen  lds
    s_add_u32 s72, s71, 2621440
    s_lshl_b32 s70, s34, 12
    s_add_u32 m0, s70, 81920
    s_nop 0
    buffer_load_dwordx4 v8, s[48:51], s72 offen  lds
    s_add_u32 s69, s72, 32768
    s_lshl_b32 s70, s34, 12
    s_add_u32 m0, s70, 82944
    s_nop 0
    buffer_load_dwordx4 v8, s[48:51], s69 offen  lds
    s_add_u32 s69, s72, 65536
    s_lshl_b32 s70, s34, 12
    s_add_u32 m0, s70, 83968
    s_nop 0
    buffer_load_dwordx4 v8, s[48:51], s69 offen  lds
    s_add_u32 s69, s72, 98304
    s_lshl_b32 s70, s34, 12
    s_add_u32 m0, s70, 84992
    s_nop 0
    buffer_load_dwordx4 v8, s[48:51], s69 offen  lds
    s_add_u32 s72, s71, 3145728
    s_lshl_b32 s70, s34, 12
    s_add_u32 m0, s70, 98304
    s_nop 0
    buffer_load_dwordx4 v8, s[48:51], s72 offen  lds
    s_add_u32 s69, s72, 32768
    s_lshl_b32 s70, s34, 12
    s_add_u32 m0, s70, 99328
    s_nop 0
    buffer_load_dwordx4 v8, s[48:51], s69 offen  lds
    s_add_u32 s69, s72, 65536
    s_lshl_b32 s70, s34, 12
    s_add_u32 m0, s70, 100352
    s_nop 0
    buffer_load_dwordx4 v8, s[48:51], s69 offen  lds
    s_add_u32 s69, s72, 98304
    s_lshl_b32 s70, s34, 12
    s_add_u32 m0, s70, 101376
    s_nop 0
    buffer_load_dwordx4 v8, s[48:51], s69 offen  lds
    s_add_u32 s72, s71, 3670016
    s_lshl_b32 s70, s34, 12
    s_add_u32 m0, s70, 114688
    s_nop 0
    buffer_load_dwordx4 v8, s[48:51], s72 offen  lds
    s_add_u32 s69, s72, 32768
    s_lshl_b32 s70, s34, 12
    s_add_u32 m0, s70, 115712
    s_nop 0
    buffer_load_dwordx4 v8, s[48:51], s69 offen  lds
    s_add_u32 s69, s72, 65536
    s_lshl_b32 s70, s34, 12
    s_add_u32 m0, s70, 116736
    s_nop 0
    buffer_load_dwordx4 v8, s[48:51], s69 offen  lds
    s_add_u32 s69, s72, 98304
    s_lshl_b32 s70, s34, 12
    s_add_u32 m0, s70, 117760
    s_nop 0
    buffer_load_dwordx4 v8, s[48:51], s69 offen  lds
    s_add_u32 s72, s71, 4194304
    s_lshl_b32 s70, s34, 12
    s_add_u32 m0, s70, 131072
    s_nop 0
    buffer_load_dwordx4 v8, s[48:51], s72 offen  lds
    s_add_u32 s69, s72, 32768
    s_lshl_b32 s70, s34, 12
    s_add_u32 m0, s70, 132096
    s_nop 0
    buffer_load_dwordx4 v8, s[48:51], s69 offen  lds
    s_add_u32 s69, s72, 65536
    s_lshl_b32 s70, s34, 12
    s_add_u32 m0, s70, 133120
    s_nop 0
    buffer_load_dwordx4 v8, s[48:51], s69 offen  lds
    s_add_u32 s69, s72, 98304
    s_lshl_b32 s70, s34, 12
    s_add_u32 m0, s70, 134144
    s_nop 0
    buffer_load_dwordx4 v8, s[48:51], s69 offen  lds
    s_add_u32 s72, s71, 4718592
    s_lshl_b32 s70, s34, 12
    s_add_u32 m0, s70, 147456
    s_nop 0
    buffer_load_dwordx4 v8, s[48:51], s72 offen  lds
    s_add_u32 s69, s72, 32768
    s_lshl_b32 s70, s34, 12
    s_add_u32 m0, s70, 148480
    s_nop 0
    buffer_load_dwordx4 v8, s[48:51], s69 offen  lds
    s_add_u32 s69, s72, 65536
    s_lshl_b32 s70, s34, 12
    s_add_u32 m0, s70, 149504
    s_nop 0
    buffer_load_dwordx4 v8, s[48:51], s69 offen  lds
    s_add_u32 s69, s72, 98304
    s_lshl_b32 s70, s34, 12
    s_add_u32 m0, s70, 150528
    s_nop 0
    buffer_load_dwordx4 v8, s[48:51], s69 offen  lds
    s_waitcnt vmcnt(36)
    s_barrier
    ds_read_b64_tr_b16 a[0:1], v16 offset:0
    ds_read_b64_tr_b16 a[2:3], v16 offset:1024
    ds_read_b64_tr_b16 a[4:5], v16 offset:4096
    ds_read_b64_tr_b16 a[6:7], v16 offset:5120
    ds_read_b64_tr_b16 a[8:9], v16 offset:8192
    ds_read_b64_tr_b16 a[10:11], v16 offset:9216
    ds_read_b64_tr_b16 a[12:13], v16 offset:12288
    ds_read_b64_tr_b16 a[14:15], v16 offset:13312
    s_waitcnt vmcnt(32)
    s_barrier
    ds_read_b64_tr_b16 a[16:17], v16 offset:16384
    ds_read_b64_tr_b16 a[18:19], v16 offset:17408
    ds_read_b64_tr_b16 a[20:21], v16 offset:20480
    ds_read_b64_tr_b16 a[22:23], v16 offset:21504
    ds_read_b64_tr_b16 a[24:25], v16 offset:24576
    ds_read_b64_tr_b16 a[26:27], v16 offset:25600
    ds_read_b64_tr_b16 a[28:29], v16 offset:28672
    ds_read_b64_tr_b16 a[30:31], v16 offset:29696
    s_waitcnt vmcnt(28)
    s_barrier
    ds_read_b64_tr_b16 a[32:33], v16 offset:32768
    ds_read_b64_tr_b16 a[34:35], v16 offset:33792
    ds_read_b64_tr_b16 a[36:37], v16 offset:36864
    ds_read_b64_tr_b16 a[38:39], v16 offset:37888
    ds_read_b64_tr_b16 a[40:41], v16 offset:40960
    ds_read_b64_tr_b16 a[42:43], v16 offset:41984
    ds_read_b64_tr_b16 a[44:45], v16 offset:45056
    ds_read_b64_tr_b16 a[46:47], v16 offset:46080
    s_waitcnt vmcnt(24)
    s_barrier
    ds_read_b64_tr_b16 a[48:49], v16 offset:49152
    ds_read_b64_tr_b16 a[50:51], v16 offset:50176
    ds_read_b64_tr_b16 a[52:53], v16 offset:53248
    ds_read_b64_tr_b16 a[54:55], v16 offset:54272
    ds_read_b64_tr_b16 a[56:57], v16 offset:57344
    ds_read_b64_tr_b16 a[58:59], v16 offset:58368
    ds_read_b64_tr_b16 a[60:61], v16 offset:61440
    ds_read_b64_tr_b16 a[62:63], v16 offset:62464
    s_waitcnt vmcnt(20)
    s_barrier
    ds_read_b64_tr_b16 a[64:65], v17 offset:0
    ds_read_b64_tr_b16 a[66:67], v17 offset:1024
    ds_read_b64_tr_b16 a[68:69], v17 offset:4096
    ds_read_b64_tr_b16 a[70:71], v17 offset:5120
    ds_read_b64_tr_b16 a[72:73], v17 offset:8192
    ds_read_b64_tr_b16 a[74:75], v17 offset:9216
    ds_read_b64_tr_b16 a[76:77], v17 offset:12288
    ds_read_b64_tr_b16 a[78:79], v17 offset:13312
    s_waitcnt vmcnt(16)
    s_barrier
    ds_read_b64_tr_b16 a[80:81], v17 offset:16384
    ds_read_b64_tr_b16 a[82:83], v17 offset:17408
    ds_read_b64_tr_b16 a[84:85], v17 offset:20480
    ds_read_b64_tr_b16 a[86:87], v17 offset:21504
    ds_read_b64_tr_b16 a[88:89], v17 offset:24576
    ds_read_b64_tr_b16 a[90:91], v17 offset:25600
    ds_read_b64_tr_b16 a[92:93], v17 offset:28672
    ds_read_b64_tr_b16 a[94:95], v17 offset:29696
    s_waitcnt vmcnt(12)
    s_barrier
    ds_read_b64_tr_b16 a[96:97], v17 offset:32768
    ds_read_b64_tr_b16 a[98:99], v17 offset:33792
    ds_read_b64_tr_b16 a[100:101], v17 offset:36864
    ds_read_b64_tr_b16 a[102:103], v17 offset:37888
    ds_read_b64_tr_b16 a[104:105], v17 offset:40960
    ds_read_b64_tr_b16 a[106:107], v17 offset:41984
    ds_read_b64_tr_b16 a[108:109], v17 offset:45056
    ds_read_b64_tr_b16 a[110:111], v17 offset:46080
    s_waitcnt vmcnt(8)
    s_barrier
    ds_read_b64_tr_b16 a[112:113], v17 offset:49152
    ds_read_b64_tr_b16 a[114:115], v17 offset:50176
    ds_read_b64_tr_b16 a[116:117], v17 offset:53248
    ds_read_b64_tr_b16 a[118:119], v17 offset:54272
    ds_read_b64_tr_b16 a[120:121], v17 offset:57344
    ds_read_b64_tr_b16 a[122:123], v17 offset:58368
    ds_read_b64_tr_b16 a[124:125], v17 offset:61440
    ds_read_b64_tr_b16 a[126:127], v17 offset:62464
    s_waitcnt vmcnt(4)
    s_barrier
    ds_read_b64_tr_b16 a[128:129], v18 offset:0
    ds_read_b64_tr_b16 a[130:131], v18 offset:1024
    ds_read_b64_tr_b16 a[132:133], v18 offset:4096
    ds_read_b64_tr_b16 a[134:135], v18 offset:5120
    ds_read_b64_tr_b16 a[136:137], v18 offset:8192
    ds_read_b64_tr_b16 a[138:139], v18 offset:9216
    ds_read_b64_tr_b16 a[140:141], v18 offset:12288
    ds_read_b64_tr_b16 a[142:143], v18 offset:13312
    s_waitcnt vmcnt(0)
    s_barrier
    ds_read_b64_tr_b16 a[144:145], v18 offset:16384
    ds_read_b64_tr_b16 a[146:147], v18 offset:17408
    ds_read_b64_tr_b16 a[148:149], v18 offset:20480
    ds_read_b64_tr_b16 a[150:151], v18 offset:21504
    ds_read_b64_tr_b16 a[152:153], v18 offset:24576
    ds_read_b64_tr_b16 a[154:155], v18 offset:25600
    ds_read_b64_tr_b16 a[156:157], v18 offset:28672
    ds_read_b64_tr_b16 a[158:159], v18 offset:29696
    s_waitcnt lgkmcnt(0)
    s_barrier
    v_bfe_u32 v2, v0, 0, 4
    v_lshlrev_b32 v8, 4, v2
    v_bfe_u32 v2, v0, 4, 2
    v_lshlrev_b32 v2, 6, v2
    v_xor_b32 v8, v2, v8
    v_bfe_u32 v2, v0, 4, 2
    s_mov_b32 s75, 1280
    v_mad_u32_u24 v8, v2, s75, v8
    s_lshl_b32 s71, s35, 3
    s_add_u32 s71, s71, s34
    s_mul_i32 s71, s71, 20480
    s_add_u32 s72, s71, 0
    s_lshl_b32 s70, s34, 12
    s_add_u32 m0, s70, 0
    s_nop 0
    buffer_load_dwordx4 v8, s[52:55], s72 offen  lds
    s_add_u32 s69, s72, 5120
    s_lshl_b32 s70, s34, 12
    s_add_u32 m0, s70, 1024
    s_nop 0
    buffer_load_dwordx4 v8, s[52:55], s69 offen  lds
    s_add_u32 s69, s72, 10240
    s_lshl_b32 s70, s34, 12
    s_add_u32 m0, s70, 2048
    s_nop 0
    buffer_load_dwordx4 v8, s[52:55], s69 offen  lds
    s_add_u32 s69, s72, 15360
    s_lshl_b32 s70, s34, 12
    s_add_u32 m0, s70, 3072
    s_nop 0
    buffer_load_dwordx4 v8, s[52:55], s69 offen  lds
    s_add_u32 s72, s71, 81920
    s_lshl_b32 s70, s34, 12
    s_add_u32 m0, s70, 16384
    s_nop 0
    buffer_load_dwordx4 v8, s[52:55], s72 offen  lds
    s_add_u32 s69, s72, 5120
    s_lshl_b32 s70, s34, 12
    s_add_u32 m0, s70, 17408
    s_nop 0
    buffer_load_dwordx4 v8, s[52:55], s69 offen  lds
    s_add_u32 s69, s72, 10240
    s_lshl_b32 s70, s34, 12
    s_add_u32 m0, s70, 18432
    s_nop 0
    buffer_load_dwordx4 v8, s[52:55], s69 offen  lds
    s_add_u32 s69, s72, 15360
    s_lshl_b32 s70, s34, 12
    s_add_u32 m0, s70, 19456
    s_nop 0
    buffer_load_dwordx4 v8, s[52:55], s69 offen  lds
    s_add_u32 s72, s71, 256
    s_lshl_b32 s70, s34, 12
    s_add_u32 m0, s70, 32768
    s_nop 0
    buffer_load_dwordx4 v8, s[52:55], s72 offen  lds
    s_add_u32 s69, s72, 5120
    s_lshl_b32 s70, s34, 12
    s_add_u32 m0, s70, 33792
    s_nop 0
    buffer_load_dwordx4 v8, s[52:55], s69 offen  lds
    s_add_u32 s69, s72, 10240
    s_lshl_b32 s70, s34, 12
    s_add_u32 m0, s70, 34816
    s_nop 0
    buffer_load_dwordx4 v8, s[52:55], s69 offen  lds
    s_add_u32 s69, s72, 15360
    s_lshl_b32 s70, s34, 12
    s_add_u32 m0, s70, 35840
    s_nop 0
    buffer_load_dwordx4 v8, s[52:55], s69 offen  lds
    s_add_u32 s72, s71, 82176
    s_lshl_b32 s70, s34, 12
    s_add_u32 m0, s70, 49152
    s_nop 0
    buffer_load_dwordx4 v8, s[52:55], s72 offen  lds
    s_add_u32 s69, s72, 5120
    s_lshl_b32 s70, s34, 12
    s_add_u32 m0, s70, 50176
    s_nop 0
    buffer_load_dwordx4 v8, s[52:55], s69 offen  lds
    s_add_u32 s69, s72, 10240
    s_lshl_b32 s70, s34, 12
    s_add_u32 m0, s70, 51200
    s_nop 0
    buffer_load_dwordx4 v8, s[52:55], s69 offen  lds
    s_add_u32 s69, s72, 15360
    s_lshl_b32 s70, s34, 12
    s_add_u32 m0, s70, 52224
    s_nop 0
    buffer_load_dwordx4 v8, s[52:55], s69 offen  lds
    s_add_u32 s72, s71, 512
    s_lshl_b32 s70, s34, 12
    s_add_u32 m0, s70, 65536
    s_nop 0
    buffer_load_dwordx4 v8, s[52:55], s72 offen  lds
    s_add_u32 s69, s72, 5120
    s_lshl_b32 s70, s34, 12
    s_add_u32 m0, s70, 66560
    s_nop 0
    buffer_load_dwordx4 v8, s[52:55], s69 offen  lds
    s_add_u32 s69, s72, 10240
    s_lshl_b32 s70, s34, 12
    s_add_u32 m0, s70, 67584
    s_nop 0
    buffer_load_dwordx4 v8, s[52:55], s69 offen  lds
    s_add_u32 s69, s72, 15360
    s_lshl_b32 s70, s34, 12
    s_add_u32 m0, s70, 68608
    s_nop 0
    buffer_load_dwordx4 v8, s[52:55], s69 offen  lds
    s_add_u32 s72, s71, 82432
    s_lshl_b32 s70, s34, 12
    s_add_u32 m0, s70, 81920
    s_nop 0
    buffer_load_dwordx4 v8, s[52:55], s72 offen  lds
    s_add_u32 s69, s72, 5120
    s_lshl_b32 s70, s34, 12
    s_add_u32 m0, s70, 82944
    s_nop 0
    buffer_load_dwordx4 v8, s[52:55], s69 offen  lds
    s_add_u32 s69, s72, 10240
    s_lshl_b32 s70, s34, 12
    s_add_u32 m0, s70, 83968
    s_nop 0
    buffer_load_dwordx4 v8, s[52:55], s69 offen  lds
    s_add_u32 s69, s72, 15360
    s_lshl_b32 s70, s34, 12
    s_add_u32 m0, s70, 84992
    s_nop 0
    buffer_load_dwordx4 v8, s[52:55], s69 offen  lds
    s_add_u32 s72, s71, 768
    s_lshl_b32 s70, s34, 12
    s_add_u32 m0, s70, 98304
    s_nop 0
    buffer_load_dwordx4 v8, s[52:55], s72 offen  lds
    s_add_u32 s69, s72, 5120
    s_lshl_b32 s70, s34, 12
    s_add_u32 m0, s70, 99328
    s_nop 0
    buffer_load_dwordx4 v8, s[52:55], s69 offen  lds
    s_add_u32 s69, s72, 10240
    s_lshl_b32 s70, s34, 12
    s_add_u32 m0, s70, 100352
    s_nop 0
    buffer_load_dwordx4 v8, s[52:55], s69 offen  lds
    s_add_u32 s69, s72, 15360
    s_lshl_b32 s70, s34, 12
    s_add_u32 m0, s70, 101376
    s_nop 0
    buffer_load_dwordx4 v8, s[52:55], s69 offen  lds
    s_add_u32 s72, s71, 82688
    s_lshl_b32 s70, s34, 12
    s_add_u32 m0, s70, 114688
    s_nop 0
    buffer_load_dwordx4 v8, s[52:55], s72 offen  lds
    s_add_u32 s69, s72, 5120
    s_lshl_b32 s70, s34, 12
    s_add_u32 m0, s70, 115712
    s_nop 0
    buffer_load_dwordx4 v8, s[52:55], s69 offen  lds
    s_add_u32 s69, s72, 10240
    s_lshl_b32 s70, s34, 12
    s_add_u32 m0, s70, 116736
    s_nop 0
    buffer_load_dwordx4 v8, s[52:55], s69 offen  lds
    s_add_u32 s69, s72, 15360
    s_lshl_b32 s70, s34, 12
    s_add_u32 m0, s70, 117760
    s_nop 0
    buffer_load_dwordx4 v8, s[52:55], s69 offen  lds
    s_add_u32 s72, s71, 1024
    s_lshl_b32 s70, s34, 12
    s_add_u32 m0, s70, 131072
    s_nop 0
    buffer_load_dwordx4 v8, s[52:55], s72 offen  lds
    s_add_u32 s69, s72, 5120
    s_lshl_b32 s70, s34, 12
    s_add_u32 m0, s70, 132096
    s_nop 0
    buffer_load_dwordx4 v8, s[52:55], s69 offen  lds
    s_add_u32 s69, s72, 10240
    s_lshl_b32 s70, s34, 12
    s_add_u32 m0, s70, 133120
    s_nop 0
    buffer_load_dwordx4 v8, s[52:55], s69 offen  lds
    s_add_u32 s69, s72, 15360
    s_lshl_b32 s70, s34, 12
    s_add_u32 m0, s70, 134144
    s_nop 0
    buffer_load_dwordx4 v8, s[52:55], s69 offen  lds
    s_add_u32 s72, s71, 82944
    s_lshl_b32 s70, s34, 12
    s_add_u32 m0, s70, 147456
    s_nop 0
    buffer_load_dwordx4 v8, s[52:55], s72 offen  lds
    s_add_u32 s69, s72, 5120
    s_lshl_b32 s70, s34, 12
    s_add_u32 m0, s70, 148480
    s_nop 0
    buffer_load_dwordx4 v8, s[52:55], s69 offen  lds
    s_add_u32 s69, s72, 10240
    s_lshl_b32 s70, s34, 12
    s_add_u32 m0, s70, 149504
    s_nop 0
    buffer_load_dwordx4 v8, s[52:55], s69 offen  lds
    s_add_u32 s69, s72, 15360
    s_lshl_b32 s70, s34, 12
    s_add_u32 m0, s70, 150528
    s_nop 0
    buffer_load_dwordx4 v8, s[52:55], s69 offen  lds
    s_waitcnt vmcnt(36)
    s_barrier
    ds_read_b64_tr_b16 a[160:161], v16 offset:0
    ds_read_b64_tr_b16 a[162:163], v16 offset:1024
    ds_read_b64_tr_b16 a[164:165], v16 offset:4096
    ds_read_b64_tr_b16 a[166:167], v16 offset:5120
    ds_read_b64_tr_b16 a[168:169], v16 offset:8192
    ds_read_b64_tr_b16 a[170:171], v16 offset:9216
    ds_read_b64_tr_b16 a[172:173], v16 offset:12288
    ds_read_b64_tr_b16 a[174:175], v16 offset:13312
    s_waitcnt vmcnt(32)
    s_barrier
    ds_read_b64_tr_b16 a[176:177], v16 offset:16384
    ds_read_b64_tr_b16 a[178:179], v16 offset:17408
    ds_read_b64_tr_b16 a[180:181], v16 offset:20480
    ds_read_b64_tr_b16 a[182:183], v16 offset:21504
    ds_read_b64_tr_b16 a[184:185], v16 offset:24576
    ds_read_b64_tr_b16 a[186:187], v16 offset:25600
    ds_read_b64_tr_b16 a[188:189], v16 offset:28672
    ds_read_b64_tr_b16 a[190:191], v16 offset:29696
    s_waitcnt vmcnt(28)
    s_barrier
    ds_read_b64_tr_b16 a[192:193], v16 offset:32768
    ds_read_b64_tr_b16 a[194:195], v16 offset:33792
    ds_read_b64_tr_b16 a[196:197], v16 offset:36864
    ds_read_b64_tr_b16 a[198:199], v16 offset:37888
    ds_read_b64_tr_b16 a[200:201], v16 offset:40960
    ds_read_b64_tr_b16 a[202:203], v16 offset:41984
    ds_read_b64_tr_b16 a[204:205], v16 offset:45056
    ds_read_b64_tr_b16 a[206:207], v16 offset:46080
    s_waitcnt vmcnt(24)
    s_barrier
    ds_read_b64_tr_b16 a[208:209], v16 offset:49152
    ds_read_b64_tr_b16 a[210:211], v16 offset:50176
    ds_read_b64_tr_b16 a[212:213], v16 offset:53248
    ds_read_b64_tr_b16 a[214:215], v16 offset:54272
    ds_read_b64_tr_b16 a[216:217], v16 offset:57344
    ds_read_b64_tr_b16 a[218:219], v16 offset:58368
    ds_read_b64_tr_b16 a[220:221], v16 offset:61440
    ds_read_b64_tr_b16 a[222:223], v16 offset:62464
    s_waitcnt vmcnt(20)
    s_barrier
    ds_read_b64_tr_b16 a[224:225], v17 offset:0
    ds_read_b64_tr_b16 a[226:227], v17 offset:1024
    ds_read_b64_tr_b16 a[228:229], v17 offset:4096
    ds_read_b64_tr_b16 a[230:231], v17 offset:5120
    ds_read_b64_tr_b16 a[232:233], v17 offset:8192
    ds_read_b64_tr_b16 a[234:235], v17 offset:9216
    ds_read_b64_tr_b16 a[236:237], v17 offset:12288
    ds_read_b64_tr_b16 a[238:239], v17 offset:13312
    s_waitcnt vmcnt(16)
    s_barrier
    ds_read_b64_tr_b16 a[240:241], v17 offset:16384
    ds_read_b64_tr_b16 a[242:243], v17 offset:17408
    ds_read_b64_tr_b16 a[244:245], v17 offset:20480
    ds_read_b64_tr_b16 a[246:247], v17 offset:21504
    ds_read_b64_tr_b16 a[248:249], v17 offset:24576
    ds_read_b64_tr_b16 a[250:251], v17 offset:25600
    ds_read_b64_tr_b16 a[252:253], v17 offset:28672
    ds_read_b64_tr_b16 a[254:255], v17 offset:29696
    s_waitcnt vmcnt(12)
    s_barrier
    ds_read_b64_tr_b16 v[192:193], v17 offset:32768
    ds_read_b64_tr_b16 v[194:195], v17 offset:33792
    ds_read_b64_tr_b16 v[196:197], v17 offset:36864
    ds_read_b64_tr_b16 v[198:199], v17 offset:37888
    ds_read_b64_tr_b16 v[200:201], v17 offset:40960
    ds_read_b64_tr_b16 v[202:203], v17 offset:41984
    ds_read_b64_tr_b16 v[204:205], v17 offset:45056
    ds_read_b64_tr_b16 v[206:207], v17 offset:46080
    s_waitcnt vmcnt(8)
    s_barrier
    ds_read_b64_tr_b16 v[208:209], v17 offset:49152
    ds_read_b64_tr_b16 v[210:211], v17 offset:50176
    ds_read_b64_tr_b16 v[212:213], v17 offset:53248
    ds_read_b64_tr_b16 v[214:215], v17 offset:54272
    ds_read_b64_tr_b16 v[216:217], v17 offset:57344
    ds_read_b64_tr_b16 v[218:219], v17 offset:58368
    ds_read_b64_tr_b16 v[220:221], v17 offset:61440
    ds_read_b64_tr_b16 v[222:223], v17 offset:62464
    s_waitcnt vmcnt(4)
    s_barrier
    ds_read_b64_tr_b16 v[224:225], v18 offset:0
    ds_read_b64_tr_b16 v[226:227], v18 offset:1024
    ds_read_b64_tr_b16 v[228:229], v18 offset:4096
    ds_read_b64_tr_b16 v[230:231], v18 offset:5120
    ds_read_b64_tr_b16 v[232:233], v18 offset:8192
    ds_read_b64_tr_b16 v[234:235], v18 offset:9216
    ds_read_b64_tr_b16 v[236:237], v18 offset:12288
    ds_read_b64_tr_b16 v[238:239], v18 offset:13312
    s_waitcnt vmcnt(0)
    s_barrier
    ds_read_b64_tr_b16 v[240:241], v18 offset:16384
    ds_read_b64_tr_b16 v[242:243], v18 offset:17408
    ds_read_b64_tr_b16 v[244:245], v18 offset:20480
    ds_read_b64_tr_b16 v[246:247], v18 offset:21504
    ds_read_b64_tr_b16 v[248:249], v18 offset:24576
    ds_read_b64_tr_b16 v[250:251], v18 offset:25600
    ds_read_b64_tr_b16 v[252:253], v18 offset:28672
    ds_read_b64_tr_b16 v[254:255], v18 offset:29696
    s_waitcnt lgkmcnt(0)
    s_barrier
    s_mov_b32 s64, s26
    s_mov_b32 s65, s27
    s_mov_b32 s66, 0x280000
    s_mov_b32 s67, 0x20000
    v_bfe_u32 v2, v0, 0, 6
    v_lshlrev_b32 v4, 4, v2
    v_mov_b32 v5, v4
    v_bfe_u32 v2, v0, 6, 2
    v_lshlrev_b32 v6, 16, v2
    v_bfe_u32 v2, v0, 5, 1
    v_lshl_add_u32 v6, v2, 15, v6
    v_bfe_u32 v2, v0, 4, 1
    v_lshl_add_u32 v6, v2, 13, v6
    v_bfe_u32 v2, v0, 0, 4
    v_lshl_add_u32 v6, v2, 4, v6
    v_bfe_u32 v2, v0, 0, 6
    v_lshlrev_b32 v7, 6, v2
    s_mul_i32 s75, s35, 1280
    v_add_u32 v7, s75, v7
    v_cmp_gt_u32 vcc, 20, v0
    v_mov_b32 v2, 0x40000000
    s_nop 0
    v_cndmask_b32 v7, v2, v7, vcc
    v_bfe_u32 v2, v0, 0, 4
    s_mov_b32 s75, 1280
    v_mul_u32_u24 v8, s75, v2
    v_bfe_u32 v2, v0, 4, 1
    v_lshl_add_u32 v8, v2, 3, v8
    v_and_b32 v2, 32, v0
    v_cmp_ne_u32 vcc, 0, v2
    v_mov_b32 v3, 0x40000000
    s_nop 0
    v_cndmask_b32 v8, v8, v3, vcc
    v_cndmask_b32 v9, v4, v3, vcc
    v_and_b32 v2, 7, v0
    v_mov_b32 v1, 0x3f80
    v_mov_b32 v15, 0x3f800000
    v_mov_b32 v10, 0
    v_cmp_eq_u32 vcc, 0, v2
    s_nop 1
    v_cndmask_b32 v10, v10, v1, vcc
    v_cmp_eq_u32 vcc, 1, v2
    s_nop 1
    v_cndmask_b32 v10, v10, v15, vcc
    v_mov_b32 v11, 0
    v_cmp_eq_u32 vcc, 2, v2
    s_nop 1
    v_cndmask_b32 v11, v11, v1, vcc
    v_cmp_eq_u32 vcc, 3, v2
    s_nop 1
    v_cndmask_b32 v11, v11, v15, vcc
    v_mov_b32 v12, 0
    v_cmp_eq_u32 vcc, 4, v2
    s_nop 1
    v_cndmask_b32 v12, v12, v1, vcc
    v_cmp_eq_u32 vcc, 5, v2
    s_nop 1
    v_cndmask_b32 v12, v12, v15, vcc
    v_mov_b32 v13, 0
    v_cmp_eq_u32 vcc, 6, v2
    s_nop 1
    v_cndmask_b32 v13, v13, v1, vcc
    v_cmp_eq_u32 vcc, 7, v2
    s_nop 1
    v_cndmask_b32 v13, v13, v15, vcc
    v_bfe_u32 v2, v0, 4, 2
    v_cmp_eq_u32 vcc, 3, v2
    s_nop 1
    v_cndmask_b32 v14, v4, v3, vcc
    s_and_b32 s83, s36, 1
    s_mul_i32 s69, s83, 2621440
    s_add_u32 s69, s69, 0x4000000
    s_lshl_b32 s70, s35, 8
    s_add_u32 s84, s69, s70
    s_mov_b32 s85, s69
    s_mov_b32 s20, 0
    s_lshl_b32 s69, s83, 7
    s_add_u32 s21, s69, 0x3000
    s_lshl_b32 s70, s35, 2
    s_add_u32 s22, s21, s70
    s_lshl_b32 s69, s83, 12
    s_lshl_b32 s70, s35, 7
    s_add_u32 s69, s69, s70
    s_add_u32 s23, s69, 0x4000
    s_mul_i32 s81, s83, 40960
    s_mov_b32 s24, s81
    s_add_u32 s81, s81, 0x100000
    s_mul_i32 s25, s83, 81920
    s_add_u32 s25, s25, 0x1400000
    s_mov_b32 s82, 0
    s_mov_b32 s80, 0
    v_mov_b32 v145, 0xa000
    v_bfe_u32 v2, v0, 4, 1
    v_lshl_add_u32 v145, v2, 12, v145
    v_bfe_u32 v2, v0, 6, 2
    v_lshl_add_u32 v145, v2, 10, v145
    v_bfe_u32 v2, v0, 5, 1
    v_lshl_add_u32 v145, v2, 9, v145
    v_bfe_u32 v2, v0, 0, 4
    v_lshl_add_u32 v145, v2, 4, v145
    v_mov_b32 v146, 0xc000
    v_bfe_u32 v2, v0, 7, 1
    v_lshl_add_u32 v146, v2, 12, v146
    v_bfe_u32 v2, v0, 5, 1
    v_lshl_add_u32 v146, v2, 9, v146
    v_bfe_u32 v2, v0, 6, 1
    v_lshl_add_u32 v146, v2, 8, v146
    v_bfe_u32 v2, v0, 0, 4
    v_lshl_add_u32 v146, v2, 4, v146
    v_bfe_u32 v2, v0, 4, 1
    v_lshl_add_u32 v146, v2, 3, v146
    v_mov_b32 v147, 0xff800000
    v_mov_b32 v148, 0x3f803f80
    v_mov_b32 v149, 0x3f803f80
    v_mov_b32 v150, 0x3f803f80
    v_mov_b32 v151, 0x3f803f80
    v_mov_b32 v155, 0
    v_bfe_u32 v2, v0, 0, 4
    v_lshlrev_b32 v1, 0, v2
    v_bfe_u32 v2, v0, 6, 1
    v_lshl_add_u32 v1, v2, 4, v1
    v_bfe_u32 v2, v0, 4, 2
    v_lshlrev_b32 v2, 2, v2
    v_sub_u32 v1, v1, v2
    v_cmp_gt_i32 s[4:5], 0, v1
    v_cmp_gt_i32 s[6:7], 1, v1
    v_cmp_gt_i32 s[8:9], 2, v1
    v_cmp_gt_i32 s[10:11], 3, v1
    v_cmp_gt_i32 s[12:13], 16, v1
    v_cmp_gt_i32 s[14:15], 17, v1
    v_cmp_gt_i32 s[16:17], 18, v1
    v_cmp_gt_i32 s[18:19], 19, v1
    s_mov_b32 s100, 0x3e0293ee
    s_mov_b32 s101, 0x3e0293ee
    s_lshl_b32 s69, s83, 5
    s_add_u32 s69, s69, s35
    s_lshl_b32 s26, s69, 13
    s_lshl_b32 s70, s34, 11
    s_add_u32 s26, s26, s70
    s_lshl_b32 s31, s69, 12
    s_add_u32 s31, s31, 0x700000
    s_lshl_b32 s32, s69, 11
    s_lshr_b32 s70, s34, 1
    s_lshl_b32 s70, s70, 10
    s_add_u32 s32, s32, s70
    s_add_u32 s32, s32, 0xf00000
    s_lshl_b32 s69, s35, 7
    s_add_u32 s28, s69, 0x1000
    s_add_u32 s29, s69, 0x2000
    s_mov_b32 s27, 0
    s_mov_b32 s30, 0
    s_mov_b32 s62, 0
    s_cmp_lg_u32 s34, 0
    s_cbranch_scc1 W0_96
    v_bfe_u32 v2, v0, 0, 6
    v_lshlrev_b32 v1, 3, v2
    s_mov_b32 s38, 262144
PL_97:
    buffer_load_dwordx2 v[2:3], v1, s[40:43], 0 offen sc1
    s_waitcnt vmcnt(0)
    v_min_u32 v2, v2, v3
    v_cmp_eq_u32 vcc, 0, v2
    s_cbranch_vccnz PN_98
    s_branch PO_99
PN_98:
    s_sleep 2
    s_sub_u32 s38, s38, 1
    s_cbranch_scc0 PL_97
    s_mov_b32 s68, 3
    s_branch FAIL
PO_99:
W0_96:
    s_barrier
    s_mul_i32 s69, s34, 10240
    s_add_u32 s70, s69, s82
    s_add_u32 s69, s69, s81
    s_mov_b32 m0, s70
    s_nop 0
    buffer_load_dwordx4 v4, s[40:43], s69 offen sc1 lds
    buffer_load_dwordx4 v4, s[40:43], s69 offen offset:1024 sc1 lds
    buffer_load_dwordx4 v4, s[40:43], s69 offen offset:2048 sc1 lds
    buffer_load_dwordx4 v4, s[40:43], s69 offen offset:3072 sc1 lds
    s_add_u32 s69, s69, 4096
    s_add_u32 s70, s70, 4096
    s_mov_b32 m0, s70
    s_nop 0
    buffer_load_dwordx4 v4, s[40:43], s69 offen sc1 lds
    buffer_load_dwordx4 v4, s[40:43], s69 offen offset:1024 sc1 lds
    buffer_load_dwordx4 v4, s[40:43], s69 offen offset:2048 sc1 lds
    buffer_load_dwordx4 v4, s[40:43], s69 offen offset:3072 sc1 lds
    s_add_u32 s69, s69, 4096
    s_add_u32 s70, s70, 4096
    s_mov_b32 m0, s70
    s_nop 0
    buffer_load_dwordx4 v4, s[40:43], s69 offen sc1 lds
    buffer_load_dwordx4 v4, s[40:43], s69 offen offset:1024 sc1 lds
    s_add_u32 s69, s81, 81920
    buffer_load_dword v144, v7, s[40:43], s69 offen
    s_add_u32 s69, s81, 163840
    buffer_load_dword v144, v7, s[40:43], s69 offen
    s_waitcnt vmcnt(2)
    s_barrier
    s_cmp_lg_u32 s37, 0
    s_cbranch_scc1 QAO_LOOP_safe
QAO_LOOP_fast:
    s_lshl_b32 s69, s80, 1
    s_add_u32 s69, s69, s83
    s_cmp_gt_u32 s27, s69
    s_cbranch_scc1 PRG_100
    s_mov_b32 s38, 262144
PL_101:
    buffer_load_dwordx2 v[2:3], off, s[40:43], s28 sc1
    s_waitcnt vmcnt(0)
    v_min_u32 v2, v2, v3
    s_nop 0
    v_readfirstlane_b32 s27, v2
    s_cmp_le_u32 s27, s69
    s_cbranch_scc1 PN_102
    s_branch PO_103
PN_102:
    s_sleep 1
    s_sub_u32 s38, s38, 1
    s_cbranch_scc0 PL_101
    s_mov_b32 s68, 40
    s_branch FAIL
PO_103:
PRG_100:
    s_lshl_b32 s70, s34, 11
    s_add_u32 s69, s26, 0x2000000
    s_add_u32 m0, s70, 110592
    s_nop 0
    buffer_load_dwordx4 v4, s[40:43], s69 offen sc1 nt lds
    buffer_load_dwordx4 v4, s[40:43], s69 offen offset:1024 sc1 nt lds
    s_add_u32 s69, s26, 0x3000000
    s_add_u32 m0, s70, 118784
    s_nop 0
    buffer_load_dwordx4 v4, s[40:43], s69 offen sc1 nt lds
    buffer_load_dwordx4 v4, s[40:43], s69 offen offset:1024 sc1 nt lds
    s_lshl_b32 s69, s80, 1
    s_add_u32 s69, s69, s83
    s_cmp_gt_u32 s30, s69
    s_cselect_b32 s63, 1, 0
    s_cbranch_scc0 KME_104
    v_lshrrev_b32 v1, 2, v4
    buffer_load_dwordx4 v[116:119], v4, s[40:43], s31 offen offset:0 sc1 nt
    buffer_load_dwordx4 v[120:123], v4, s[40:43], s31 offen offset:1024 sc1 nt
    buffer_load_dwordx4 v[124:127], v4, s[40:43], s31 offen offset:2048 sc1 nt
    buffer_load_dwordx4 v[128:131], v4, s[40:43], s31 offen offset:3072 sc1 nt
    buffer_load_dword v132, v1, s[40:43], s32 offen offset:0 sc1 nt
    v_mov_b32 v133, 0
    buffer_load_dword v134, v1, s[40:43], s32 offen offset:256 sc1 nt
    v_mov_b32 v135, 0
    buffer_load_dword v136, v1, s[40:43], s32 offen offset:512 sc1 nt
    v_mov_b32 v137, 0
    buffer_load_dword v138, v1, s[40:43], s32 offen offset:768 sc1 nt
    v_mov_b32 v139, 0
KME_104:
    s_cmp_lt_u32 s80, 31
    s_cselect_b32 s69, 81920, 0
    s_add_u32 s81, s81, s69
    s_xor_b32 s82, s82, 0x10000
    ds_read_b128 v[48:51], v5 offset:0
    ds_read_b128 v[52:55], v5 offset:1024
    ds_read_b128 v[56:59], v5 offset:2048
    ds_read_b128 v[60:63], v5 offset:3072
    s_waitcnt lgkmcnt(3)
    v_mfma_f32_32x32x16_bf16 v[16:31], a[0:3], v[48:51], 0
    s_mul_i32 s72, s34, 10240
    s_add_u32 s73, s72, s82
    s_add_u32 s72, s72, s81
    s_mov_b32 m0, s73
    s_nop 0
    buffer_load_dwordx4 v4, s[40:43], s72 offen sc1 lds
    ds_read_b128 v[48:51], v5 offset:4096
    s_waitcnt lgkmcnt(3)
    v_mfma_f32_32x32x16_bf16 v[16:31], a[4:7], v[52:55], v[16:31]
    ds_read_b128 v[52:55], v5 offset:5120
    s_waitcnt lgkmcnt(3)
    v_mfma_f32_32x32x16_bf16 v[16:31], a[8:11], v[56:59], v[16:31]
    buffer_load_dwordx4 v4, s[40:43], s72 offen offset:1024 sc1 lds
    ds_read_b128 v[56:59], v5 offset:6144
    s_waitcnt lgkmcnt(3)
    v_mfma_f32_32x32x16_bf16 v[16:31], a[12:15], v[60:63], v[16:31]
    ds_read_b128 v[60:63], v5 offset:7168
    s_waitcnt lgkmcnt(3)
    v_mfma_f32_32x32x16_bf16 v[16:31], a[16:19], v[48:51], v[16:31]
    buffer_load_dwordx4 v4, s[40:43], s72 offen offset:2048 sc1 lds
    ds_read_b128 v[48:51], v5 offset:8192
    s_waitcnt lgkmcnt(3)
    v_mfma_f32_32x32x16_bf16 v[16:31], a[20:23], v[52:55], v[16:31]
    ds_read_b128 v[52:55], v5 offset:9216
    s_waitcnt lgkmcnt(3)
    v_mfma_f32_32x32x16_bf16 v[16:31], a[24:27], v[56:59], v[16:31]
    buffer_load_dwordx4 v4, s[40:43], s72 offen offset:3072 sc1 lds
    ds_read_b128 v[56:59], v5 offset:10240
    s_waitcnt lgkmcnt(3)
    v_mfma_f32_32x32x16_bf16 v[16:31], a[28:31], v[60:63], v[16:31]
    ds_read_b128 v[60:63], v5 offset:11264
    s_waitcnt lgkmcnt(3)
    v_mfma_f32_32x32x16_bf16 v[16:31], a[32:35], v[48:51], v[16:31]
    s_add_u32 s73, s73, 4096
    s_mov_b32 m0, s73
    s_add_u32 s72, s72, 4096
    buffer_load_dwordx4 v4, s[40:43], s72 offen sc1 lds
    ds_read_b128 v[48:51], v5 offset:12288
    s_waitcnt lgkmcnt(3)
    v_mfma_f32_32x32x16_bf16 v[16:31], a[36:39], v[52:55], v[16:31]
    ds_read_b128 v[52:55], v5 offset:13312
    s_waitcnt lgkmcnt(3)
    v_mfma_f32_32x32x16_bf16 v[16:31], a[40:43], v[56:59], v[16:31]
    buffer_load_dwordx4 v4, s[40:43], s72 offen offset:1024 sc1 lds
    ds_read_b128 v[56:59], v5 offset:14336
    s_waitcnt lgkmcnt(3)
    v_mfma_f32_32x32x16_bf16 v[16:31], a[44:47], v[60:63], v[16:31]
    ds_read_b128 v[60:63], v5 offset:15360
    s_waitcnt lgkmcnt(3)
    v_mfma_f32_32x32x16_bf16 v[16:31], a[48:51], v[48:51], v[16:31]
    buffer_load_dwordx4 v4, s[40:43], s72 offen offset:2048 sc1 lds
    ds_read_b128 v[48:51], v5 offset:16384
    s_waitcnt lgkmcnt(3)
    v_mfma_f32_32x32x16_bf16 v[16:31], a[52:55], v[52:55], v[16:31]
    ds_read_b128 v[52:55], v5 offset:17408
    s_waitcnt lgkmcnt(3)
    v_mfma_f32_32x32x16_bf16 v[16:31], a[56:59], v[56:59], v[16:31]
    buffer_load_dwordx4 v4, s[40:43], s72 offen offset:3072 sc1 lds
    ds_read_b128 v[56:59], v5 offset:18432
    s_waitcnt lgkmcnt(3)
    v_mfma_f32_32x32x16_bf16 v[16:31], a[60:63], v[60:63], v[16:31]
    ds_read_b128 v[60:63], v5 offset:19456
    s_waitcnt lgkmcnt(3)
    v_mfma_f32_32x32x16_bf16 v[16:31], a[64:67], v[48:51], v[16:31]
    s_add_u32 s73, s73, 4096
    s_mov_b32 m0, s73
    s_add_u32 s72, s72, 4096
    buffer_load_dwordx4 v4, s[40:43], s72 offen sc1 lds
    ds_read_b128 v[48:51], v5 offset:20480
    s_waitcnt lgkmcnt(3)
    v_mfma_f32_32x32x16_bf16 v[16:31], a[68:71], v[52:55], v[16:31]
    ds_read_b128 v[52:55], v5 offset:21504
    s_waitcnt lgkmcnt(3)
    v_mfma_f32_32x32x16_bf16 v[16:31], a[72:75], v[56:59], v[16:31]
    buffer_load_dwordx4 v4, s[40:43], s72 offen offset:1024 sc1 lds
    ds_read_b128 v[56:59], v5 offset:22528
    s_waitcnt lgkmcnt(3)
    v_mfma_f32_32x32x16_bf16 v[16:31], a[76:79], v[60:63], v[16:31]
    ds_read_b128 v[60:63], v5 offset:23552
    s_waitcnt lgkmcnt(3)
    v_mfma_f32_32x32x16_bf16 v[16:31], a[80:83], v[48:51], v[16:31]
    ds_read_b128 v[48:51], v5 offset:24576
    s_waitcnt lgkmcnt(3)
    v_mfma_f32_32x32x16_bf16 v[16:31], a[84:87], v[52:55], v[16:31]
    s_waitcnt vmcnt(14)
    s_barrier
    s_cmp_lg_u32 s34, 0
    s_cbranch_scc1 W0_105
    v_mov_b32 v1, s80
    s_mov_b64 exec, 1
    buffer_store_dword v1, off, s[40:43], s22
    s_mov_b64 exec, -1
W0_105:
    ds_read_b128 v[52:55], v5 offset:25600
    s_waitcnt lgkmcnt(3)
    v_mfma_f32_32x32x16_bf16 v[16:31], a[88:91], v[56:59], v[16:31]
    ds_read_b128 v[56:59], v5 offset:26624
    s_waitcnt lgkmcnt(3)
    v_mfma_f32_32x32x16_bf16 v[16:31], a[92:95], v[60:63], v[16:31]
    ds_read_b128 v[60:63], v5 offset:27648
    s_waitcnt lgkmcnt(3)
    v_mfma_f32_32x32x16_bf16 v[16:31], a[96:99], v[48:51], v[16:31]
    ds_read_b128 v[48:51], v5 offset:28672
    s_waitcnt lgkmcnt(3)
    v_mfma_f32_32x32x16_bf16 v[16:31], a[100:103], v[52:55], v[16:31]
    ds_read_b128 v[52:55], v5 offset:29696
    s_waitcnt lgkmcnt(3)
    v_mfma_f32_32x32x16_bf16 v[16:31], a[104:107], v[56:59], v[16:31]
    ds_read_b128 v[56:59], v5 offset:30720
    s_waitcnt lgkmcnt(3)
    v_mfma_f32_32x32x16_bf16 v[16:31], a[108:111], v[60:63], v[16:31]
    ds_read_b128 v[60:63], v5 offset:31744
    s_waitcnt lgkmcnt(3)
    v_mfma_f32_32x32x16_bf16 v[16:31], a[112:115], v[48:51], v[16:31]
    ds_read_b128 v[48:51], v5 offset:32768
    s_waitcnt lgkmcnt(3)
    v_mfma_f32_32x32x16_bf16 v[16:31], a[116:119], v[52:55], v[16:31]
    ds_read_b128 v[52:55], v5 offset:33792
    s_waitcnt lgkmcnt(3)
    v_mfma_f32_32x32x16_bf16 v[16:31], a[120:123], v[56:59], v[16:31]
    ds_read_b128 v[56:59], v5 offset:34816
    s_waitcnt lgkmcnt(3)
    v_mfma_f32_32x32x16_bf16 v[16:31], a[124:127], v[60:63], v[16:31]
    ds_read_b128 v[60:63], v5 offset:35840
    s_waitcnt lgkmcnt(3)
    v_mfma_f32_32x32x16_bf16 v[16:31], a[128:131], v[48:51], v[16:31]
    ds_read_b128 v[48:51], v5 offset:36864
    s_waitcnt lgkmcnt(3)
    v_mfma_f32_32x32x16_bf16 v[16:31], a[132:135], v[52:55], v[16:31]
    ds_read_b128 v[52:55], v5 offset:37888
    s_waitcnt lgkmcnt(3)
    v_mfma_f32_32x32x16_bf16 v[16:31], a[136:139], v[56:59], v[16:31]
    ds_read_b128 v[56:59], v5 offset:38912
    s_waitcnt lgkmcnt(3)
    v_mfma_f32_32x32x16_bf16 v[16:31], a[140:143], v[60:63], v[16:31]
    ds_read_b128 v[60:63], v5 offset:39936
    s_waitcnt lgkmcnt(3)
    v_mfma_f32_32x32x16_bf16 v[16:31], a[144:147], v[48:51], v[16:31]
    s_waitcnt lgkmcnt(2)
    v_mfma_f32_32x32x16_bf16 v[16:31], a[148:151], v[52:55], v[16:31]
    s_waitcnt lgkmcnt(1)
    v_mfma_f32_32x32x16_bf16 v[16:31], a[152:155], v[56:59], v[16:31]
    s_waitcnt lgkmcnt(0)
    v_mfma_f32_32x32x16_bf16 v[16:31], a[156:159], v[60:63], v[16:31]
    s_nop 11
    v_cvt_pk_bf16_f32 v64, v16, v17
    v_cvt_pk_bf16_f32 v65, v18, v19
    v_cvt_pk_bf16_f32 v66, v20, v21
    v_cvt_pk_bf16_f32 v67, v22, v23
    v_cvt_pk_bf16_f32 v68, v24, v25
    v_cvt_pk_bf16_f32 v69, v26, v27
    v_cvt_pk_bf16_f32 v70, v28, v29
    v_cvt_pk_bf16_f32 v71, v30, v31
    ds_write_b128 v145, v[64:67]
    ds_write_b128 v145, v[68:71] offset:256
    s_and_b32 s69, s34, 1
    s_lshl_b32 s69, s69, 12
    v_add_u32 v1, s69, v4
    v_add_u32 v3, 110592, v4
    s_lshr_b32 s69, s34, 1
    s_lshl_b32 s69, s69, 12
    s_add_u32 s69, s69, 118784
    v_add_u32 v15, s69, v4
    s_waitcnt vmcnt(10) lgkmcnt(0)
    s_barrier
    ds_read_b128 v[72:75], v1 offset:40960
    ds_read_b128 v[76:79], v1 offset:41984
    ds_read_b128 v[80:83], v1 offset:43008
    ds_read_b128 v[84:87], v1 offset:44032
    ds_read_b128 v[88:91], v3 offset:0
    ds_read_b128 v[92:95], v3 offset:4096
    ds_read_b128 v[96:99], v3 offset:1024
    ds_read_b128 v[100:103], v3 offset:5120
    ds_read_b128 v[160:163], v15 offset:0
    ds_read_b128 v[164:167], v15 offset:1024
    ds_read_b128 v[168:171], v15 offset:2048
    ds_read_b128 v[172:175], v15 offset:3072
    s_waitcnt lgkmcnt(11)
    s_waitcnt lgkmcnt(7)
    v_mfma_f32_16x16x32_bf16 v[104:107], v[88:91], v[72:75], 0
    ds_read_b128 v[88:91], v3 offset:2048
    s_waitcnt lgkmcnt(7)
    v_mfma_f32_16x16x32_bf16 v[108:111], v[92:95], v[72:75], 0
    ds_read_b128 v[92:95], v3 offset:6144
    s_waitcnt lgkmcnt(7)
    v_mfma_f32_16x16x32_bf16 v[104:107], v[96:99], v[76:79], v[104:107]
    ds_read_b128 v[96:99], v3 offset:3072
    s_waitcnt lgkmcnt(7)
    v_mfma_f32_16x16x32_bf16 v[108:111], v[100:103], v[76:79], v[108:111]
    ds_read_b128 v[100:103], v3 offset:7168
    s_waitcnt lgkmcnt(3)
    v_mfma_f32_16x16x32_bf16 v[104:107], v[88:91], v[80:83], v[104:107]
    s_waitcnt lgkmcnt(2)
    v_mfma_f32_16x16x32_bf16 v[108:111], v[92:95], v[80:83], v[108:111]
    s_waitcnt lgkmcnt(1)
    v_mfma_f32_16x16x32_bf16 v[104:107], v[96:99], v[84:87], v[104:107]
    s_waitcnt lgkmcnt(0)
    v_mfma_f32_16x16x32_bf16 v[108:111], v[100:103], v[84:87], v[108:111]
    s_waitcnt lgkmcnt(0)
    s_cmp_eq_u32 s80, 0
    s_cbranch_scc1 N0_106
    s_add_u32 s69, s80, 0
    v_and_b32 v1, 31, v0
    v_lshlrev_b32 v1, 2, v1
    s_mov_b32 s38, 262144
PL_107:
    buffer_load_dword v2, v1, s[40:43], s21 offen sc1
    s_waitcnt vmcnt(0)
    v_cmp_gt_u32 vcc, s69, v2
    s_cbranch_vccnz PN_108
    s_branch PO_109
PN_108:
    s_sleep 1
    s_sub_u32 s38, s38, 1
    s_cbranch_scc0 PL_107
    s_mov_b32 s68, 43
    s_branch FAIL
PO_109:
    s_add_u32 s69, s80, 0
    s_cmp_ge_u32 s62, s69
    s_cbranch_scc1 BOK_110
    s_mov_b32 s38, 262144
PL_111:
    buffer_load_dword v2, off, s[40:43], s23 sc1
    s_waitcnt vmcnt(0)
    v_readfirstlane_b32 s62, v2
    s_cmp_lt_u32 s62, s69
    s_cbranch_scc1 PN_112
    s_branch PO_113
PN_112:
    s_sleep 1
    s_sub_u32 s38, s38, 1
    s_cbranch_scc0 PL_111
    s_mov_b32 s68, 42
    s_branch FAIL
PO_113:
BOK_110:
    s_add_u32 s73, s56, 4096
    buffer_load_dwordx4 v[48:51], v4, s[40:43], s56 offen offset:0 sc1
    buffer_load_dwordx4 v[52:55], v4, s[40:43], s56 offen offset:1024 sc1
    buffer_load_dwordx4 v[56:59], v4, s[40:43], s56 offen offset:2048 sc1
    buffer_load_dwordx4 v[60:63], v4, s[40:43], s56 offen offset:3072 sc1
    buffer_load_dwordx4 v[176:179], v4, s[40:43], s73 offen offset:0 sc1
    buffer_load_dwordx4 v[180:183], v4, s[40:43], s73 offen offset:1024 sc1
    buffer_load_dwordx4 v[184:187], v4, s[40:43], s73 offen offset:2048 sc1
    buffer_load_dwordx4 v[188:191], v4, s[40:43], s73 offen offset:3072 sc1
    buffer_load_dwordx4 v[36:39], v9, s[40:43], s58 offen sc1
N0_106:
    s_cmp_lg_u32 s63, 0
    s_cbranch_scc1 KML_114
    s_lshl_b32 s69, s80, 1
    s_add_u32 s69, s69, s83
    s_cmp_gt_u32 s30, s69
    s_cbranch_scc1 PRG_116
    s_mov_b32 s38, 262144
PL_117:
    buffer_load_dwordx2 v[2:3], off, s[40:43], s29 sc1
    s_waitcnt vmcnt(0)
    v_min_u32 v2, v2, v3
    s_nop 0
    v_readfirstlane_b32 s30, v2
    s_cmp_le_u32 s30, s69
    s_cbranch_scc1 PN_118
    s_branch PO_119
PN_118:
    s_sleep 1
    s_sub_u32 s38, s38, 1
    s_cbranch_scc0 PL_117
    s_mov_b32 s68, 41
    s_branch FAIL
PO_119:
PRG_116:
    v_lshrrev_b32 v1, 2, v4
    buffer_load_dwordx4 v[116:119], v4, s[40:43], s31 offen offset:0 sc1 nt
    buffer_load_dwordx4 v[120:123], v4, s[40:43], s31 offen offset:1024 sc1 nt
    buffer_load_dwordx4 v[124:127], v4, s[40:43], s31 offen offset:2048 sc1 nt
    buffer_load_dwordx4 v[128:131], v4, s[40:43], s31 offen offset:3072 sc1 nt
    buffer_load_dword v132, v1, s[40:43], s32 offen offset:0 sc1 nt
    v_mov_b32 v133, 0
    buffer_load_dword v134, v1, s[40:43], s32 offen offset:256 sc1 nt
    v_mov_b32 v135, 0
    buffer_load_dword v136, v1, s[40:43], s32 offen offset:512 sc1 nt
    v_mov_b32 v137, 0
    buffer_load_dword v138, v1, s[40:43], s32 offen offset:768 sc1 nt
    v_mov_b32 v139, 0
KML_114:
    v_cndmask_b32 v104, v104, v147, s[4:5]
    v_cndmask_b32 v105, v105, v147, s[6:7]
    v_cndmask_b32 v106, v106, v147, s[8:9]
    v_cndmask_b32 v107, v107, v147, s[10:11]
    v_cndmask_b32 v108, v108, v147, s[12:13]
    v_cndmask_b32 v109, v109, v147, s[14:15]
    v_cndmask_b32 v110, v110, v147, s[16:17]
    v_cndmask_b32 v111, v111, v147, s[18:19]
    v_max3_f32 v156, v104, v105, v106
    v_max3_f32 v157, v108, v109, v110
    v_max3_f32 v156, v156, v107, v111
    s_waitcnt vmcnt(7)
    v_mfma_f32_16x16x32_bf16 v[112:115], v[116:119], v[72:75], 0
    s_waitcnt vmcnt(6)
    v_mfma_f32_16x16x32_bf16 v[112:115], v[120:123], v[76:79], v[112:115]
    s_waitcnt vmcnt(5)
    v_mfma_f32_16x16x32_bf16 v[112:115], v[124:127], v[80:83], v[112:115]
    s_waitcnt vmcnt(4)
    v_mfma_f32_16x16x32_bf16 v[112:115], v[128:131], v[84:87], v[112:115]
    s_nop 7
    v_max3_f32 v157, v157, v112, v113
    v_max_f32 v156, v156, v157
    v_mov_b32 v157, v156
    s_nop 1
    v_permlane16_swap_b32 v156, v157
    v_max_f32 v156, v156, v157
    v_mov_b32 v157, v156
    s_nop 1
    v_permlane32_swap_b32 v156, v157
    v_max_f32 v156, v156, v157
    v_mul_f32 v156, s100, v156
    v_fma_f32 v104, v104, s100, -v156
    v_fma_f32 v105, v105, s100, -v156
    v_fma_f32 v106, v106, s100, -v156
    v_fma_f32 v107, v107, s100, -v156
    v_fma_f32 v108, v108, s100, -v156
    v_fma_f32 v109, v109, s100, -v156
    v_fma_f32 v110, v110, s100, -v156
    v_fma_f32 v111, v111, s100, -v156
    v_fma_f32 v112, v112, s100, -v156
    v_fma_f32 v113, v113, s100, -v156
    v_exp_f32 v104, v104
    v_exp_f32 v105, v105
    v_exp_f32 v106, v106
    v_exp_f32 v107, v107
    v_exp_f32 v108, v108
    v_exp_f32 v109, v109
    v_exp_f32 v110, v110
    v_exp_f32 v111, v111
    v_exp_f32 v112, v112
    v_exp_f32 v113, v113
    v_cvt_pk_bf16_f32 v140, v104, v105
    v_cvt_pk_bf16_f32 v141, v106, v107
    v_cvt_pk_bf16_f32 v142, v108, v109
    v_cvt_pk_bf16_f32 v143, v110, v111
    v_cvt_pk_bf16_f32 v154, v112, v113
    s_waitcnt vmcnt(0)
    v_mfma_f32_16x16x32_bf16 v[32:35], v[148:151], v[140:143], 0
    v_mfma_f32_16x16x32_bf16 v[16:19], v[160:163], v[140:143], 0
    v_mfma_f32_16x16x32_bf16 v[20:23], v[164:167], v[140:143], 0
    v_mfma_f32_16x16x32_bf16 v[24:27], v[168:171], v[140:143], 0
    v_mfma_f32_16x16x32_bf16 v[28:31], v[172:175], v[140:143], 0
    v_mfma_f32_16x16x16_bf16 v[32:35], v[148:149], v[154:155], v[32:35]
    v_mfma_f32_16x16x16_bf16 v[16:19], v[132:133], v[154:155], v[16:19]
    v_mfma_f32_16x16x16_bf16 v[20:23], v[134:135], v[154:155], v[20:23]
    v_mfma_f32_16x16x16_bf16 v[24:27], v[136:137], v[154:155], v[24:27]
    v_mfma_f32_16x16x16_bf16 v[28:31], v[138:139], v[154:155], v[28:31]
    v_rcp_f32 v156, v32
    s_nop 0
    v_pk_mul_f32 v[16:17], v[16:17], v[156:157] op_sel_hi:[1,0]
    v_pk_mul_f32 v[18:19], v[18:19], v[156:157] op_sel_hi:[1,0]
    v_cvt_pk_bf16_f32 v64, v16, v17
    v_cvt_pk_bf16_f32 v65, v18, v19
    ds_write_b64 v146, v[64:65] offset:0
    v_pk_mul_f32 v[20:21], v[20:21], v[156:157] op_sel_hi:[1,0]
    v_pk_mul_f32 v[22:23], v[22:23], v[156:157] op_sel_hi:[1,0]
    v_cvt_pk_bf16_f32 v66, v20, v21
    v_cvt_pk_bf16_f32 v67, v22, v23
    ds_write_b64 v146, v[66:67] offset:1024
    v_pk_mul_f32 v[24:25], v[24:25], v[156:157] op_sel_hi:[1,0]
    v_pk_mul_f32 v[26:27], v[26:27], v[156:157] op_sel_hi:[1,0]
    v_cvt_pk_bf16_f32 v68, v24, v25
    v_cvt_pk_bf16_f32 v69, v26, v27
    ds_write_b64 v146, v[68:69] offset:2048
    v_pk_mul_f32 v[28:29], v[28:29], v[156:157] op_sel_hi:[1,0]
    v_pk_mul_f32 v[30:31], v[30:31], v[156:157] op_sel_hi:[1,0]
    v_cvt_pk_bf16_f32 v70, v28, v29
    v_cvt_pk_bf16_f32 v71, v30, v31
    ds_write_b64 v146, v[70:71] offset:3072
    s_cmp_eq_u32 s80, 0
    s_cbranch_scc1 N1_120
    s_cmp_eq_u32 s80, 99
    s_cbranch_scc1 N1_120
    v_mfma_f32_16x16x32_bf16 v[44:47], v[10:13], v[48:51], 0
    v_mfma_f32_16x16x32_bf16 v[44:47], v[10:13], v[52:55], v[44:47]
    v_mfma_f32_16x16x32_bf16 v[44:47], v[10:13], v[56:59], v[44:47]
    v_mfma_f32_16x16x32_bf16 v[44:47], v[10:13], v[60:63], v[44:47]
    v_mfma_f32_16x16x32_bf16 v[44:47], v[10:13], v[176:179], v[44:47]
    v_mfma_f32_16x16x32_bf16 v[44:47], v[10:13], v[180:183], v[44:47]
    v_mfma_f32_16x16x32_bf16 v[44:47], v[10:13], v[184:187], v[44:47]
    v_mfma_f32_16x16x32_bf16 v[44:47], v[10:13], v[188:191], v[44:47]
    s_nop 7
    v_pk_add_f32 v[44:45], v[44:45], v[36:37]
    v_pk_add_f32 v[46:47], v[46:47], v[38:39]
    v_cvt_pk_bf16_f32 v44, v44, v45
    v_cvt_pk_bf16_f32 v45, v46, v47
    buffer_store_dwordx2 v[44:45], v8, s[64:67], s57 offen
N1_120:
    s_waitcnt lgkmcnt(0)
    s_barrier
    ds_read_b128 v[72:75], v4 offset:49152
    ds_read_b128 v[76:79], v4 offset:50176
    ds_read_b128 v[80:83], v4 offset:51200
    ds_read_b128 v[84:87], v4 offset:52224
    ds_read_b128 v[88:91], v4 offset:53248
    ds_read_b128 v[92:95], v4 offset:54272
    ds_read_b128 v[96:99], v4 offset:55296
    ds_read_b128 v[100:103], v4 offset:56320
    s_add_u32 s69, s81, 163840
    buffer_load_dword v144, v7, s[40:43], s69 offen
    s_cmp_lg_u32 s34, 0
    s_cselect_b32 s63, 0, s80
    s_cmp_eq_u32 s80, 99
    s_cselect_b32 s63, 0, s63
    s_cmp_eq_u32 s63, 0
    s_cbranch_scc1 N2_121
    buffer_load_dwordx4 v[160:163], v9, s[40:43], s61 offen sc1
    s_add_u32 s73, s59, 4096
    buffer_load_dwordx4 v[104:107], v4, s[40:43], s59 offen offset:0 sc1
    buffer_load_dwordx4 v[108:111], v4, s[40:43], s59 offen offset:1024 sc1
    buffer_load_dwordx4 v[112:115], v4, s[40:43], s59 offen offset:2048 sc1
    buffer_load_dwordx4 v[116:119], v4, s[40:43], s59 offen offset:3072 sc1
    buffer_load_dwordx4 v[120:123], v4, s[40:43], s73 offen offset:0 sc1
    buffer_load_dwordx4 v[124:127], v4, s[40:43], s73 offen offset:1024 sc1
    buffer_load_dwordx4 v[128:131], v4, s[40:43], s73 offen offset:2048 sc1
    buffer_load_dwordx4 v[132:135], v4, s[40:43], s73 offen offset:3072 sc1
N2_121:
    s_waitcnt lgkmcnt(0)
    s_add_u32 s72, s84, s20
    v_mfma_f32_32x32x16_bf16 v[16:31], a[160:163], v[72:75], 0
    v_mfma_f32_32x32x16_bf16 v[16:31], a[164:167], v[76:79], v[16:31]
    v_mfma_f32_32x32x16_bf16 v[16:31], a[168:171], v[80:83], v[16:31]
    v_mfma_f32_32x32x16_bf16 v[16:31], a[172:175], v[84:87], v[16:31]
    v_mfma_f32_32x32x16_bf16 v[16:31], a[176:179], v[88:91], v[16:31]
    v_mfma_f32_32x32x16_bf16 v[16:31], a[180:183], v[92:95], v[16:31]
    v_mfma_f32_32x32x16_bf16 v[16:31], a[184:187], v[96:99], v[16:31]
    v_mfma_f32_32x32x16_bf16 v[16:31], a[188:191], v[100:103], v[16:31]
    v_mfma_f32_32x32x16_bf16 v[32:47], a[192:195], v[72:75], 0
    v_mfma_f32_32x32x16_bf16 v[32:47], a[196:199], v[76:79], v[32:47]
    v_mfma_f32_32x32x16_bf16 v[32:47], a[200:203], v[80:83], v[32:47]
    v_cvt_pk_bf16_f32 v64, v16, v17
    v_cvt_pk_bf16_f32 v65, v18, v19
    v_cvt_pk_bf16_f32 v66, v20, v21
    v_cvt_pk_bf16_f32 v67, v22, v23
    v_cvt_pk_bf16_f32 v68, v24, v25
    v_cvt_pk_bf16_f32 v69, v26, v27
    v_cvt_pk_bf16_f32 v70, v28, v29
    v_cvt_pk_bf16_f32 v71, v30, v31
    s_add_u32 s73, s72, 16384
    buffer_store_dwordx4 v[64:67], v6, s[40:43], s72 offen
    buffer_store_dwordx4 v[68:71], v6, s[40:43], s73 offen
    s_add_u32 s72, s72, 0x40000
    v_mfma_f32_32x32x16_bf16 v[32:47], a[204:207], v[84:87], v[32:47]
    v_mfma_f32_32x32x16_bf16 v[32:47], a[208:211], v[88:91], v[32:47]
    v_mfma_f32_32x32x16_bf16 v[32:47], a[212:215], v[92:95], v[32:47]
    v_mfma_f32_32x32x16_bf16 v[32:47], a[216:219], v[96:99], v[32:47]
    v_mfma_f32_32x32x16_bf16 v[32:47], a[220:223], v[100:103], v[32:47]
    v_mfma_f32_32x32x16_bf16 v[16:31], a[224:227], v[72:75], 0
    v_mfma_f32_32x32x16_bf16 v[16:31], a[228:231], v[76:79], v[16:31]
    v_mfma_f32_32x32x16_bf16 v[16:31], a[232:235], v[80:83], v[16:31]
    v_cvt_pk_bf16_f32 v64, v32, v33
    v_cvt_pk_bf16_f32 v65, v34, v35
    v_cvt_pk_bf16_f32 v66, v36, v37
    v_cvt_pk_bf16_f32 v67, v38, v39
    v_cvt_pk_bf16_f32 v68, v40, v41
    v_cvt_pk_bf16_f32 v69, v42, v43
    v_cvt_pk_bf16_f32 v70, v44, v45
    v_cvt_pk_bf16_f32 v71, v46, v47
    s_add_u32 s73, s72, 16384
    buffer_store_dwordx4 v[64:67], v6, s[40:43], s72 offen
    buffer_store_dwordx4 v[68:71], v6, s[40:43], s73 offen
    s_add_u32 s72, s72, 0x40000
    v_mfma_f32_32x32x16_bf16 v[16:31], a[236:239], v[84:87], v[16:31]
    v_mfma_f32_32x32x16_bf16 v[16:31], a[240:243], v[88:91], v[16:31]
    v_mfma_f32_32x32x16_bf16 v[16:31], a[244:247], v[92:95], v[16:31]
    v_mfma_f32_32x32x16_bf16 v[16:31], a[248:251], v[96:99], v[16:31]
    v_mfma_f32_32x32x16_bf16 v[16:31], a[252:255], v[100:103], v[16:31]
    v_mfma_f32_32x32x16_bf16 v[32:47], v[192:195], v[72:75], 0
    v_mfma_f32_32x32x16_bf16 v[32:47], v[196:199], v[76:79], v[32:47]
    v_mfma_f32_32x32x16_bf16 v[32:47], v[200:203], v[80:83], v[32:47]
    v_cvt_pk_bf16_f32 v64, v16, v17
    v_cvt_pk_bf16_f32 v65, v18, v19
    v_cvt_pk_bf16_f32 v66, v20, v21
    v_cvt_pk_bf16_f32 v67, v22, v23
    v_cvt_pk_bf16_f32 v68, v24, v25
    v_cvt_pk_bf16_f32 v69, v26, v27
    v_cvt_pk_bf16_f32 v70, v28, v29
    v_cvt_pk_bf16_f32 v71, v30, v31
    s_add_u32 s73, s72, 16384
    buffer_store_dwordx4 v[64:67], v6, s[40:43], s72 offen
    buffer_store_dwordx4 v[68:71], v6, s[40:43], s73 offen
    s_add_u32 s72, s72, 0x40000
    v_mfma_f32_32x32x16_bf16 v[32:47], v[204:207], v[84:87], v[32:47]
    v_mfma_f32_32x32x16_bf16 v[32:47], v[208:211], v[88:91], v[32:47]
    v_mfma_f32_32x32x16_bf16 v[32:47], v[212:215], v[92:95], v[32:47]
    v_mfma_f32_32x32x16_bf16 v[32:47], v[216:219], v[96:99], v[32:47]
    v_mfma_f32_32x32x16_bf16 v[32:47], v[220:223], v[100:103], v[32:47]
    v_mfma_f32_32x32x16_bf16 v[16:31], v[224:227], v[72:75], 0
    v_mfma_f32_32x32x16_bf16 v[16:31], v[228:231], v[76:79], v[16:31]
    v_mfma_f32_32x32x16_bf16 v[16:31], v[232:235], v[80:83], v[16:31]
    v_cvt_pk_bf16_f32 v64, v32, v33
    v_cvt_pk_bf16_f32 v65, v34, v35
    v_cvt_pk_bf16_f32 v66, v36, v37
    v_cvt_pk_bf16_f32 v67, v38, v39
    v_cvt_pk_bf16_f32 v68, v40, v41
    v_cvt_pk_bf16_f32 v69, v42, v43
    v_cvt_pk_bf16_f32 v70, v44, v45
    v_cvt_pk_bf16_f32 v71, v46, v47
    s_add_u32 s73, s72, 16384
    buffer_store_dwordx4 v[64:67], v6, s[40:43], s72 offen
    buffer_store_dwordx4 v[68:71], v6, s[40:43], s73 offen
    s_add_u32 s72, s72, 0x40000
    v_mfma_f32_32x32x16_bf16 v[16:31], v[236:239], v[84:87], v[16:31]
    v_mfma_f32_32x32x16_bf16 v[16:31], v[240:243], v[88:91], v[16:31]
    v_mfma_f32_32x32x16_bf16 v[16:31], v[244:247], v[92:95], v[16:31]
    v_mfma_f32_32x32x16_bf16 v[16:31], v[248:251], v[96:99], v[16:31]
    v_mfma_f32_32x32x16_bf16 v[16:31], v[252:255], v[100:103], v[16:31]
    s_nop 11
    v_cvt_pk_bf16_f32 v64, v16, v17
    v_cvt_pk_bf16_f32 v65, v18, v19
    v_cvt_pk_bf16_f32 v66, v20, v21
    v_cvt_pk_bf16_f32 v67, v22, v23
    v_cvt_pk_bf16_f32 v68, v24, v25
    v_cvt_pk_bf16_f32 v69, v26, v27
    v_cvt_pk_bf16_f32 v70, v28, v29
    v_cvt_pk_bf16_f32 v71, v30, v31
    s_add_u32 s73, s72, 16384
    buffer_store_dwordx4 v[64:67], v6, s[40:43], s72 offen
    buffer_store_dwordx4 v[68:71], v6, s[40:43], s73 offen
    s_add_u32 s72, s72, 0x40000
    s_cmp_eq_u32 s63, 0
    s_cbranch_scc1 N3_122
    s_waitcnt vmcnt(17)
    v_mfma_f32_16x16x32_bf16 v[136:139], v[10:13], v[104:107], 0
    s_waitcnt vmcnt(16)
    v_mfma_f32_16x16x32_bf16 v[136:139], v[10:13], v[108:111], v[136:139]
    s_waitcnt vmcnt(15)
    v_mfma_f32_16x16x32_bf16 v[136:139], v[10:13], v[112:115], v[136:139]
    s_waitcnt vmcnt(14)
    v_mfma_f32_16x16x32_bf16 v[136:139], v[10:13], v[116:119], v[136:139]
    s_waitcnt vmcnt(13)
    v_mfma_f32_16x16x32_bf16 v[136:139], v[10:13], v[120:123], v[136:139]
    s_waitcnt vmcnt(12)
    v_mfma_f32_16x16x32_bf16 v[136:139], v[10:13], v[124:127], v[136:139]
    s_waitcnt vmcnt(11)
    v_mfma_f32_16x16x32_bf16 v[136:139], v[10:13], v[128:131], v[136:139]
    s_waitcnt vmcnt(10)
    v_mfma_f32_16x16x32_bf16 v[136:139], v[10:13], v[132:135], v[136:139]
    s_nop 7
    v_pk_add_f32 v[136:137], v[136:137], v[160:161]
    v_pk_add_f32 v[138:139], v[138:139], v[162:163]
    v_cvt_pk_bf16_f32 v136, v136, v137
    v_cvt_pk_bf16_f32 v137, v138, v139
    buffer_store_dwordx2 v[136:137], v8, s[64:67], s60 offen
N3_122:
    s_mov_b32 s48, s56
    s_mov_b32 s49, s57
    s_mov_b32 s50, s58
    s_mov_b32 s51, s59
    s_mov_b32 s52, s60
    s_mov_b32 s53, s61
    s_lshl_b32 s71, s35, 2
    s_add_u32 s71, s71, s34
    s_lshl_b32 s56, s71, 13
    s_add_u32 s56, s56, s85
    s_add_u32 s56, s56, s20
    s_and_b32 s57, s71, 1
    s_mul_i32 s57, s57, 20480
    s_lshr_b32 s58, s71, 1
    s_lshl_b32 s58, s58, 4
    s_add_u32 s57, s57, s58
    s_add_u32 s57, s57, s24
    s_lshl_b32 s58, s71, 9
    s_add_u32 s58, s58, s25
    s_add_u32 s71, s35, 128
    s_lshl_b32 s59, s71, 13
    s_add_u32 s59, s59, s85
    s_add_u32 s59, s59, s20
    s_and_b32 s60, s71, 1
    s_mul_i32 s60, s60, 20480
    s_lshr_b32 s61, s71, 1
    s_lshl_b32 s61, s61, 4
    s_add_u32 s60, s60, s61
    s_add_u32 s60, s60, s24
    s_lshl_b32 s61, s71, 9
    s_add_u32 s61, s61, s25
    s_cmp_eq_u32 s34, 0
    s_cselect_b32 s59, s59, 0x40000000
    s_cselect_b32 s60, s60, 0x40000000
    s_cselect_b32 s61, s61, 0x40000000
    s_add_u32 s26, s26, 0x80000
    s_add_u32 s31, s31, 0x40000
    s_add_u32 s32, s32, 0x20000
    s_xor_b32 s20, s20, 0x140000
    s_add_u32 s24, s24, 81920
    s_add_u32 s25, s25, 163840
    v_xor_b32 v5, 0x10000, v5
    s_add_u32 s80, s80, 1
    s_cmp_lt_u32 s80, 32
    s_branch NL_123
    s_cmp_lg_u32 s80, 31
    s_cbranch_scc1 NL_123
    s_mul_i32 s85, s83, 1310720
    s_add_u32 s85, s85, 0x4500000
    s_lshl_b32 s69, s35, 8
    s_add_u32 s84, s85, s69
    s_mov_b32 s20, 0
NL_123:
    s_cmp_lt_u32 s80, 32
    s_cbranch_scc1 QAO_LOOP_fast
    s_add_u32 s69, s80, 0
    s_cmp_ge_u32 s62, s69
    s_cbranch_scc1 BOK_124
    s_mov_b32 s38, 262144
PL_125:
    buffer_load_dword v2, off, s[40:43], s23 sc1
    s_waitcnt vmcnt(0)
    v_readfirstlane_b32 s62, v2
    s_cmp_lt_u32 s62, s69
    s_cbranch_scc1 PN_126
    s_branch PO_127
PN_126:
    s_sleep 1
    s_sub_u32 s38, s38, 1
    s_cbranch_scc0 PL_125
    s_mov_b32 s68, 42
    s_branch FAIL
PO_127:
BOK_124:
    buffer_load_dwordx4 v[140:143], v9, s[40:43], s58 offen sc1
    buffer_load_dwordx4 v[176:179], v9, s[40:43], s61 offen sc1
    s_waitcnt vmcnt(2)
    s_barrier
    s_cmp_lg_u32 s34, 0
    s_cbranch_scc1 W0_128
    v_mov_b32 v1, s80
    s_mov_b64 exec, 1
    buffer_store_dword v1, off, s[40:43], s22
    s_mov_b64 exec, -1
W0_128:
    s_add_u32 s69, s80, 0
    v_and_b32 v1, 31, v0
    v_lshlrev_b32 v1, 2, v1
    s_mov_b32 s38, 262144
PL_129:
    buffer_load_dword v2, v1, s[40:43], s21 offen sc1
    s_waitcnt vmcnt(0)
    v_cmp_gt_u32 vcc, s69, v2
    s_cbranch_vccnz PN_130
    s_branch PO_131
PN_130:
    s_sleep 1
    s_sub_u32 s38, s38, 1
    s_cbranch_scc0 PL_129
    s_mov_b32 s68, 44
    s_branch FAIL
PO_131:
    s_mov_b32 s38, 262144
    s_add_u32 s73, s56, 4096
    buffer_load_dwordx4 v[104:107], v4, s[40:43], s56 offen offset:0 sc1
    buffer_load_dwordx4 v[108:111], v4, s[40:43], s56 offen offset:1024 sc1
    buffer_load_dwordx4 v[112:115], v4, s[40:43], s56 offen offset:2048 sc1
    buffer_load_dwordx4 v[116:119], v4, s[40:43], s56 offen offset:3072 sc1
    buffer_load_dwordx4 v[120:123], v4, s[40:43], s73 offen offset:0 sc1
    buffer_load_dwordx4 v[124:127], v4, s[40:43], s73 offen offset:1024 sc1
    buffer_load_dwordx4 v[128:131], v4, s[40:43], s73 offen offset:2048 sc1
    buffer_load_dwordx4 v[132:135], v4, s[40:43], s73 offen offset:3072 sc1
    s_cmp_lg_u32 s34, 0
    s_cbranch_scc1 RONE_133
    s_add_u32 s73, s59, 4096
    buffer_load_dwordx4 v[72:75], v4, s[40:43], s59 offen offset:0 sc1
    buffer_load_dwordx4 v[76:79], v4, s[40:43], s59 offen offset:1024 sc1
    buffer_load_dwordx4 v[80:83], v4, s[40:43], s59 offen offset:2048 sc1
    buffer_load_dwordx4 v[84:87], v4, s[40:43], s59 offen offset:3072 sc1
    buffer_load_dwordx4 v[88:91], v4, s[40:43], s73 offen offset:0 sc1
    buffer_load_dwordx4 v[92:95], v4, s[40:43], s73 offen offset:1024 sc1
    buffer_load_dwordx4 v[96:99], v4, s[40:43], s73 offen offset:2048 sc1
    buffer_load_dwordx4 v[100:103], v4, s[40:43], s73 offen offset:3072 sc1
    s_waitcnt vmcnt(15)
    v_mfma_f32_16x16x32_bf16 v[136:139], v[10:13], v[104:107], 0
    s_waitcnt vmcnt(14)
    v_mfma_f32_16x16x32_bf16 v[136:139], v[10:13], v[108:111], v[136:139]
    s_waitcnt vmcnt(13)
    v_mfma_f32_16x16x32_bf16 v[136:139], v[10:13], v[112:115], v[136:139]
    s_waitcnt vmcnt(12)
    v_mfma_f32_16x16x32_bf16 v[136:139], v[10:13], v[116:119], v[136:139]
    s_waitcnt vmcnt(11)
    v_mfma_f32_16x16x32_bf16 v[136:139], v[10:13], v[120:123], v[136:139]
    s_waitcnt vmcnt(10)
    v_mfma_f32_16x16x32_bf16 v[136:139], v[10:13], v[124:127], v[136:139]
    s_waitcnt vmcnt(9)
    v_mfma_f32_16x16x32_bf16 v[136:139], v[10:13], v[128:131], v[136:139]
    s_waitcnt vmcnt(8)
    v_mfma_f32_16x16x32_bf16 v[136:139], v[10:13], v[132:135], v[136:139]
    s_nop 7
    v_pk_add_f32 v[136:137], v[136:137], v[140:141]
    v_pk_add_f32 v[138:139], v[138:139], v[142:143]
    v_cvt_pk_bf16_f32 v136, v136, v137
    v_cvt_pk_bf16_f32 v137, v138, v139
    buffer_store_dwordx2 v[136:137], v8, s[64:67], s57 offen
    s_waitcnt vmcnt(8)
    v_mfma_f32_16x16x32_bf16 v[16:19], v[10:13], v[72:75], 0
    s_waitcnt vmcnt(7)
    v_mfma_f32_16x16x32_bf16 v[16:19], v[10:13], v[76:79], v[16:19]
    s_waitcnt vmcnt(6)
    v_mfma_f32_16x16x32_bf16 v[16:19], v[10:13], v[80:83], v[16:19]
    s_waitcnt vmcnt(5)
    v_mfma_f32_16x16x32_bf16 v[16:19], v[10:13], v[84:87], v[16:19]
    s_waitcnt vmcnt(4)
    v_mfma_f32_16x16x32_bf16 v[16:19], v[10:13], v[88:91], v[16:19]
    s_waitcnt vmcnt(3)
    v_mfma_f32_16x16x32_bf16 v[16:19], v[10:13], v[92:95], v[16:19]
    s_waitcnt vmcnt(2)
    v_mfma_f32_16x16x32_bf16 v[16:19], v[10:13], v[96:99], v[16:19]
    s_waitcnt vmcnt(1)
    v_mfma_f32_16x16x32_bf16 v[16:19], v[10:13], v[100:103], v[16:19]
    s_nop 7
    v_pk_add_f32 v[16:17], v[16:17], v[176:177]
    v_pk_add_f32 v[18:19], v[18:19], v[178:179]
    v_cvt_pk_bf16_f32 v16, v16, v17
    v_cvt_pk_bf16_f32 v17, v18, v19
    buffer_store_dwordx2 v[16:17], v8, s[64:67], s60 offen
    s_branch RW0_132
RONE_133:
    s_waitcnt vmcnt(7)
    v_mfma_f32_16x16x32_bf16 v[136:139], v[10:13], v[104:107], 0
    s_waitcnt vmcnt(6)
    v_mfma_f32_16x16x32_bf16 v[136:139], v[10:13], v[108:111], v[136:139]
    s_waitcnt vmcnt(5)
    v_mfma_f32_16x16x32_bf16 v[136:139], v[10:13], v[112:115], v[136:139]
    s_waitcnt vmcnt(4)
    v_mfma_f32_16x16x32_bf16 v[136:139], v[10:13], v[116:119], v[136:139]
    s_waitcnt vmcnt(3)
    v_mfma_f32_16x16x32_bf16 v[136:139], v[10:13], v[120:123], v[136:139]
    s_waitcnt vmcnt(2)
    v_mfma_f32_16x16x32_bf16 v[136:139], v[10:13], v[124:127], v[136:139]
    s_waitcnt vmcnt(1)
    v_mfma_f32_16x16x32_bf16 v[136:139], v[10:13], v[128:131], v[136:139]
    s_waitcnt vmcnt(0)
    v_mfma_f32_16x16x32_bf16 v[136:139], v[10:13], v[132:135], v[136:139]
    s_nop 7
    v_pk_add_f32 v[136:137], v[136:137], v[140:141]
    v_pk_add_f32 v[138:139], v[138:139], v[142:143]
    v_cvt_pk_bf16_f32 v136, v136, v137
    v_cvt_pk_bf16_f32 v137, v138, v139
    buffer_store_dwordx2 v[136:137], v8, s[64:67], s57 offen
RW0_132:
    s_branch END
QAO_LOOP_safe:
    s_lshl_b32 s69, s80, 1
    s_add_u32 s69, s69, s83
    s_cmp_gt_u32 s27, s69
    s_cbranch_scc1 PRG_134
    s_mov_b32 s38, 262144
PL_135:
    buffer_load_dwordx2 v[2:3], off, s[40:43], s28 sc1
    s_waitcnt vmcnt(0)
    v_min_u32 v2, v2, v3
    s_nop 0
    v_readfirstlane_b32 s27, v2
    s_cmp_le_u32 s27, s69
    s_cbranch_scc1 PN_136
    s_branch PO_137
PN_136:
    s_sleep 1
    s_sub_u32 s38, s38, 1
    s_cbranch_scc0 PL_135
    s_mov_b32 s68, 40
    s_branch FAIL
PO_137:
PRG_134:
    s_lshl_b32 s70, s34, 11
    s_add_u32 s69, s26, 0x2000000
    s_add_u32 m0, s70, 110592
    s_nop 0
    buffer_load_dwordx4 v4, s[40:43], s69 offen sc1 nt lds
    buffer_load_dwordx4 v4, s[40:43], s69 offen offset:1024 sc1 nt lds
    s_add_u32 s69, s26, 0x3000000
    s_add_u32 m0, s70, 118784
    s_nop 0
    buffer_load_dwordx4 v4, s[40:43], s69 offen sc1 nt lds
    buffer_load_dwordx4 v4, s[40:43], s69 offen offset:1024 sc1 nt lds
    s_lshl_b32 s69, s80, 1
    s_add_u32 s69, s69, s83
    s_cmp_gt_u32 s30, s69
    s_cselect_b32 s63, 1, 0
    s_cbranch_scc0 KME_138
    v_lshrrev_b32 v1, 2, v4
    buffer_load_dwordx4 v[116:119], v4, s[40:43], s31 offen offset:0 sc1 nt
    buffer_load_dwordx4 v[120:123], v4, s[40:43], s31 offen offset:1024 sc1 nt
    buffer_load_dwordx4 v[124:127], v4, s[40:43], s31 offen offset:2048 sc1 nt
    buffer_load_dwordx4 v[128:131], v4, s[40:43], s31 offen offset:3072 sc1 nt
    buffer_load_dword v132, v1, s[40:43], s32 offen offset:0 sc1 nt
    v_mov_b32 v133, 0
    buffer_load_dword v134, v1, s[40:43], s32 offen offset:256 sc1 nt
    v_mov_b32 v135, 0
    buffer_load_dword v136, v1, s[40:43], s32 offen offset:512 sc1 nt
    v_mov_b32 v137, 0
    buffer_load_dword v138, v1, s[40:43], s32 offen offset:768 sc1 nt
    v_mov_b32 v139, 0
KME_138:
    s_cmp_lt_u32 s80, 31
    s_cselect_b32 s69, 81920, 0
    s_add_u32 s81, s81, s69
    s_xor_b32 s82, s82, 0x10000
    ds_read_b128 v[48:51], v5 offset:0
    ds_read_b128 v[52:55], v5 offset:1024
    ds_read_b128 v[56:59], v5 offset:2048
    ds_read_b128 v[60:63], v5 offset:3072
    s_waitcnt lgkmcnt(3)
    v_mfma_f32_32x32x16_bf16 v[16:31], a[0:3], v[48:51], 0
    s_mul_i32 s72, s34, 10240
    s_add_u32 s73, s72, s82
    s_add_u32 s72, s72, s81
    s_mov_b32 m0, s73
    s_nop 0
    buffer_load_dwordx4 v4, s[40:43], s72 offen sc1 lds
    ds_read_b128 v[48:51], v5 offset:4096
    s_waitcnt lgkmcnt(3)
    v_mfma_f32_32x32x16_bf16 v[16:31], a[4:7], v[52:55], v[16:31]
    ds_read_b128 v[52:55], v5 offset:5120
    s_waitcnt lgkmcnt(3)
    v_mfma_f32_32x32x16_bf16 v[16:31], a[8:11], v[56:59], v[16:31]
    buffer_load_dwordx4 v4, s[40:43], s72 offen offset:1024 sc1 lds
    ds_read_b128 v[56:59], v5 offset:6144
    s_waitcnt lgkmcnt(3)
    v_mfma_f32_32x32x16_bf16 v[16:31], a[12:15], v[60:63], v[16:31]
    ds_read_b128 v[60:63], v5 offset:7168
    s_waitcnt lgkmcnt(3)
    v_mfma_f32_32x32x16_bf16 v[16:31], a[16:19], v[48:51], v[16:31]
    buffer_load_dwordx4 v4, s[40:43], s72 offen offset:2048 sc1 lds
    ds_read_b128 v[48:51], v5 offset:8192
    s_waitcnt lgkmcnt(3)
    v_mfma_f32_32x32x16_bf16 v[16:31], a[20:23], v[52:55], v[16:31]
    ds_read_b128 v[52:55], v5 offset:9216
    s_waitcnt lgkmcnt(3)
    v_mfma_f32_32x32x16_bf16 v[16:31], a[24:27], v[56:59], v[16:31]
    buffer_load_dwordx4 v4, s[40:43], s72 offen offset:3072 sc1 lds
    ds_read_b128 v[56:59], v5 offset:10240
    s_waitcnt lgkmcnt(3)
    v_mfma_f32_32x32x16_bf16 v[16:31], a[28:31], v[60:63], v[16:31]
    ds_read_b128 v[60:63], v5 offset:11264
    s_waitcnt lgkmcnt(3)
    v_mfma_f32_32x32x16_bf16 v[16:31], a[32:35], v[48:51], v[16:31]
    s_add_u32 s73, s73, 4096
    s_mov_b32 m0, s73
    s_add_u32 s72, s72, 4096
    buffer_load_dwordx4 v4, s[40:43], s72 offen sc1 lds
    ds_read_b128 v[48:51], v5 offset:12288
    s_waitcnt lgkmcnt(3)
    v_mfma_f32_32x32x16_bf16 v[16:31], a[36:39], v[52:55], v[16:31]
    ds_read_b128 v[52:55], v5 offset:13312
    s_waitcnt lgkmcnt(3)
    v_mfma_f32_32x32x16_bf16 v[16:31], a[40:43], v[56:59], v[16:31]
    buffer_load_dwordx4 v4, s[40:43], s72 offen offset:1024 sc1 lds
    ds_read_b128 v[56:59], v5 offset:14336
    s_waitcnt lgkmcnt(3)
    v_mfma_f32_32x32x16_bf16 v[16:31], a[44:47], v[60:63], v[16:31]
    ds_read_b128 v[60:63], v5 offset:15360
    s_waitcnt lgkmcnt(3)
    v_mfma_f32_32x32x16_bf16 v[16:31], a[48:51], v[48:51], v[16:31]
    buffer_load_dwordx4 v4, s[40:43], s72 offen offset:2048 sc1 lds
    ds_read_b128 v[48:51], v5 offset:16384
    s_waitcnt lgkmcnt(3)
    v_mfma_f32_32x32x16_bf16 v[16:31], a[52:55], v[52:55], v[16:31]
    ds_read_b128 v[52:55], v5 offset:17408
    s_waitcnt lgkmcnt(3)
    v_mfma_f32_32x32x16_bf16 v[16:31], a[56:59], v[56:59], v[16:31]
    buffer_load_dwordx4 v4, s[40:43], s72 offen offset:3072 sc1 lds
    ds_read_b128 v[56:59], v5 offset:18432
    s_waitcnt lgkmcnt(3)
    v_mfma_f32_32x32x16_bf16 v[16:31], a[60:63], v[60:63], v[16:31]
    ds_read_b128 v[60:63], v5 offset:19456
    s_waitcnt lgkmcnt(3)
    v_mfma_f32_32x32x16_bf16 v[16:31], a[64:67], v[48:51], v[16:31]
    s_add_u32 s73, s73, 4096
    s_mov_b32 m0, s73
    s_add_u32 s72, s72, 4096
    buffer_load_dwordx4 v4, s[40:43], s72 offen sc1 lds
    ds_read_b128 v[48:51], v5 offset:20480
    s_waitcnt lgkmcnt(3)
    v_mfma_f32_32x32x16_bf16 v[16:31], a[68:71], v[52:55], v[16:31]
    ds_read_b128 v[52:55], v5 offset:21504
    s_waitcnt lgkmcnt(3)
    v_mfma_f32_32x32x16_bf16 v[16:31], a[72:75], v[56:59], v[16:31]
    buffer_load_dwordx4 v4, s[40:43], s72 offen offset:1024 sc1 lds
    ds_read_b128 v[56:59], v5 offset:22528
    s_waitcnt lgkmcnt(3)
    v_mfma_f32_32x32x16_bf16 v[16:31], a[76:79], v[60:63], v[16:31]
    ds_read_b128 v[60:63], v5 offset:23552
    s_waitcnt lgkmcnt(3)
    v_mfma_f32_32x32x16_bf16 v[16:31], a[80:83], v[48:51], v[16:31]
    ds_read_b128 v[48:51], v5 offset:24576
    s_waitcnt lgkmcnt(3)
    v_mfma_f32_32x32x16_bf16 v[16:31], a[84:87], v[52:55], v[16:31]
    s_waitcnt vmcnt(14)
    s_barrier
    s_cmp_lg_u32 s34, 0
    s_cbranch_scc1 W0_139
    v_mov_b32 v1, s80
    s_mov_b64 exec, 1
    buffer_store_dword v1, off, s[40:43], s22 sc1
    s_mov_b64 exec, -1
W0_139:
    ds_read_b128 v[52:55], v5 offset:25600
    s_waitcnt lgkmcnt(3)
    v_mfma_f32_32x32x16_bf16 v[16:31], a[88:91], v[56:59], v[16:31]
    ds_read_b128 v[56:59], v5 offset:26624
    s_waitcnt lgkmcnt(3)
    v_mfma_f32_32x32x16_bf16 v[16:31], a[92:95], v[60:63], v[16:31]
    ds_read_b128 v[60:63], v5 offset:27648
    s_waitcnt lgkmcnt(3)
    v_mfma_f32_32x32x16_bf16 v[16:31], a[96:99], v[48:51], v[16:31]
    ds_read_b128 v[48:51], v5 offset:28672
    s_waitcnt lgkmcnt(3)
    v_mfma_f32_32x32x16_bf16 v[16:31], a[100:103], v[52:55], v[16:31]
    ds_read_b128 v[52:55], v5 offset:29696
    s_waitcnt lgkmcnt(3)
    v_mfma_f32_32x32x16_bf16 v[16:31], a[104:107], v[56:59], v[16:31]
    ds_read_b128 v[56:59], v5 offset:30720
    s_waitcnt lgkmcnt(3)
    v_mfma_f32_32x32x16_bf16 v[16:31], a[108:111], v[60:63], v[16:31]
    ds_read_b128 v[60:63], v5 offset:31744
    s_waitcnt lgkmcnt(3)
    v_mfma_f32_32x32x16_bf16 v[16:31], a[112:115], v[48:51], v[16:31]
    ds_read_b128 v[48:51], v5 offset:32768
    s_waitcnt lgkmcnt(3)
    v_mfma_f32_32x32x16_bf16 v[16:31], a[116:119], v[52:55], v[16:31]
    ds_read_b128 v[52:55], v5 offset:33792
    s_waitcnt lgkmcnt(3)
    v_mfma_f32_32x32x16_bf16 v[16:31], a[120:123], v[56:59], v[16:31]
    ds_read_b128 v[56:59], v5 offset:34816
    s_waitcnt lgkmcnt(3)
    v_mfma_f32_32x32x16_bf16 v[16:31], a[124:127], v[60:63], v[16:31]
    ds_read_b128 v[60:63], v5 offset:35840
    s_waitcnt lgkmcnt(3)
    v_mfma_f32_32x32x16_bf16 v[16:31], a[128:131], v[48:51], v[16:31]
    ds_read_b128 v[48:51], v5 offset:36864
    s_waitcnt lgkmcnt(3)
    v_mfma_f32_32x32x16_bf16 v[16:31], a[132:135], v[52:55], v[16:31]
    ds_read_b128 v[52:55], v5 offset:37888
    s_waitcnt lgkmcnt(3)
    v_mfma_f32_32x32x16_bf16 v[16:31], a[136:139], v[56:59], v[16:31]
    ds_read_b128 v[56:59], v5 offset:38912
    s_waitcnt lgkmcnt(3)
    v_mfma_f32_32x32x16_bf16 v[16:31], a[140:143], v[60:63], v[16:31]
    ds_read_b128 v[60:63], v5 offset:39936
    s_waitcnt lgkmcnt(3)
    v_mfma_f32_32x32x16_bf16 v[16:31], a[144:147], v[48:51], v[16:31]
    s_waitcnt lgkmcnt(2)
    v_mfma_f32_32x32x16_bf16 v[16:31], a[148:151], v[52:55], v[16:31]
    s_waitcnt lgkmcnt(1)
    v_mfma_f32_32x32x16_bf16 v[16:31], a[152:155], v[56:59], v[16:31]
    s_waitcnt lgkmcnt(0)
    v_mfma_f32_32x32x16_bf16 v[16:31], a[156:159], v[60:63], v[16:31]
    s_nop 11
    v_cvt_pk_bf16_f32 v64, v16, v17
    v_cvt_pk_bf16_f32 v65, v18, v19
    v_cvt_pk_bf16_f32 v66, v20, v21
    v_cvt_pk_bf16_f32 v67, v22, v23
    v_cvt_pk_bf16_f32 v68, v24, v25
    v_cvt_pk_bf16_f32 v69, v26, v27
    v_cvt_pk_bf16_f32 v70, v28, v29
    v_cvt_pk_bf16_f32 v71, v30, v31
    ds_write_b128 v145, v[64:67]
    ds_write_b128 v145, v[68:71] offset:256
    s_and_b32 s69, s34, 1
    s_lshl_b32 s69, s69, 12
    v_add_u32 v1, s69, v4
    v_add_u32 v3, 110592, v4
    s_lshr_b32 s69, s34, 1
    s_lshl_b32 s69, s69, 12
    s_add_u32 s69, s69, 118784
    v_add_u32 v15, s69, v4
    s_waitcnt vmcnt(10) lgkmcnt(0)
    s_barrier
    ds_read_b128 v[72:75], v1 offset:40960
    ds_read_b128 v[76:79], v1 offset:41984
    ds_read_b128 v[80:83], v1 offset:43008
    ds_read_b128 v[84:87], v1 offset:44032
    ds_read_b128 v[88:91], v3 offset:0
    ds_read_b128 v[92:95], v3 offset:4096
    ds_read_b128 v[96:99], v3 offset:1024
    ds_read_b128 v[100:103], v3 offset:5120
    ds_read_b128 v[160:163], v15 offset:0
    ds_read_b128 v[164:167], v15 offset:1024
    ds_read_b128 v[168:171], v15 offset:2048
    ds_read_b128 v[172:175], v15 offset:3072
    s_waitcnt lgkmcnt(11)
    s_waitcnt lgkmcnt(7)
    v_mfma_f32_16x16x32_bf16 v[104:107], v[88:91], v[72:75], 0
    ds_read_b128 v[88:91], v3 offset:2048
    s_waitcnt lgkmcnt(7)
    v_mfma_f32_16x16x32_bf16 v[108:111], v[92:95], v[72:75], 0
    ds_read_b128 v[92:95], v3 offset:6144
    s_waitcnt lgkmcnt(7)
    v_mfma_f32_16x16x32_bf16 v[104:107], v[96:99], v[76:79], v[104:107]
    ds_read_b128 v[96:99], v3 offset:3072
    s_waitcnt lgkmcnt(7)
    v_mfma_f32_16x16x32_bf16 v[108:111], v[100:103], v[76:79], v[108:111]
    ds_read_b128 v[100:103], v3 offset:7168
    s_waitcnt lgkmcnt(3)
    v_mfma_f32_16x16x32_bf16 v[104:107], v[88:91], v[80:83], v[104:107]
    s_waitcnt lgkmcnt(2)
    v_mfma_f32_16x16x32_bf16 v[108:111], v[92:95], v[80:83], v[108:111]
    s_waitcnt lgkmcnt(1)
    v_mfma_f32_16x16x32_bf16 v[104:107], v[96:99], v[84:87], v[104:107]
    s_waitcnt lgkmcnt(0)
    v_mfma_f32_16x16x32_bf16 v[108:111], v[100:103], v[84:87], v[108:111]
    s_waitcnt lgkmcnt(0)
    s_cmp_eq_u32 s80, 0
    s_cbranch_scc1 N0_140
    s_add_u32 s69, s80, 0
    v_and_b32 v1, 31, v0
    v_lshlrev_b32 v1, 2, v1
    s_mov_b32 s38, 262144
PL_141:
    buffer_load_dword v2, v1, s[40:43], s21 offen sc1
    s_waitcnt vmcnt(0)
    v_cmp_gt_u32 vcc, s69, v2
    s_cbranch_vccnz PN_142
    s_branch PO_143
PN_142:
    s_sleep 1
    s_sub_u32 s38, s38, 1
    s_cbranch_scc0 PL_141
    s_mov_b32 s68, 43
    s_branch FAIL
PO_143:
    s_add_u32 s69, s80, 0
    s_cmp_ge_u32 s62, s69
    s_cbranch_scc1 BOK_144
    s_mov_b32 s38, 262144
PL_145:
    buffer_load_dword v2, off, s[40:43], s23 sc1
    s_waitcnt vmcnt(0)
    v_readfirstlane_b32 s62, v2
    s_cmp_lt_u32 s62, s69
    s_cbranch_scc1 PN_146
    s_branch PO_147
PN_146:
    s_sleep 1
    s_sub_u32 s38, s38, 1
    s_cbranch_scc0 PL_145
    s_mov_b32 s68, 42
    s_branch FAIL
PO_147:
BOK_144:
    s_add_u32 s73, s56, 4096
    buffer_load_dwordx4 v[48:51], v4, s[40:43], s56 offen offset:0 sc1
    buffer_load_dwordx4 v[52:55], v4, s[40:43], s56 offen offset:1024 sc1
    buffer_load_dwordx4 v[56:59], v4, s[40:43], s56 offen offset:2048 sc1
    buffer_load_dwordx4 v[60:63], v4, s[40:43], s56 offen offset:3072 sc1
    buffer_load_dwordx4 v[176:179], v4, s[40:43], s73 offen offset:0 sc1
    buffer_load_dwordx4 v[180:183], v4, s[40:43], s73 offen offset:1024 sc1
    buffer_load_dwordx4 v[184:187], v4, s[40:43], s73 offen offset:2048 sc1
    buffer_load_dwordx4 v[188:191], v4, s[40:43], s73 offen offset:3072 sc1
    buffer_load_dwordx4 v[36:39], v9, s[40:43], s58 offen sc1
N0_140:
    s_cmp_lg_u32 s63, 0
    s_cbranch_scc1 KML_148
    s_lshl_b32 s69, s80, 1
    s_add_u32 s69, s69, s83
    s_cmp_gt_u32 s30, s69
    s_cbranch_scc1 PRG_150
    s_mov_b32 s38, 262144
PL_151:
    buffer_load_dwordx2 v[2:3], off, s[40:43], s29 sc1
    s_waitcnt vmcnt(0)
    v_min_u32 v2, v2, v3
    s_nop 0
    v_readfirstlane_b32 s30, v2
    s_cmp_le_u32 s30, s69
    s_cbranch_scc1 PN_152
    s_branch PO_153
PN_152:
    s_sleep 1
    s_sub_u32 s38, s38, 1
    s_cbranch_scc0 PL_151
    s_mov_b32 s68, 41
    s_branch FAIL
PO_153:
PRG_150:
    v_lshrrev_b32 v1, 2, v4
    buffer_load_dwordx4 v[116:119], v4, s[40:43], s31 offen offset:0 sc1 nt
    buffer_load_dwordx4 v[120:123], v4, s[40:43], s31 offen offset:1024 sc1 nt
    buffer_load_dwordx4 v[124:127], v4, s[40:43], s31 offen offset:2048 sc1 nt
    buffer_load_dwordx4 v[128:131], v4, s[40:43], s31 offen offset:3072 sc1 nt
    buffer_load_dword v132, v1, s[40:43], s32 offen offset:0 sc1 nt
    v_mov_b32 v133, 0
    buffer_load_dword v134, v1, s[40:43], s32 offen offset:256 sc1 nt
    v_mov_b32 v135, 0
    buffer_load_dword v136, v1, s[40:43], s32 offen offset:512 sc1 nt
    v_mov_b32 v137, 0
    buffer_load_dword v138, v1, s[40:43], s32 offen offset:768 sc1 nt
    v_mov_b32 v139, 0
KML_148:
    v_cndmask_b32 v104, v104, v147, s[4:5]
    v_cndmask_b32 v105, v105, v147, s[6:7]
    v_cndmask_b32 v106, v106, v147, s[8:9]
    v_cndmask_b32 v107, v107, v147, s[10:11]
    v_cndmask_b32 v108, v108, v147, s[12:13]
    v_cndmask_b32 v109, v109, v147, s[14:15]
    v_cndmask_b32 v110, v110, v147, s[16:17]
    v_cndmask_b32 v111, v111, v147, s[18:19]
    v_max3_f32 v156, v104, v105, v106
    v_max3_f32 v157, v108, v109, v110
    v_max3_f32 v156, v156, v107, v111
    s_waitcnt vmcnt(7)
    v_mfma_f32_16x16x32_bf16 v[112:115], v[116:119], v[72:75], 0
    s_waitcnt vmcnt(6)
    v_mfma_f32_16x16x32_bf16 v[112:115], v[120:123], v[76:79], v[112:115]
    s_waitcnt vmcnt(5)
    v_mfma_f32_16x16x32_bf16 v[112:115], v[124:127], v[80:83], v[112:115]
    s_waitcnt vmcnt(4)
    v_mfma_f32_16x16x32_bf16 v[112:115], v[128:131], v[84:87], v[112:115]
    s_nop 7
    v_max3_f32 v157, v157, v112, v113
    v_max_f32 v156, v156, v157
    v_mov_b32 v157, v156
    s_nop 1
    v_permlane16_swap_b32 v156, v157
    v_max_f32 v156, v156, v157
    v_mov_b32 v157, v156
    s_nop 1
    v_permlane32_swap_b32 v156, v157
    v_max_f32 v156, v156, v157
    v_mul_f32 v156, s100, v156
    v_fma_f32 v104, v104, s100, -v156
    v_fma_f32 v105, v105, s100, -v156
    v_fma_f32 v106, v106, s100, -v156
    v_fma_f32 v107, v107, s100, -v156
    v_fma_f32 v108, v108, s100, -v156
    v_fma_f32 v109, v109, s100, -v156
    v_fma_f32 v110, v110, s100, -v156
    v_fma_f32 v111, v111, s100, -v156
    v_fma_f32 v112, v112, s100, -v156
    v_fma_f32 v113, v113, s100, -v156
    v_exp_f32 v104, v104
    v_exp_f32 v105, v105
    v_exp_f32 v106, v106
    v_exp_f32 v107, v107
    v_exp_f32 v108, v108
    v_exp_f32 v109, v109
    v_exp_f32 v110, v110
    v_exp_f32 v111, v111
    v_exp_f32 v112, v112
    v_exp_f32 v113, v113
    v_cvt_pk_bf16_f32 v140, v104, v105
    v_cvt_pk_bf16_f32 v141, v106, v107
    v_cvt_pk_bf16_f32 v142, v108, v109
    v_cvt_pk_bf16_f32 v143, v110, v111
    v_cvt_pk_bf16_f32 v154, v112, v113
    s_waitcnt vmcnt(0)
    v_mfma_f32_16x16x32_bf16 v[32:35], v[148:151], v[140:143], 0
    v_mfma_f32_16x16x32_bf16 v[16:19], v[160:163], v[140:143], 0
    v_mfma_f32_16x16x32_bf16 v[20:23], v[164:167], v[140:143], 0
    v_mfma_f32_16x16x32_bf16 v[24:27], v[168:171], v[140:143], 0
    v_mfma_f32_16x16x32_bf16 v[28:31], v[172:175], v[140:143], 0
    v_mfma_f32_16x16x16_bf16 v[32:35], v[148:149], v[154:155], v[32:35]
    v_mfma_f32_16x16x16_bf16 v[16:19], v[132:133], v[154:155], v[16:19]
    v_mfma_f32_16x16x16_bf16 v[20:23], v[134:135], v[154:155], v[20:23]
    v_mfma_f32_16x16x16_bf16 v[24:27], v[136:137], v[154:155], v[24:27]
    v_mfma_f32_16x16x16_bf16 v[28:31], v[138:139], v[154:155], v[28:31]
    v_rcp_f32 v156, v32
    s_nop 0
    v_pk_mul_f32 v[16:17], v[16:17], v[156:157] op_sel_hi:[1,0]
    v_pk_mul_f32 v[18:19], v[18:19], v[156:157] op_sel_hi:[1,0]
    v_cvt_pk_bf16_f32 v64, v16, v17
    v_cvt_pk_bf16_f32 v65, v18, v19
    ds_write_b64 v146, v[64:65] offset:0
    v_pk_mul_f32 v[20:21], v[20:21], v[156:157] op_sel_hi:[1,0]
    v_pk_mul_f32 v[22:23], v[22:23], v[156:157] op_sel_hi:[1,0]
    v_cvt_pk_bf16_f32 v66, v20, v21
    v_cvt_pk_bf16_f32 v67, v22, v23
    ds_write_b64 v146, v[66:67] offset:1024
    v_pk_mul_f32 v[24:25], v[24:25], v[156:157] op_sel_hi:[1,0]
    v_pk_mul_f32 v[26:27], v[26:27], v[156:157] op_sel_hi:[1,0]
    v_cvt_pk_bf16_f32 v68, v24, v25
    v_cvt_pk_bf16_f32 v69, v26, v27
    ds_write_b64 v146, v[68:69] offset:2048
    v_pk_mul_f32 v[28:29], v[28:29], v[156:157] op_sel_hi:[1,0]
    v_pk_mul_f32 v[30:31], v[30:31], v[156:157] op_sel_hi:[1,0]
    v_cvt_pk_bf16_f32 v70, v28, v29
    v_cvt_pk_bf16_f32 v71, v30, v31
    ds_write_b64 v146, v[70:71] offset:3072
    s_cmp_eq_u32 s80, 0
    s_cbranch_scc1 N1_154
    s_cmp_eq_u32 s80, 99
    s_cbranch_scc1 N1_154
    v_mfma_f32_16x16x32_bf16 v[44:47], v[10:13], v[48:51], 0
    v_mfma_f32_16x16x32_bf16 v[44:47], v[10:13], v[52:55], v[44:47]
    v_mfma_f32_16x16x32_bf16 v[44:47], v[10:13], v[56:59], v[44:47]
    v_mfma_f32_16x16x32_bf16 v[44:47], v[10:13], v[60:63], v[44:47]
    v_mfma_f32_16x16x32_bf16 v[44:47], v[10:13], v[176:179], v[44:47]
    v_mfma_f32_16x16x32_bf16 v[44:47], v[10:13], v[180:183], v[44:47]
    v_mfma_f32_16x16x32_bf16 v[44:47], v[10:13], v[184:187], v[44:47]
    v_mfma_f32_16x16x32_bf16 v[44:47], v[10:13], v[188:191], v[44:47]
    s_nop 7
    v_pk_add_f32 v[44:45], v[44:45], v[36:37]
    v_pk_add_f32 v[46:47], v[46:47], v[38:39]
    v_cvt_pk_bf16_f32 v44, v44, v45
    v_cvt_pk_bf16_f32 v45, v46, v47
    buffer_store_dwordx2 v[44:45], v8, s[64:67], s57 offen sc1
N1_154:
    s_waitcnt lgkmcnt(0)
    s_barrier
    ds_read_b128 v[72:75], v4 offset:49152
    ds_read_b128 v[76:79], v4 offset:50176
    ds_read_b128 v[80:83], v4 offset:51200
    ds_read_b128 v[84:87], v4 offset:52224
    ds_read_b128 v[88:91], v4 offset:53248
    ds_read_b128 v[92:95], v4 offset:54272
    ds_read_b128 v[96:99], v4 offset:55296
    ds_read_b128 v[100:103], v4 offset:56320
    s_add_u32 s69, s81, 163840
    buffer_load_dword v144, v7, s[40:43], s69 offen
    s_cmp_lg_u32 s34, 0
    s_cselect_b32 s63, 0, s80
    s_cmp_eq_u32 s80, 99
    s_cselect_b32 s63, 0, s63
    s_cmp_eq_u32 s63, 0
    s_cbranch_scc1 N2_155
    buffer_load_dwordx4 v[160:163], v9, s[40:43], s61 offen sc1
    s_add_u32 s73, s59, 4096
    buffer_load_dwordx4 v[104:107], v4, s[40:43], s59 offen offset:0 sc1
    buffer_load_dwordx4 v[108:111], v4, s[40:43], s59 offen offset:1024 sc1
    buffer_load_dwordx4 v[112:115], v4, s[40:43], s59 offen offset:2048 sc1
    buffer_load_dwordx4 v[116:119], v4, s[40:43], s59 offen offset:3072 sc1
    buffer_load_dwordx4 v[120:123], v4, s[40:43], s73 offen offset:0 sc1
    buffer_load_dwordx4 v[124:127], v4, s[40:43], s73 offen offset:1024 sc1
    buffer_load_dwordx4 v[128:131], v4, s[40:43], s73 offen offset:2048 sc1
    buffer_load_dwordx4 v[132:135], v4, s[40:43], s73 offen offset:3072 sc1
N2_155:
    s_waitcnt lgkmcnt(0)
    s_add_u32 s72, s84, s20
    v_mfma_f32_32x32x16_bf16 v[16:31], a[160:163], v[72:75], 0
    v_mfma_f32_32x32x16_bf16 v[16:31], a[164:167], v[76:79], v[16:31]
    v_mfma_f32_32x32x16_bf16 v[16:31], a[168:171], v[80:83], v[16:31]
    v_mfma_f32_32x32x16_bf16 v[16:31], a[172:175], v[84:87], v[16:31]
    v_mfma_f32_32x32x16_bf16 v[16:31], a[176:179], v[88:91], v[16:31]
    v_mfma_f32_32x32x16_bf16 v[16:31], a[180:183], v[92:95], v[16:31]
    v_mfma_f32_32x32x16_bf16 v[16:31], a[184:187], v[96:99], v[16:31]
    v_mfma_f32_32x32x16_bf16 v[16:31], a[188:191], v[100:103], v[16:31]
    v_mfma_f32_32x32x16_bf16 v[32:47], a[192:195], v[72:75], 0
    v_mfma_f32_32x32x16_bf16 v[32:47], a[196:199], v[76:79], v[32:47]
    v_mfma_f32_32x32x16_bf16 v[32:47], a[200:203], v[80:83], v[32:47]
    v_cvt_pk_bf16_f32 v64, v16, v17
    v_cvt_pk_bf16_f32 v65, v18, v19
    v_cvt_pk_bf16_f32 v66, v20, v21
    v_cvt_pk_bf16_f32 v67, v22, v23
    v_cvt_pk_bf16_f32 v68, v24, v25
    v_cvt_pk_bf16_f32 v69, v26, v27
    v_cvt_pk_bf16_f32 v70, v28, v29
    v_cvt_pk_bf16_f32 v71, v30, v31
    s_add_u32 s73, s72, 16384
    buffer_store_dwordx4 v[64:67], v6, s[40:43], s72 offen sc1
    buffer_store_dwordx4 v[68:71], v6, s[40:43], s73 offen sc1
    s_add_u32 s72, s72, 0x40000
    v_mfma_f32_32x32x16_bf16 v[32:47], a[204:207], v[84:87], v[32:47]
    v_mfma_f32_32x32x16_bf16 v[32:47], a[208:211], v[88:91], v[32:47]
    v_mfma_f32_32x32x16_bf16 v[32:47], a[212:215], v[92:95], v[32:47]
    v_mfma_f32_32x32x16_bf16 v[32:47], a[216:219], v[96:99], v[32:47]
    v_mfma_f32_32x32x16_bf16 v[32:47], a[220:223], v[100:103], v[32:47]
    v_mfma_f32_32x32x16_bf16 v[16:31], a[224:227], v[72:75], 0
    v_mfma_f32_32x32x16_bf16 v[16:31], a[228:231], v[76:79], v[16:31]
    v_mfma_f32_32x32x16_bf16 v[16:31], a[232:235], v[80:83], v[16:31]
    v_cvt_pk_bf16_f32 v64, v32, v33
    v_cvt_pk_bf16_f32 v65, v34, v35
    v_cvt_pk_bf16_f32 v66, v36, v37
    v_cvt_pk_bf16_f32 v67, v38, v39
    v_cvt_pk_bf16_f32 v68, v40, v41
    v_cvt_pk_bf16_f32 v69, v42, v43
    v_cvt_pk_bf16_f32 v70, v44, v45
    v_cvt_pk_bf16_f32 v71, v46, v47
    s_add_u32 s73, s72, 16384
    buffer_store_dwordx4 v[64:67], v6, s[40:43], s72 offen sc1
    buffer_store_dwordx4 v[68:71], v6, s[40:43], s73 offen sc1
    s_add_u32 s72, s72, 0x40000
    v_mfma_f32_32x32x16_bf16 v[16:31], a[236:239], v[84:87], v[16:31]
    v_mfma_f32_32x32x16_bf16 v[16:31], a[240:243], v[88:91], v[16:31]
    v_mfma_f32_32x32x16_bf16 v[16:31], a[244:247], v[92:95], v[16:31]
    v_mfma_f32_32x32x16_bf16 v[16:31], a[248:251], v[96:99], v[16:31]
    v_mfma_f32_32x32x16_bf16 v[16:31], a[252:255], v[100:103], v[16:31]
    v_mfma_f32_32x32x16_bf16 v[32:47], v[192:195], v[72:75], 0
    v_mfma_f32_32x32x16_bf16 v[32:47], v[196:199], v[76:79], v[32:47]
    v_mfma_f32_32x32x16_bf16 v[32:47], v[200:203], v[80:83], v[32:47]
    v_cvt_pk_bf16_f32 v64, v16, v17
    v_cvt_pk_bf16_f32 v65, v18, v19
    v_cvt_pk_bf16_f32 v66, v20, v21
    v_cvt_pk_bf16_f32 v67, v22, v23
    v_cvt_pk_bf16_f32 v68, v24, v25
    v_cvt_pk_bf16_f32 v69, v26, v27
    v_cvt_pk_bf16_f32 v70, v28, v29
    v_cvt_pk_bf16_f32 v71, v30, v31
    s_add_u32 s73, s72, 16384
    buffer_store_dwordx4 v[64:67], v6, s[40:43], s72 offen sc1
    buffer_store_dwordx4 v[68:71], v6, s[40:43], s73 offen sc1
    s_add_u32 s72, s72, 0x40000
    v_mfma_f32_32x32x16_bf16 v[32:47], v[204:207], v[84:87], v[32:47]
    v_mfma_f32_32x32x16_bf16 v[32:47], v[208:211], v[88:91], v[32:47]
    v_mfma_f32_32x32x16_bf16 v[32:47], v[212:215], v[92:95], v[32:47]
    v_mfma_f32_32x32x16_bf16 v[32:47], v[216:219], v[96:99], v[32:47]
    v_mfma_f32_32x32x16_bf16 v[32:47], v[220:223], v[100:103], v[32:47]
    v_mfma_f32_32x32x16_bf16 v[16:31], v[224:227], v[72:75], 0
    v_mfma_f32_32x32x16_bf16 v[16:31], v[228:231], v[76:79], v[16:31]
    v_mfma_f32_32x32x16_bf16 v[16:31], v[232:235], v[80:83], v[16:31]
    v_cvt_pk_bf16_f32 v64, v32, v33
    v_cvt_pk_bf16_f32 v65, v34, v35
    v_cvt_pk_bf16_f32 v66, v36, v37
    v_cvt_pk_bf16_f32 v67, v38, v39
    v_cvt_pk_bf16_f32 v68, v40, v41
    v_cvt_pk_bf16_f32 v69, v42, v43
    v_cvt_pk_bf16_f32 v70, v44, v45
    v_cvt_pk_bf16_f32 v71, v46, v47
    s_add_u32 s73, s72, 16384
    buffer_store_dwordx4 v[64:67], v6, s[40:43], s72 offen sc1
    buffer_store_dwordx4 v[68:71], v6, s[40:43], s73 offen sc1
    s_add_u32 s72, s72, 0x40000
    v_mfma_f32_32x32x16_bf16 v[16:31], v[236:239], v[84:87], v[16:31]
    v_mfma_f32_32x32x16_bf16 v[16:31], v[240:243], v[88:91], v[16:31]
    v_mfma_f32_32x32x16_bf16 v[16:31], v[244:247], v[92:95], v[16:31]
    v_mfma_f32_32x32x16_bf16 v[16:31], v[248:251], v[96:99], v[16:31]
    v_mfma_f32_32x32x16_bf16 v[16:31], v[252:255], v[100:103], v[16:31]
    s_nop 11
    v_cvt_pk_bf16_f32 v64, v16, v17
    v_cvt_pk_bf16_f32 v65, v18, v19
    v_cvt_pk_bf16_f32 v66, v20, v21
    v_cvt_pk_bf16_f32 v67, v22, v23
    v_cvt_pk_bf16_f32 v68, v24, v25
    v_cvt_pk_bf16_f32 v69, v26, v27
    v_cvt_pk_bf16_f32 v70, v28, v29
    v_cvt_pk_bf16_f32 v71, v30, v31
    s_add_u32 s73, s72, 16384
    buffer_store_dwordx4 v[64:67], v6, s[40:43], s72 offen sc1
    buffer_store_dwordx4 v[68:71], v6, s[40:43], s73 offen sc1
    s_add_u32 s72, s72, 0x40000
    s_cmp_eq_u32 s63, 0
    s_cbranch_scc1 N3_156
    s_waitcnt vmcnt(17)
    v_mfma_f32_16x16x32_bf16 v[136:139], v[10:13], v[104:107], 0
    s_waitcnt vmcnt(16)
    v_mfma_f32_16x16x32_bf16 v[136:139], v[10:13], v[108:111], v[136:139]
    s_waitcnt vmcnt(15)
    v_mfma_f32_16x16x32_bf16 v[136:139], v[10:13], v[112:115], v[136:139]
    s_waitcnt vmcnt(14)
    v_mfma_f32_16x16x32_bf16 v[136:139], v[10:13], v[116:119], v[136:139]
    s_waitcnt vmcnt(13)
    v_mfma_f32_16x16x32_bf16 v[136:139], v[10:13], v[120:123], v[136:139]
    s_waitcnt vmcnt(12)
    v_mfma_f32_16x16x32_bf16 v[136:139], v[10:13], v[124:127], v[136:139]
    s_waitcnt vmcnt(11)
    v_mfma_f32_16x16x32_bf16 v[136:139], v[10:13], v[128:131], v[136:139]
    s_waitcnt vmcnt(10)
    v_mfma_f32_16x16x32_bf16 v[136:139], v[10:13], v[132:135], v[136:139]
    s_nop 7
    v_pk_add_f32 v[136:137], v[136:137], v[160:161]
    v_pk_add_f32 v[138:139], v[138:139], v[162:163]
    v_cvt_pk_bf16_f32 v136, v136, v137
    v_cvt_pk_bf16_f32 v137, v138, v139
    buffer_store_dwordx2 v[136:137], v8, s[64:67], s60 offen sc1
N3_156:
    s_mov_b32 s48, s56
    s_mov_b32 s49, s57
    s_mov_b32 s50, s58
    s_mov_b32 s51, s59
    s_mov_b32 s52, s60
    s_mov_b32 s53, s61
    s_lshl_b32 s71, s35, 2
    s_add_u32 s71, s71, s34
    s_lshl_b32 s56, s71, 13
    s_add_u32 s56, s56, s85
    s_add_u32 s56, s56, s20
    s_and_b32 s57, s71, 1
    s_mul_i32 s57, s57, 20480
    s_lshr_b32 s58, s71, 1
    s_lshl_b32 s58, s58, 4
    s_add_u32 s57, s57, s58
    s_add_u32 s57, s57, s24
    s_lshl_b32 s58, s71, 9
    s_add_u32 s58, s58, s25
    s_add_u32 s71, s35, 128
    s_lshl_b32 s59, s71, 13
    s_add_u32 s59, s59, s85
    s_add_u32 s59, s59, s20
    s_and_b32 s60, s71, 1
    s_mul_i32 s60, s60, 20480
    s_lshr_b32 s61, s71, 1
    s_lshl_b32 s61, s61, 4
    s_add_u32 s60, s60, s61
    s_add_u32 s60, s60, s24
    s_lshl_b32 s61, s71, 9
    s_add_u32 s61, s61, s25
    s_cmp_eq_u32 s34, 0
    s_cselect_b32 s59, s59, 0x40000000
    s_cselect_b32 s60, s60, 0x40000000
    s_cselect_b32 s61, s61, 0x40000000
    s_add_u32 s26, s26, 0x80000
    s_add_u32 s31, s31, 0x40000
    s_add_u32 s32, s32, 0x20000
    s_xor_b32 s20, s20, 0x140000
    s_add_u32 s24, s24, 81920
    s_add_u32 s25, s25, 163840
    v_xor_b32 v5, 0x10000, v5
    s_add_u32 s80, s80, 1
    s_cmp_lt_u32 s80, 32
    s_branch NL_157
    s_cmp_lg_u32 s80, 31
    s_cbranch_scc1 NL_157
    s_mul_i32 s85, s83, 1310720
    s_add_u32 s85, s85, 0x4500000
    s_lshl_b32 s69, s35, 8
    s_add_u32 s84, s85, s69
    s_mov_b32 s20, 0
NL_157:
    s_cmp_lt_u32 s80, 32
    s_cbranch_scc1 QAO_LOOP_safe
    s_add_u32 s69, s80, 0
    s_cmp_ge_u32 s62, s69
    s_cbranch_scc1 BOK_158
    s_mov_b32 s38, 262144
PL_159:
    buffer_load_dword v2, off, s[40:43], s23 sc1
    s_waitcnt vmcnt(0)
    v_readfirstlane_b32 s62, v2
    s_cmp_lt_u32 s62, s69
    s_cbranch_scc1 PN_160
    s_branch PO_161
PN_160:
    s_sleep 1
    s_sub_u32 s38, s38, 1
    s_cbranch_scc0 PL_159
    s_mov_b32 s68, 42
    s_branch FAIL
PO_161:
BOK_158:
    buffer_load_dwordx4 v[140:143], v9, s[40:43], s58 offen sc1
    buffer_load_dwordx4 v[176:179], v9, s[40:43], s61 offen sc1
    s_waitcnt vmcnt(2)
    s_barrier
    s_cmp_lg_u32 s34, 0
    s_cbranch_scc1 W0_162
    v_mov_b32 v1, s80
    s_mov_b64 exec, 1
    buffer_store_dword v1, off, s[40:43], s22 sc1
    s_mov_b64 exec, -1
W0_162:
    s_add_u32 s69, s80, 0
    v_and_b32 v1, 31, v0
    v_lshlrev_b32 v1, 2, v1
    s_mov_b32 s38, 262144
PL_163:
    buffer_load_dword v2, v1, s[40:43], s21 offen sc1
    s_waitcnt vmcnt(0)
    v_cmp_gt_u32 vcc, s69, v2
    s_cbranch_vccnz PN_164
    s_branch PO_165
PN_164:
    s_sleep 1
    s_sub_u32 s38, s38, 1
    s_cbranch_scc0 PL_163
    s_mov_b32 s68, 44
    s_branch FAIL
PO_165:
    s_mov_b32 s38, 262144
    s_add_u32 s73, s56, 4096
    buffer_load_dwordx4 v[104:107], v4, s[40:43], s56 offen offset:0 sc1
    buffer_load_dwordx4 v[108:111], v4, s[40:43], s56 offen offset:1024 sc1
    buffer_load_dwordx4 v[112:115], v4, s[40:43], s56 offen offset:2048 sc1
    buffer_load_dwordx4 v[116:119], v4, s[40:43], s56 offen offset:3072 sc1
    buffer_load_dwordx4 v[120:123], v4, s[40:43], s73 offen offset:0 sc1
    buffer_load_dwordx4 v[124:127], v4, s[40:43], s73 offen offset:1024 sc1
    buffer_load_dwordx4 v[128:131], v4, s[40:43], s73 offen offset:2048 sc1
    buffer_load_dwordx4 v[132:135], v4, s[40:43], s73 offen offset:3072 sc1
    s_cmp_lg_u32 s34, 0
    s_cbranch_scc1 RONE_167
    s_add_u32 s73, s59, 4096
    buffer_load_dwordx4 v[72:75], v4, s[40:43], s59 offen offset:0 sc1
    buffer_load_dwordx4 v[76:79], v4, s[40:43], s59 offen offset:1024 sc1
    buffer_load_dwordx4 v[80:83], v4, s[40:43], s59 offen offset:2048 sc1
    buffer_load_dwordx4 v[84:87], v4, s[40:43], s59 offen offset:3072 sc1
    buffer_load_dwordx4 v[88:91], v4, s[40:43], s73 offen offset:0 sc1
    buffer_load_dwordx4 v[92:95], v4, s[40:43], s73 offen offset:1024 sc1
    buffer_load_dwordx4 v[96:99], v4, s[40:43], s73 offen offset:2048 sc1
    buffer_load_dwordx4 v[100:103], v4, s[40:43], s73 offen offset:3072 sc1
    s_waitcnt vmcnt(15)
    v_mfma_f32_16x16x32_bf16 v[136:139], v[10:13], v[104:107], 0
    s_waitcnt vmcnt(14)
    v_mfma_f32_16x16x32_bf16 v[136:139], v[10:13], v[108:111], v[136:139]
    s_waitcnt vmcnt(13)
    v_mfma_f32_16x16x32_bf16 v[136:139], v[10:13], v[112:115], v[136:139]
    s_waitcnt vmcnt(12)
    v_mfma_f32_16x16x32_bf16 v[136:139], v[10:13], v[116:119], v[136:139]
    s_waitcnt vmcnt(11)
    v_mfma_f32_16x16x32_bf16 v[136:139], v[10:13], v[120:123], v[136:139]
    s_waitcnt vmcnt(10)
    v_mfma_f32_16x16x32_bf16 v[136:139], v[10:13], v[124:127], v[136:139]
    s_waitcnt vmcnt(9)
    v_mfma_f32_16x16x32_bf16 v[136:139], v[10:13], v[128:131], v[136:139]
    s_waitcnt vmcnt(8)
    v_mfma_f32_16x16x32_bf16 v[136:139], v[10:13], v[132:135], v[136:139]
    s_nop 7
    v_pk_add_f32 v[136:137], v[136:137], v[140:141]
    v_pk_add_f32 v[138:139], v[138:139], v[142:143]
    v_cvt_pk_bf16_f32 v136, v136, v137
    v_cvt_pk_bf16_f32 v137, v138, v139
    buffer_store_dwordx2 v[136:137], v8, s[64:67], s57 offen sc1
    s_waitcnt vmcnt(8)
    v_mfma_f32_16x16x32_bf16 v[16:19], v[10:13], v[72:75], 0
    s_waitcnt vmcnt(7)
    v_mfma_f32_16x16x32_bf16 v[16:19], v[10:13], v[76:79], v[16:19]
    s_waitcnt vmcnt(6)
    v_mfma_f32_16x16x32_bf16 v[16:19], v[10:13], v[80:83], v[16:19]
    s_waitcnt vmcnt(5)
    v_mfma_f32_16x16x32_bf16 v[16:19], v[10:13], v[84:87], v[16:19]
    s_waitcnt vmcnt(4)
    v_mfma_f32_16x16x32_bf16 v[16:19], v[10:13], v[88:91], v[16:19]
    s_waitcnt vmcnt(3)
    v_mfma_f32_16x16x32_bf16 v[16:19], v[10:13], v[92:95], v[16:19]
    s_waitcnt vmcnt(2)
    v_mfma_f32_16x16x32_bf16 v[16:19], v[10:13], v[96:99], v[16:19]
    s_waitcnt vmcnt(1)
    v_mfma_f32_16x16x32_bf16 v[16:19], v[10:13], v[100:103], v[16:19]
    s_nop 7
    v_pk_add_f32 v[16:17], v[16:17], v[176:177]
    v_pk_add_f32 v[18:19], v[18:19], v[178:179]
    v_cvt_pk_bf16_f32 v16, v16, v17
    v_cvt_pk_bf16_f32 v17, v18, v19
    buffer_store_dwordx2 v[16:17], v8, s[64:67], s60 offen sc1
    s_branch RW0_166
RONE_167:
    s_waitcnt vmcnt(7)
    v_mfma_f32_16x16x32_bf16 v[136:139], v[10:13], v[104:107], 0
    s_waitcnt vmcnt(6)
    v_mfma_f32_16x16x32_bf16 v[136:139], v[10:13], v[108:111], v[136:139]
    s_waitcnt vmcnt(5)
    v_mfma_f32_16x16x32_bf16 v[136:139], v[10:13], v[112:115], v[136:139]
    s_waitcnt vmcnt(4)
    v_mfma_f32_16x16x32_bf16 v[136:139], v[10:13], v[116:119], v[136:139]
    s_waitcnt vmcnt(3)
    v_mfma_f32_16x16x32_bf16 v[136:139], v[10:13], v[120:123], v[136:139]
    s_waitcnt vmcnt(2)
    v_mfma_f32_16x16x32_bf16 v[136:139], v[10:13], v[124:127], v[136:139]
    s_waitcnt vmcnt(1)
    v_mfma_f32_16x16x32_bf16 v[136:139], v[10:13], v[128:131], v[136:139]
    s_waitcnt vmcnt(0)
    v_mfma_f32_16x16x32_bf16 v[136:139], v[10:13], v[132:135], v[136:139]
    s_nop 7
    v_pk_add_f32 v[136:137], v[136:137], v[140:141]
    v_pk_add_f32 v[138:139], v[138:139], v[142:143]
    v_cvt_pk_bf16_f32 v136, v136, v137
    v_cvt_pk_bf16_f32 v137, v138, v139
    buffer_store_dwordx2 v[136:137], v8, s[64:67], s57 offen sc1
RW0_166:
    s_branch END
ROLE_FFN:
    s_and_b32 s80, s36, 1
    s_lshl_b32 s80, s80, 5
    s_add_u32 s80, s80, s35
    s_add_u32 s80, s80, 64
    s_mov_b32 s64, s4
    s_mov_b32 s65, s5
    s_mov_b32 s66, 0x280000
    s_mov_b32 s67, 0x20000
    v_bfe_u32 v2, v0, 4, 4
    s_mov_b32 s75, 1280
    v_mul_u32_u24 v1, s75, v2
    v_bfe_u32 v2, v0, 0, 4
    v_lshl_add_u32 v1, v2, 4, v1
    s_mul_i32 s69, s80, 20480
    buffer_load_dwordx4 v[8:11], v1, s[64:67], s69 offen offset:0
    buffer_load_dwordx4 v[12:15], v1, s[64:67], s69 offen offset:256
    buffer_load_dwordx4 v[16:19], v1, s[64:67], s69 offen offset:512
    buffer_load_dwordx4 v[20:23], v1, s[64:67], s69 offen offset:768
    buffer_load_dwordx4 v[24:27], v1, s[64:67], s69 offen offset:1024
    v_bfe_u32 v2, v0, 1, 3
    v_lshlrev_b32 v3, 10, v2
    v_bfe_u32 v2, v0, 0, 1
    v_lshl_add_u32 v3, v2, 9, v3
    v_bfe_u32 v2, v0, 4, 4
    v_lshl_add_u32 v3, v2, 4, v3
    s_lshr_b32 s70, s80, 1
    s_mul_i32 s70, s70, 40960
    s_and_b32 s71, s80, 1
    s_lshl_b32 s71, s71, 8
    s_add_u32 s70, s70, s71
    s_add_u32 s70, s70, 0x100000
    s_waitcnt vmcnt(0)
    s_cmp_lg_u32 s34, 1
    s_cbranch_scc1 CI_168
    s_cmp_eq_u32 s101, 0
    s_cbranch_scc1 CI_168
    s_waitcnt vmcnt(0)
    s_lshl_b32 s68, s33, 5
    s_add_u32 s68, s68, 16
    v_mov_b32 v30, 1
    s_mov_b64 exec, 1
    buffer_atomic_add v30, off, s[44:47], s68
    s_mov_b64 exec, -1
CI_168:
    s_mov_b32 s60, s8
    s_mov_b32 s61, s9
    s_mov_b32 s62, 0x500000
    s_mov_b32 s63, 0x20000
    s_mul_i32 s72, s80, 40960
    v_bfe_u32 v2, v0, 0, 6
    v_lshlrev_b32 v29, 7, v2
    s_lshl_b32 s73, s34, 13
    s_add_u32 s73, s73, s72
    s_add_u32 s74, s73, 0
    buffer_load_dword v255, v29, s[60:63], s74 offen
    s_cmp_lg_u32 s34, 3
    s_cbranch_scc1 TT_169
    s_add_u32 s74, s72, 32768
    buffer_load_dword v255, v29, s[60:63], s74 offen
TT_169:
    v_lshlrev_b32 v32, 16, v8
    v_and_b32 v33, 0xffff0000, v8
    v_lshlrev_b32 v34, 16, v9
    v_and_b32 v35, 0xffff0000, v9
    v_lshlrev_b32 v36, 16, v10
    v_and_b32 v37, 0xffff0000, v10
    v_lshlrev_b32 v38, 16, v11
    v_and_b32 v39, 0xffff0000, v11
    v_lshlrev_b32 v40, 16, v12
    v_and_b32 v41, 0xffff0000, v12
    v_lshlrev_b32 v42, 16, v13
    v_and_b32 v43, 0xffff0000, v13
    v_lshlrev_b32 v44, 16, v14
    v_and_b32 v45, 0xffff0000, v14
    v_lshlrev_b32 v46, 16, v15
    v_and_b32 v47, 0xffff0000, v15
    v_lshlrev_b32 v48, 16, v16
    v_and_b32 v49, 0xffff0000, v16
    v_lshlrev_b32 v50, 16, v17
    v_and_b32 v51, 0xffff0000, v17
    v_lshlrev_b32 v52, 16, v18
    v_and_b32 v53, 0xffff0000, v18
    v_lshlrev_b32 v54, 16, v19
    v_and_b32 v55, 0xffff0000, v19
    v_lshlrev_b32 v56, 16, v20
    v_and_b32 v57, 0xffff0000, v20
    v_lshlrev_b32 v58, 16, v21
    v_and_b32 v59, 0xffff0000, v21
    v_lshlrev_b32 v60, 16, v22
    v_and_b32 v61, 0xffff0000, v22
    v_lshlrev_b32 v62, 16, v23
    v_and_b32 v63, 0xffff0000, v23
    v_lshlrev_b32 v64, 16, v24
    v_and_b32 v65, 0xffff0000, v24
    v_lshlrev_b32 v66, 16, v25
    v_and_b32 v67, 0xffff0000, v25
    v_lshlrev_b32 v68, 16, v26
    v_and_b32 v69, 0xffff0000, v26
    v_lshlrev_b32 v70, 16, v27
    v_and_b32 v71, 0xffff0000, v27
    v_pk_add_f32 v[4:5], v[32:33], v[34:35]
    v_pk_add_f32 v[4:5], v[4:5], v[36:37]
    v_pk_add_f32 v[4:5], v[4:5], v[38:39]
    v_pk_add_f32 v[4:5], v[4:5], v[40:41]
    v_pk_add_f32 v[4:5], v[4:5], v[42:43]
    v_pk_add_f32 v[4:5], v[4:5], v[44:45]
    v_pk_add_f32 v[4:5], v[4:5], v[46:47]
    v_pk_add_f32 v[4:5], v[4:5], v[48:49]
    v_pk_add_f32 v[4:5], v[4:5], v[50:51]
    v_pk_add_f32 v[4:5], v[4:5], v[52:53]
    v_pk_add_f32 v[4:5], v[4:5], v[54:55]
    v_pk_add_f32 v[4:5], v[4:5], v[56:57]
    v_pk_add_f32 v[4:5], v[4:5], v[58:59]
    v_pk_add_f32 v[4:5], v[4:5], v[60:61]
    v_pk_add_f32 v[4:5], v[4:5], v[62:63]
    v_pk_add_f32 v[4:5], v[4:5], v[64:65]
    v_pk_add_f32 v[4:5], v[4:5], v[66:67]
    v_pk_add_f32 v[4:5], v[4:5], v[68:69]
    v_pk_add_f32 v[4:5], v[4:5], v[70:71]
    v_add_f32 v4, v4, v5
    s_nop 1
    v_add_f32_dpp v4, v4, v4 row_ror:8 row_mask:0xf bank_mask:0xf
    s_nop 1
    v_add_f32_dpp v4, v4, v4 row_ror:4 row_mask:0xf bank_mask:0xf
    s_nop 1
    v_add_f32_dpp v4, v4, v4 row_ror:2 row_mask:0xf bank_mask:0xf
    s_nop 1
    v_add_f32_dpp v4, v4, v4 row_ror:1 row_mask:0xf bank_mask:0xf
    v_mul_f32 v4, 0x3acccccd, v4
    v_mov_b32 v5, 0
    v_mov_b32 v6, 0
    v_sub_f32 v7, v32, v4
    v_sub_f32 v28, v33, v4
    v_fmac_f32 v5, v7, v7
    v_fmac_f32 v6, v28, v28
    v_sub_f32 v7, v34, v4
    v_sub_f32 v28, v35, v4
    v_fmac_f32 v5, v7, v7
    v_fmac_f32 v6, v28, v28
    v_sub_f32 v7, v36, v4
    v_sub_f32 v28, v37, v4
    v_fmac_f32 v5, v7, v7
    v_fmac_f32 v6, v28, v28
    v_sub_f32 v7, v38, v4
    v_sub_f32 v28, v39, v4
    v_fmac_f32 v5, v7, v7
    v_fmac_f32 v6, v28, v28
    v_sub_f32 v7, v40, v4
    v_sub_f32 v28, v41, v4
    v_fmac_f32 v5, v7, v7
    v_fmac_f32 v6, v28, v28
    v_sub_f32 v7, v42, v4
    v_sub_f32 v28, v43, v4
    v_fmac_f32 v5, v7, v7
    v_fmac_f32 v6, v28, v28
    v_sub_f32 v7, v44, v4
    v_sub_f32 v28, v45, v4
    v_fmac_f32 v5, v7, v7
    v_fmac_f32 v6, v28, v28
    v_sub_f32 v7, v46, v4
    v_sub_f32 v28, v47, v4
    v_fmac_f32 v5, v7, v7
    v_fmac_f32 v6, v28, v28
    v_sub_f32 v7, v48, v4
    v_sub_f32 v28, v49, v4
    v_fmac_f32 v5, v7, v7
    v_fmac_f32 v6, v28, v28
    v_sub_f32 v7, v50, v4
    v_sub_f32 v28, v51, v4
    v_fmac_f32 v5, v7, v7
    v_fmac_f32 v6, v28, v28
    v_sub_f32 v7, v52, v4
    v_sub_f32 v28, v53, v4
    v_fmac_f32 v5, v7, v7
    v_fmac_f32 v6, v28, v28
    v_sub_f32 v7, v54, v4
    v_sub_f32 v28, v55, v4
    v_fmac_f32 v5, v7, v7
    v_fmac_f32 v6, v28, v28
    v_sub_f32 v7, v56, v4
    v_sub_f32 v28, v57, v4
    v_fmac_f32 v5, v7, v7
    v_fmac_f32 v6, v28, v28
    v_sub_f32 v7, v58, v4
    v_sub_f32 v28, v59, v4
    v_fmac_f32 v5, v7, v7
    v_fmac_f32 v6, v28, v28
    v_sub_f32 v7, v60, v4
    v_sub_f32 v28, v61, v4
    v_fmac_f32 v5, v7, v7
    v_fmac_f32 v6, v28, v28
    v_sub_f32 v7, v62, v4
    v_sub_f32 v28, v63, v4
    v_fmac_f32 v5, v7, v7
    v_fmac_f32 v6, v28, v28
    v_sub_f32 v7, v64, v4
    v_sub_f32 v28, v65, v4
    v_fmac_f32 v5, v7, v7
    v_fmac_f32 v6, v28, v28
    v_sub_f32 v7, v66, v4
    v_sub_f32 v28, v67, v4
    v_fmac_f32 v5, v7, v7
    v_fmac_f32 v6, v28, v28
    v_sub_f32 v7, v68, v4
    v_sub_f32 v28, v69, v4
    v_fmac_f32 v5, v7, v7
    v_fmac_f32 v6, v28, v28
    v_sub_f32 v7, v70, v4
    v_sub_f32 v28, v71, v4
    v_fmac_f32 v5, v7, v7
    v_fmac_f32 v6, v28, v28
    v_add_f32 v5, v5, v6
    s_nop 1
    v_add_f32_dpp v5, v5, v5 row_ror:8 row_mask:0xf bank_mask:0xf
    s_nop 1
    v_add_f32_dpp v5, v5, v5 row_ror:4 row_mask:0xf bank_mask:0xf
    s_nop 1
    v_add_f32_dpp v5, v5, v5 row_ror:2 row_mask:0xf bank_mask:0xf
    s_nop 1
    v_add_f32_dpp v5, v5, v5 row_ror:1 row_mask:0xf bank_mask:0xf
    v_mul_f32 v5, 0x3acccccd, v5
    v_cvt_pk_bf16_f32 v4, v4, v4
    v_lshlrev_b32 v4, 16, v4
    v_cvt_pk_bf16_f32 v5, v5, v5
    v_lshlrev_b32 v5, 16, v5
    v_add_f32 v5, 0x3727c5ac, v5
    v_cvt_pk_bf16_f32 v5, v5, v5
    v_lshlrev_b32 v5, 16, v5
    v_sqrt_f32 v5, v5
    s_nop 0
    v_cvt_pk_bf16_f32 v5, v5, v5
    v_lshlrev_b32 v5, 16, v5
    v_rcp_f32 v5, v5
    v_sub_f32 v32, v32, v4
    v_sub_f32 v33, v33, v4
    v_cvt_pk_bf16_f32 v7, v32, v33
    v_lshlrev_b32 v28, 16, v7
    v_and_b32 v7, 0xffff0000, v7
    v_mul_f32 v28, v28, v5
    v_mul_f32 v7, v7, v5
    v_cvt_pk_bf16_f32 v8, v28, v7
    v_sub_f32 v34, v34, v4
    v_sub_f32 v35, v35, v4
    v_cvt_pk_bf16_f32 v7, v34, v35
    v_lshlrev_b32 v28, 16, v7
    v_and_b32 v7, 0xffff0000, v7
    v_mul_f32 v28, v28, v5
    v_mul_f32 v7, v7, v5
    v_cvt_pk_bf16_f32 v9, v28, v7
    v_sub_f32 v36, v36, v4
    v_sub_f32 v37, v37, v4
    v_cvt_pk_bf16_f32 v7, v36, v37
    v_lshlrev_b32 v28, 16, v7
    v_and_b32 v7, 0xffff0000, v7
    v_mul_f32 v28, v28, v5
    v_mul_f32 v7, v7, v5
    v_cvt_pk_bf16_f32 v10, v28, v7
    v_sub_f32 v38, v38, v4
    v_sub_f32 v39, v39, v4
    v_cvt_pk_bf16_f32 v7, v38, v39
    v_lshlrev_b32 v28, 16, v7
    v_and_b32 v7, 0xffff0000, v7
    v_mul_f32 v28, v28, v5
    v_mul_f32 v7, v7, v5
    v_cvt_pk_bf16_f32 v11, v28, v7
    v_sub_f32 v40, v40, v4
    v_sub_f32 v41, v41, v4
    v_cvt_pk_bf16_f32 v7, v40, v41
    v_lshlrev_b32 v28, 16, v7
    v_and_b32 v7, 0xffff0000, v7
    v_mul_f32 v28, v28, v5
    v_mul_f32 v7, v7, v5
    v_cvt_pk_bf16_f32 v12, v28, v7
    v_sub_f32 v42, v42, v4
    v_sub_f32 v43, v43, v4
    v_cvt_pk_bf16_f32 v7, v42, v43
    v_lshlrev_b32 v28, 16, v7
    v_and_b32 v7, 0xffff0000, v7
    v_mul_f32 v28, v28, v5
    v_mul_f32 v7, v7, v5
    v_cvt_pk_bf16_f32 v13, v28, v7
    v_sub_f32 v44, v44, v4
    v_sub_f32 v45, v45, v4
    v_cvt_pk_bf16_f32 v7, v44, v45
    v_lshlrev_b32 v28, 16, v7
    v_and_b32 v7, 0xffff0000, v7
    v_mul_f32 v28, v28, v5
    v_mul_f32 v7, v7, v5
    v_cvt_pk_bf16_f32 v14, v28, v7
    v_sub_f32 v46, v46, v4
    v_sub_f32 v47, v47, v4
    v_cvt_pk_bf16_f32 v7, v46, v47
    v_lshlrev_b32 v28, 16, v7
    v_and_b32 v7, 0xffff0000, v7
    v_mul_f32 v28, v28, v5
    v_mul_f32 v7, v7, v5
    v_cvt_pk_bf16_f32 v15, v28, v7
    v_sub_f32 v48, v48, v4
    v_sub_f32 v49, v49, v4
    v_cvt_pk_bf16_f32 v7, v48, v49
    v_lshlrev_b32 v28, 16, v7
    v_and_b32 v7, 0xffff0000, v7
    v_mul_f32 v28, v28, v5
    v_mul_f32 v7, v7, v5
    v_cvt_pk_bf16_f32 v16, v28, v7
    v_sub_f32 v50, v50, v4
    v_sub_f32 v51, v51, v4
    v_cvt_pk_bf16_f32 v7, v50, v51
    v_lshlrev_b32 v28, 16, v7
    v_and_b32 v7, 0xffff0000, v7
    v_mul_f32 v28, v28, v5
    v_mul_f32 v7, v7, v5
    v_cvt_pk_bf16_f32 v17, v28, v7
    v_sub_f32 v52, v52, v4
    v_sub_f32 v53, v53, v4
    v_cvt_pk_bf16_f32 v7, v52, v53
    v_lshlrev_b32 v28, 16, v7
    v_and_b32 v7, 0xffff0000, v7
    v_mul_f32 v28, v28, v5
    v_mul_f32 v7, v7, v5
    v_cvt_pk_bf16_f32 v18, v28, v7
    v_sub_f32 v54, v54, v4
    v_sub_f32 v55, v55, v4
    v_cvt_pk_bf16_f32 v7, v54, v55
    v_lshlrev_b32 v28, 16, v7
    v_and_b32 v7, 0xffff0000, v7
    v_mul_f32 v28, v28, v5
    v_mul_f32 v7, v7, v5
    v_cvt_pk_bf16_f32 v19, v28, v7
    v_sub_f32 v56, v56, v4
    v_sub_f32 v57, v57, v4
    v_cvt_pk_bf16_f32 v7, v56, v57
    v_lshlrev_b32 v28, 16, v7
    v_and_b32 v7, 0xffff0000, v7
    v_mul_f32 v28, v28, v5
    v_mul_f32 v7, v7, v5
    v_cvt_pk_bf16_f32 v20, v28, v7
    v_sub_f32 v58, v58, v4
    v_sub_f32 v59, v59, v4
    v_cvt_pk_bf16_f32 v7, v58, v59
    v_lshlrev_b32 v28, 16, v7
    v_and_b32 v7, 0xffff0000, v7
    v_mul_f32 v28, v28, v5
    v_mul_f32 v7, v7, v5
    v_cvt_pk_bf16_f32 v21, v28, v7
    v_sub_f32 v60, v60, v4
    v_sub_f32 v61, v61, v4
    v_cvt_pk_bf16_f32 v7, v60, v61
    v_lshlrev_b32 v28, 16, v7
    v_and_b32 v7, 0xffff0000, v7
    v_mul_f32 v28, v28, v5
    v_mul_f32 v7, v7, v5
    v_cvt_pk_bf16_f32 v22, v28, v7
    v_sub_f32 v62, v62, v4
    v_sub_f32 v63, v63, v4
    v_cvt_pk_bf16_f32 v7, v62, v63
    v_lshlrev_b32 v28, 16, v7
    v_and_b32 v7, 0xffff0000, v7
    v_mul_f32 v28, v28, v5
    v_mul_f32 v7, v7, v5
    v_cvt_pk_bf16_f32 v23, v28, v7
    v_sub_f32 v64, v64, v4
    v_sub_f32 v65, v65, v4
    v_cvt_pk_bf16_f32 v7, v64, v65
    v_lshlrev_b32 v28, 16, v7
    v_and_b32 v7, 0xffff0000, v7
    v_mul_f32 v28, v28, v5
    v_mul_f32 v7, v7, v5
    v_cvt_pk_bf16_f32 v24, v28, v7
    v_sub_f32 v66, v66, v4
    v_sub_f32 v67, v67, v4
    v_cvt_pk_bf16_f32 v7, v66, v67
    v_lshlrev_b32 v28, 16, v7
    v_and_b32 v7, 0xffff0000, v7
    v_mul_f32 v28, v28, v5
    v_mul_f32 v7, v7, v5
    v_cvt_pk_bf16_f32 v25, v28, v7
    v_sub_f32 v68, v68, v4
    v_sub_f32 v69, v69, v4
    v_cvt_pk_bf16_f32 v7, v68, v69
    v_lshlrev_b32 v28, 16, v7
    v_and_b32 v7, 0xffff0000, v7
    v_mul_f32 v28, v28, v5
    v_mul_f32 v7, v7, v5
    v_cvt_pk_bf16_f32 v26, v28, v7
    v_sub_f32 v70, v70, v4
    v_sub_f32 v71, v71, v4
    v_cvt_pk_bf16_f32 v7, v70, v71
    v_lshlrev_b32 v28, 16, v7
    v_and_b32 v7, 0xffff0000, v7
    v_mul_f32 v28, v28, v5
    v_mul_f32 v7, v7, v5
    v_cvt_pk_bf16_f32 v27, v28, v7
    buffer_store_dwordx4 v[8:11], v3, s[40:43], s70 offen sc1
    s_add_u32 s70, s70, 8192
    buffer_store_dwordx4 v[12:15], v3, s[40:43], s70 offen sc1
    s_add_u32 s70, s70, 8192
    buffer_store_dwordx4 v[16:19], v3, s[40:43], s70 offen sc1
    s_add_u32 s70, s70, 8192
    buffer_store_dwordx4 v[20:23], v3, s[40:43], s70 offen sc1
    s_add_u32 s70, s70, 8192
    buffer_store_dwordx4 v[24:27], v3, s[40:43], s70 offen sc1
    s_waitcnt vmcnt(0)
    s_barrier
    v_mov_b32 v1, 0x4
    v_bfe_u32 v2, v0, 0, 3
    v_lshl_add_u32 v1, v2, 5, v1
    v_bfe_u32 v2, v0, 3, 1
    s_mov_b32 s75, 12
    v_mad_u32_u24 v1, v2, s75, v1
    s_mov_b32 s38, 262144
PL_170:
    buffer_load_dword v2, v1, s[44:47], 0 offen sc1
    s_waitcnt vmcnt(0)
    v_and_b32 v3, 8, v0
    v_cmp_ne_u32 vcc, 0, v3
    s_nop 1
    v_cndmask_b32 v3, 0, v2, vcc
    s_nop 1
    v_add_u32_dpp v3, v3, v3 row_ror:8 row_mask:0xf bank_mask:0xf
    s_nop 1
    v_add_u32_dpp v3, v3, v3 row_ror:4 row_mask:0xf bank_mask:0xf
    s_nop 1
    v_add_u32_dpp v3, v3, v3 quad_perm:[2,3,0,1] row_mask:0xf bank_mask:0xf
    s_nop 1
    v_add_u32_dpp v3, v3, v3 quad_perm:[1,0,3,2] row_mask:0xf bank_mask:0xf
    v_cmp_gt_u32 vcc, 0x100, v3
    s_cbranch_vccnz PN_171
    s_branch PO_172
PN_171:
    s_sleep 1
    s_sub_u32 s38, s38, 1
    s_cbranch_scc0 PL_170
    s_mov_b32 s68, 2
    s_branch FAIL
PO_172:
    s_cmp_eq_u32 s101, 0
    s_cbranch_scc1 VOK_173
    v_and_b32 v3, 8, v0
    v_cmp_ne_u32 vcc, 0, v3
    v_mov_b32 v3, -1
    s_nop 0
    v_cndmask_b32 v3, v3, 32, vcc
    v_cmp_ne_u32 vcc, v3, v2
    s_cbranch_vccz VOK_173
    s_branch RESPEC
VOK_173:
    s_cmp_lg_u32 s34, 0
    s_cbranch_scc1 W0_174
    s_lshl_b32 s69, s80, 2
    s_add_u32 s69, s69, 0x0
    v_mov_b32 v1, 1
    s_mov_b64 exec, 1
    buffer_store_dword v1, off, s[40:43], s69 sc1
    s_mov_b64 exec, -1
W0_174:
    s_mov_b32 s60, s14
    s_mov_b32 s61, s15
    s_mov_b32 s62, 0x500000
    s_mov_b32 s63, 0x20000
    s_mul_i32 s69, s80, 40960
    v_bfe_u32 v2, v0, 0, 6
    v_lshlrev_b32 v1, 7, v2
    s_lshl_b32 s71, s34, 13
    s_add_u32 s71, s71, s69
    s_add_u32 s74, s71, 0
    buffer_load_dword v255, v1, s[60:63], s74 offen
    s_cmp_lg_u32 s34, 0
    s_cbranch_scc1 W0_175
    s_add_u32 s74, s69, 32768
    buffer_load_dword v255, v1, s[60:63], s74 offen
W0_175:
    s_cmp_ge_u32 s35, 27
    s_cbranch_scc1 FNP_176
    s_mov_b32 s48, s20
    s_mov_b32 s49, s21
    s_mov_b32 s50, 0x21c000
    s_mov_b32 s51, 0x20000
    s_mov_b32 s52, s22
    s_mov_b32 s53, s23
    s_mov_b32 s54, 0x21c000
    s_mov_b32 s55, 0x20000
    s_mov_b32 s56, s24
    s_mov_b32 s57, s25
    s_mov_b32 s58, 0x21c000
    s_mov_b32 s59, 0x20000
    s_cmp_lg_u32 s37, 0
    s_cbranch_scc1 GATE_177
    s_cmp_lg_u32 s34, 0
    s_cbranch_scc1 W0_178
    s_lshl_b32 s69, s35, 7
    s_add_u32 s69, s69, 0x2000
    s_mov_b32 s38, 262144
PL_179:
    buffer_load_dword v2, off, s[40:43], s69 sc1
    s_waitcnt vmcnt(0)
    v_cmp_gt_u32 vcc, 1, v2
    s_cbranch_vccnz PN_180
    s_branch PO_181
PN_180:
    s_sleep 8
    s_sub_u32 s38, s38, 1
    s_cbranch_scc0 PL_179
    s_mov_b32 s68, 50
    s_branch FAIL
PO_181:
W0_178:
GATE_177:
    s_barrier
    v_bfe_u32 v2, v0, 3, 3
    s_mov_b32 s75, 3456
    v_mul_u32_u24 v8, s75, v2
    v_bfe_u32 v2, v0, 0, 3
    v_lshl_add_u32 v8, v2, 4, v8
    s_lshl_b32 s71, s35, 7
    s_mul_i32 s69, s34, 55296
    s_add_u32 s71, s71, s69
    s_lshl_b32 s73, s34, 11
    s_add_u32 s72, s71, 0
    s_add_u32 m0, s73, 0
    s_nop 0
    buffer_load_dwordx4 v8, s[48:51], s72 offen  lds
    s_add_u32 m0, s73, 81920
    s_nop 0
    buffer_load_dwordx4 v8, s[52:55], s72 offen  lds
    s_add_u32 s72, s71, 27648
    s_add_u32 m0, s73, 1024
    s_nop 0
    buffer_load_dwordx4 v8, s[48:51], s72 offen  lds
    s_add_u32 m0, s73, 82944
    s_nop 0
    buffer_load_dwordx4 v8, s[52:55], s72 offen  lds
    s_add_u32 s72, s71, 221184
    s_add_u32 m0, s73, 8192
    s_nop 0
    buffer_load_dwordx4 v8, s[48:51], s72 offen  lds
    s_add_u32 m0, s73, 90112
    s_nop 0
    buffer_load_dwordx4 v8, s[52:55], s72 offen  lds
    s_add_u32 s72, s71, 248832
    s_add_u32 m0, s73, 9216
    s_nop 0
    buffer_load_dwordx4 v8, s[48:51], s72 offen  lds
    s_add_u32 m0, s73, 91136
    s_nop 0
    buffer_load_dwordx4 v8, s[52:55], s72 offen  lds
    s_add_u32 s72, s71, 442368
    s_add_u32 m0, s73, 16384
    s_nop 0
    buffer_load_dwordx4 v8, s[48:51], s72 offen  lds
    s_add_u32 m0, s73, 98304
    s_nop 0
    buffer_load_dwordx4 v8, s[52:55], s72 offen  lds
    s_add_u32 s72, s71, 470016
    s_add_u32 m0, s73, 17408
    s_nop 0
    buffer_load_dwordx4 v8, s[48:51], s72 offen  lds
    s_add_u32 m0, s73, 99328
    s_nop 0
    buffer_load_dwordx4 v8, s[52:55], s72 offen  lds
    s_add_u32 s72, s71, 663552
    s_add_u32 m0, s73, 24576
    s_nop 0
    buffer_load_dwordx4 v8, s[48:51], s72 offen  lds
    s_add_u32 m0, s73, 106496
    s_nop 0
    buffer_load_dwordx4 v8, s[52:55], s72 offen  lds
    s_add_u32 s72, s71, 691200
    s_add_u32 m0, s73, 25600
    s_nop 0
    buffer_load_dwordx4 v8, s[48:51], s72 offen  lds
    s_add_u32 m0, s73, 107520
    s_nop 0
    buffer_load_dwordx4 v8, s[52:55], s72 offen  lds
    s_add_u32 s72, s71, 884736
    s_add_u32 m0, s73, 32768
    s_nop 0
    buffer_load_dwordx4 v8, s[48:51], s72 offen  lds
    s_add_u32 m0, s73, 114688
    s_nop 0
    buffer_load_dwordx4 v8, s[52:55], s72 offen  lds
    s_add_u32 s72, s71, 912384
    s_add_u32 m0, s73, 33792
    s_nop 0
    buffer_load_dwordx4 v8, s[48:51], s72 offen  lds
    s_add_u32 m0, s73, 115712
    s_nop 0
    buffer_load_dwordx4 v8, s[52:55], s72 offen  lds
    s_add_u32 s72, s71, 1105920
    s_add_u32 m0, s73, 40960
    s_nop 0
    buffer_load_dwordx4 v8, s[48:51], s72 offen  lds
    s_add_u32 m0, s73, 122880
    s_nop 0
    buffer_load_dwordx4 v8, s[52:55], s72 offen  lds
    s_add_u32 s72, s71, 1133568
    s_add_u32 m0, s73, 41984
    s_nop 0
    buffer_load_dwordx4 v8, s[48:51], s72 offen  lds
    s_add_u32 m0, s73, 123904
    s_nop 0
    buffer_load_dwordx4 v8, s[52:55], s72 offen  lds
    s_add_u32 s72, s71, 1327104
    s_add_u32 m0, s73, 49152
    s_nop 0
    buffer_load_dwordx4 v8, s[48:51], s72 offen  lds
    s_add_u32 m0, s73, 131072
    s_nop 0
    buffer_load_dwordx4 v8, s[52:55], s72 offen  lds
    s_add_u32 s72, s71, 1354752
    s_add_u32 m0, s73, 50176
    s_nop 0
    buffer_load_dwordx4 v8, s[48:51], s72 offen  lds
    s_add_u32 m0, s73, 132096
    s_nop 0
    buffer_load_dwordx4 v8, s[52:55], s72 offen  lds
    s_add_u32 s72, s71, 1548288
    s_add_u32 m0, s73, 57344
    s_nop 0
    buffer_load_dwordx4 v8, s[48:51], s72 offen  lds
    s_add_u32 m0, s73, 139264
    s_nop 0
    buffer_load_dwordx4 v8, s[52:55], s72 offen  lds
    s_add_u32 s72, s71, 1575936
    s_add_u32 m0, s73, 58368
    s_nop 0
    buffer_load_dwordx4 v8, s[48:51], s72 offen  lds
    s_add_u32 m0, s73, 140288
    s_nop 0
    buffer_load_dwordx4 v8, s[52:55], s72 offen  lds
    s_add_u32 s72, s71, 1769472
    s_add_u32 m0, s73, 65536
    s_nop 0
    buffer_load_dwordx4 v8, s[48:51], s72 offen  lds
    s_add_u32 m0, s73, 147456
    s_nop 0
    buffer_load_dwordx4 v8, s[52:55], s72 offen  lds
    s_add_u32 s72, s71, 1797120
    s_add_u32 m0, s73, 66560
    s_nop 0
    buffer_load_dwordx4 v8, s[48:51], s72 offen  lds
    s_add_u32 m0, s73, 148480
    s_nop 0
    buffer_load_dwordx4 v8, s[52:55], s72 offen  lds
    s_add_u32 s72, s71, 1990656
    s_add_u32 m0, s73, 73728
    s_nop 0
    buffer_load_dwordx4 v8, s[48:51], s72 offen  lds
    s_add_u32 m0, s73, 155648
    s_nop 0
    buffer_load_dwordx4 v8, s[52:55], s72 offen  lds
    s_add_u32 s72, s71, 2018304
    s_add_u32 m0, s73, 74752
    s_nop 0
    buffer_load_dwordx4 v8, s[48:51], s72 offen  lds
    s_add_u32 m0, s73, 156672
    s_nop 0
    buffer_load_dwordx4 v8, s[52:55], s72 offen  lds
    v_bfe_u32 v2, v0, 4, 1
    s_mov_b32 s75, 81920
    v_mul_u32_u24 v16, s75, v2
    v_bfe_u32 v2, v0, 5, 1
    v_lshl_add_u32 v16, v2, 10, v16
    v_bfe_u32 v2, v0, 2, 2
    v_lshl_add_u32 v16, v2, 7, v16
    v_bfe_u32 v2, v0, 6, 2
    v_lshl_add_u32 v16, v2, 5, v16
    v_bfe_u32 v2, v0, 0, 1
    v_lshl_add_u32 v16, v2, 4, v16
    v_bfe_u32 v2, v0, 1, 1
    v_lshl_add_u32 v16, v2, 3, v16
    v_add_u32 v17, 0x10000, v16
    s_waitcnt vmcnt(36)
    s_barrier
    ds_read_b64_tr_b16 a[0:1], v16 offset:0
    ds_read_b64_tr_b16 a[2:3], v16 offset:512
    ds_read_b64_tr_b16 a[4:5], v16 offset:2048
    ds_read_b64_tr_b16 a[6:7], v16 offset:2560
    ds_read_b64_tr_b16 a[8:9], v16 offset:4096
    ds_read_b64_tr_b16 a[10:11], v16 offset:4608
    ds_read_b64_tr_b16 a[12:13], v16 offset:6144
    ds_read_b64_tr_b16 a[14:15], v16 offset:6656
    s_waitcnt vmcnt(32)
    s_barrier
    ds_read_b64_tr_b16 a[16:17], v16 offset:8192
    ds_read_b64_tr_b16 a[18:19], v16 offset:8704
    ds_read_b64_tr_b16 a[20:21], v16 offset:10240
    ds_read_b64_tr_b16 a[22:23], v16 offset:10752
    ds_read_b64_tr_b16 a[24:25], v16 offset:12288
    ds_read_b64_tr_b16 a[26:27], v16 offset:12800
    ds_read_b64_tr_b16 a[28:29], v16 offset:14336
    ds_read_b64_tr_b16 a[30:31], v16 offset:14848
    s_waitcnt vmcnt(28)
    s_barrier
    ds_read_b64_tr_b16 a[32:33], v16 offset:16384
    ds_read_b64_tr_b16 a[34:35], v16 offset:16896
    ds_read_b64_tr_b16 a[36:37], v16 offset:18432
    ds_read_b64_tr_b16 a[38:39], v16 offset:18944
    ds_read_b64_tr_b16 a[40:41], v16 offset:20480
    ds_read_b64_tr_b16 a[42:43], v16 offset:20992
    ds_read_b64_tr_b16 a[44:45], v16 offset:22528
    ds_read_b64_tr_b16 a[46:47], v16 offset:23040
    s_waitcnt vmcnt(24)
    s_barrier
    ds_read_b64_tr_b16 a[48:49], v16 offset:24576
    ds_read_b64_tr_b16 a[50:51], v16 offset:25088
    ds_read_b64_tr_b16 a[52:53], v16 offset:26624
    ds_read_b64_tr_b16 a[54:55], v16 offset:27136
    ds_read_b64_tr_b16 a[56:57], v16 offset:28672
    ds_read_b64_tr_b16 a[58:59], v16 offset:29184
    ds_read_b64_tr_b16 a[60:61], v16 offset:30720
    ds_read_b64_tr_b16 a[62:63], v16 offset:31232
    s_waitcnt vmcnt(20)
    s_barrier
    ds_read_b64_tr_b16 a[64:65], v16 offset:32768
    ds_read_b64_tr_b16 a[66:67], v16 offset:33280
    ds_read_b64_tr_b16 a[68:69], v16 offset:34816
    ds_read_b64_tr_b16 a[70:71], v16 offset:35328
    ds_read_b64_tr_b16 a[72:73], v16 offset:36864
    ds_read_b64_tr_b16 a[74:75], v16 offset:37376
    ds_read_b64_tr_b16 a[76:77], v16 offset:38912
    ds_read_b64_tr_b16 a[78:79], v16 offset:39424
    s_waitcnt vmcnt(16)
    s_barrier
    ds_read_b64_tr_b16 a[80:81], v16 offset:40960
    ds_read_b64_tr_b16 a[82:83], v16 offset:41472
    ds_read_b64_tr_b16 a[84:85], v16 offset:43008
    ds_read_b64_tr_b16 a[86:87], v16 offset:43520
    ds_read_b64_tr_b16 a[88:89], v16 offset:45056
    ds_read_b64_tr_b16 a[90:91], v16 offset:45568
    ds_read_b64_tr_b16 a[92:93], v16 offset:47104
    ds_read_b64_tr_b16 a[94:95], v16 offset:47616
    s_waitcnt vmcnt(12)
    s_barrier
    ds_read_b64_tr_b16 a[96:97], v16 offset:49152
    ds_read_b64_tr_b16 a[98:99], v16 offset:49664
    ds_read_b64_tr_b16 a[100:101], v16 offset:51200
    ds_read_b64_tr_b16 a[102:103], v16 offset:51712
    ds_read_b64_tr_b16 a[104:105], v16 offset:53248
    ds_read_b64_tr_b16 a[106:107], v16 offset:53760
    ds_read_b64_tr_b16 a[108:109], v16 offset:55296
    ds_read_b64_tr_b16 a[110:111], v16 offset:55808
    s_waitcnt vmcnt(8)
    s_barrier
    ds_read_b64_tr_b16 a[112:113], v16 offset:57344
    ds_read_b64_tr_b16 a[114:115], v16 offset:57856
    ds_read_b64_tr_b16 a[116:117], v16 offset:59392
    ds_read_b64_tr_b16 a[118:119], v16 offset:59904
    ds_read_b64_tr_b16 a[120:121], v16 offset:61440
    ds_read_b64_tr_b16 a[122:123], v16 offset:61952
    ds_read_b64_tr_b16 a[124:125], v16 offset:63488
    ds_read_b64_tr_b16 a[126:127], v16 offset:64000
    s_waitcnt vmcnt(4)
    s_barrier
    ds_read_b64_tr_b16 a[128:129], v17 offset:0
    ds_read_b64_tr_b16 a[130:131], v17 offset:512
    ds_read_b64_tr_b16 a[132:133], v17 offset:2048
    ds_read_b64_tr_b16 a[134:135], v17 offset:2560
    ds_read_b64_tr_b16 a[136:137], v17 offset:4096
    ds_read_b64_tr_b16 a[138:139], v17 offset:4608
    ds_read_b64_tr_b16 a[140:141], v17 offset:6144
    ds_read_b64_tr_b16 a[142:143], v17 offset:6656
    s_waitcnt vmcnt(0)
    s_barrier
    ds_read_b64_tr_b16 a[144:145], v17 offset:8192
    ds_read_b64_tr_b16 a[146:147], v17 offset:8704
    ds_read_b64_tr_b16 a[148:149], v17 offset:10240
    ds_read_b64_tr_b16 a[150:151], v17 offset:10752
    ds_read_b64_tr_b16 a[152:153], v17 offset:12288
    ds_read_b64_tr_b16 a[154:155], v17 offset:12800
    ds_read_b64_tr_b16 a[156:157], v17 offset:14336
    ds_read_b64_tr_b16 a[158:159], v17 offset:14848
    s_waitcnt lgkmcnt(0)
    s_barrier
    v_bfe_u32 v2, v0, 0, 4
    v_lshlrev_b32 v8, 4, v2
    v_bfe_u32 v2, v0, 4, 2
    v_lshlrev_b32 v2, 6, v2
    v_xor_b32 v8, v2, v8
    v_bfe_u32 v2, v0, 4, 2
    s_mov_b32 s75, 1280
    v_mad_u32_u24 v8, v2, s75, v8
    v_bfe_u32 v2, v0, 6, 2
    v_lshlrev_b32 v16, 6, v2
    v_bfe_u32 v2, v0, 0, 1
    v_lshl_add_u32 v16, v2, 5, v16
    v_bfe_u32 v2, v0, 4, 1
    v_lshl_add_u32 v16, v2, 4, v16
    v_bfe_u32 v2, v0, 1, 1
    v_lshl_add_u32 v16, v2, 3, v16
    v_bfe_u32 v2, v0, 2, 2
    v_lshlrev_b32 v2, 6, v2
    v_xor_b32 v16, v2, v16
    v_bfe_u32 v2, v0, 2, 2
    v_lshl_add_u32 v16, v2, 8, v16
    v_bfe_u32 v2, v0, 5, 1
    v_lshl_add_u32 v16, v2, 11, v16
    v_add_u32 v17, 0x10000, v16
    v_add_u32 v18, 0x20000, v16
    s_lshl_b32 s71, s35, 2
    s_add_u32 s71, s71, s34
    s_mul_i32 s71, s71, 20480
    s_add_u32 s72, s71, 0
    s_lshl_b32 s70, s34, 12
    s_add_u32 m0, s70, 0
    s_nop 0
    buffer_load_dwordx4 v8, s[56:59], s72 offen  lds
    s_add_u32 s69, s72, 5120
    s_lshl_b32 s70, s34, 12
    s_add_u32 m0, s70, 1024
    s_nop 0
    buffer_load_dwordx4 v8, s[56:59], s69 offen  lds
    s_add_u32 s69, s72, 10240
    s_lshl_b32 s70, s34, 12
    s_add_u32 m0, s70, 2048
    s_nop 0
    buffer_load_dwordx4 v8, s[56:59], s69 offen  lds
    s_add_u32 s69, s72, 15360
    s_lshl_b32 s70, s34, 12
    s_add_u32 m0, s70, 3072
    s_nop 0
    buffer_load_dwordx4 v8, s[56:59], s69 offen  lds
    s_add_u32 s72, s71, 256
    s_lshl_b32 s70, s34, 12
    s_add_u32 m0, s70, 16384
    s_nop 0
    buffer_load_dwordx4 v8, s[56:59], s72 offen  lds
    s_add_u32 s69, s72, 5120
    s_lshl_b32 s70, s34, 12
    s_add_u32 m0, s70, 17408
    s_nop 0
    buffer_load_dwordx4 v8, s[56:59], s69 offen  lds
    s_add_u32 s69, s72, 10240
    s_lshl_b32 s70, s34, 12
    s_add_u32 m0, s70, 18432
    s_nop 0
    buffer_load_dwordx4 v8, s[56:59], s69 offen  lds
    s_add_u32 s69, s72, 15360
    s_lshl_b32 s70, s34, 12
    s_add_u32 m0, s70, 19456
    s_nop 0
    buffer_load_dwordx4 v8, s[56:59], s69 offen  lds
    s_add_u32 s72, s71, 512
    s_lshl_b32 s70, s34, 12
    s_add_u32 m0, s70, 32768
    s_nop 0
    buffer_load_dwordx4 v8, s[56:59], s72 offen  lds
    s_add_u32 s69, s72, 5120
    s_lshl_b32 s70, s34, 12
    s_add_u32 m0, s70, 33792
    s_nop 0
    buffer_load_dwordx4 v8, s[56:59], s69 offen  lds
    s_add_u32 s69, s72, 10240
    s_lshl_b32 s70, s34, 12
    s_add_u32 m0, s70, 34816
    s_nop 0
    buffer_load_dwordx4 v8, s[56:59], s69 offen  lds
    s_add_u32 s69, s72, 15360
    s_lshl_b32 s70, s34, 12
    s_add_u32 m0, s70, 35840
    s_nop 0
    buffer_load_dwordx4 v8, s[56:59], s69 offen  lds
    s_add_u32 s72, s71, 768
    s_lshl_b32 s70, s34, 12
    s_add_u32 m0, s70, 49152
    s_nop 0
    buffer_load_dwordx4 v8, s[56:59], s72 offen  lds
    s_add_u32 s69, s72, 5120
    s_lshl_b32 s70, s34, 12
    s_add_u32 m0, s70, 50176
    s_nop 0
    buffer_load_dwordx4 v8, s[56:59], s69 offen  lds
    s_add_u32 s69, s72, 10240
    s_lshl_b32 s70, s34, 12
    s_add_u32 m0, s70, 51200
    s_nop 0
    buffer_load_dwordx4 v8, s[56:59], s69 offen  lds
    s_add_u32 s69, s72, 15360
    s_lshl_b32 s70, s34, 12
    s_add_u32 m0, s70, 52224
    s_nop 0
    buffer_load_dwordx4 v8, s[56:59], s69 offen  lds
    s_add_u32 s72, s71, 1024
    s_lshl_b32 s70, s34, 12
    s_add_u32 m0, s70, 65536
    s_nop 0
    buffer_load_dwordx4 v8, s[56:59], s72 offen  lds
    s_add_u32 s69, s72, 5120
    s_lshl_b32 s70, s34, 12
    s_add_u32 m0, s70, 66560
    s_nop 0
    buffer_load_dwordx4 v8, s[56:59], s69 offen  lds
    s_add_u32 s69, s72, 10240
    s_lshl_b32 s70, s34, 12
    s_add_u32 m0, s70, 67584
    s_nop 0
    buffer_load_dwordx4 v8, s[56:59], s69 offen  lds
    s_add_u32 s69, s72, 15360
    s_lshl_b32 s70, s34, 12
    s_add_u32 m0, s70, 68608
    s_nop 0
    buffer_load_dwordx4 v8, s[56:59], s69 offen  lds
    s_waitcnt vmcnt(16)
    s_barrier
    ds_read_b64_tr_b16 a[160:161], v16 offset:0
    ds_read_b64_tr_b16 a[162:163], v16 offset:1024
    ds_read_b64_tr_b16 a[164:165], v16 offset:4096
    ds_read_b64_tr_b16 a[166:167], v16 offset:5120
    ds_read_b64_tr_b16 a[168:169], v16 offset:8192
    ds_read_b64_tr_b16 a[170:171], v16 offset:9216
    ds_read_b64_tr_b16 a[172:173], v16 offset:12288
    ds_read_b64_tr_b16 a[174:175], v16 offset:13312
    s_waitcnt vmcnt(12)
    s_barrier
    ds_read_b64_tr_b16 a[176:177], v16 offset:16384
    ds_read_b64_tr_b16 a[178:179], v16 offset:17408
    ds_read_b64_tr_b16 a[180:181], v16 offset:20480
    ds_read_b64_tr_b16 a[182:183], v16 offset:21504
    ds_read_b64_tr_b16 a[184:185], v16 offset:24576
    ds_read_b64_tr_b16 a[186:187], v16 offset:25600
    ds_read_b64_tr_b16 a[188:189], v16 offset:28672
    ds_read_b64_tr_b16 a[190:191], v16 offset:29696
    s_waitcnt vmcnt(8)
    s_barrier
    ds_read_b64_tr_b16 a[192:193], v16 offset:32768
    ds_read_b64_tr_b16 a[194:195], v16 offset:33792
    ds_read_b64_tr_b16 a[196:197], v16 offset:36864
    ds_read_b64_tr_b16 a[198:199], v16 offset:37888
    ds_read_b64_tr_b16 a[200:201], v16 offset:40960
    ds_read_b64_tr_b16 a[202:203], v16 offset:41984
    ds_read_b64_tr_b16 a[204:205], v16 offset:45056
    ds_read_b64_tr_b16 a[206:207], v16 offset:46080
    s_waitcnt vmcnt(4)
    s_barrier
    ds_read_b64_tr_b16 a[208:209], v16 offset:49152
    ds_read_b64_tr_b16 a[210:211], v16 offset:50176
    ds_read_b64_tr_b16 a[212:213], v16 offset:53248
    ds_read_b64_tr_b16 a[214:215], v16 offset:54272
    ds_read_b64_tr_b16 a[216:217], v16 offset:57344
    ds_read_b64_tr_b16 a[218:219], v16 offset:58368
    ds_read_b64_tr_b16 a[220:221], v16 offset:61440
    ds_read_b64_tr_b16 a[222:223], v16 offset:62464
    s_waitcnt vmcnt(0)
    s_barrier
    ds_read_b64_tr_b16 a[224:225], v17 offset:0
    ds_read_b64_tr_b16 a[226:227], v17 offset:1024
    ds_read_b64_tr_b16 a[228:229], v17 offset:4096
    ds_read_b64_tr_b16 a[230:231], v17 offset:5120
    ds_read_b64_tr_b16 a[232:233], v17 offset:8192
    ds_read_b64_tr_b16 a[234:235], v17 offset:9216
    ds_read_b64_tr_b16 a[236:237], v17 offset:12288
    ds_read_b64_tr_b16 a[238:239], v17 offset:13312
    s_waitcnt lgkmcnt(0)
    s_barrier
FNP_176:
    s_mov_b32 s64, s4
    s_mov_b32 s65, s5
    s_mov_b32 s66, 0x280000
    s_mov_b32 s67, 0x20000
    v_bfe_u32 v2, v0, 0, 6
    v_lshlrev_b32 v4, 4, v2
    v_mov_b32 v5, v4
    v_bfe_u32 v2, v0, 6, 2
    v_lshlrev_b32 v6, 16, v2
    v_bfe_u32 v2, v0, 5, 1
    v_lshl_add_u32 v6, v2, 15, v6
    v_bfe_u32 v2, v0, 4, 1
    v_lshl_add_u32 v6, v2, 13, v6
    v_bfe_u32 v2, v0, 0, 4
    v_lshl_add_u32 v6, v2, 4, v6
    v_bfe_u32 v2, v0, 0, 6
    v_lshlrev_b32 v7, 6, v2
    s_mul_i32 s75, s35, 1280
    v_add_u32 v7, s75, v7
    v_cmp_gt_u32 vcc, 20, v0
    v_mov_b32 v2, 0x40000000
    s_nop 0
    v_cndmask_b32 v7, v2, v7, vcc
    v_bfe_u32 v2, v0, 0, 4
    s_mov_b32 s75, 1280
    v_mul_u32_u24 v8, s75, v2
    v_bfe_u32 v2, v0, 4, 1
    v_lshl_add_u32 v8, v2, 3, v8
    v_and_b32 v2, 32, v0
    v_cmp_ne_u32 vcc, 0, v2
    v_mov_b32 v3, 0x40000000
    s_nop 0
    v_cndmask_b32 v8, v8, v3, vcc
    v_cndmask_b32 v9, v4, v3, vcc
    v_and_b32 v2, 7, v0
    v_mov_b32 v1, 0x3f80
    v_mov_b32 v15, 0x3f800000
    v_mov_b32 v10, 0
    v_cmp_eq_u32 vcc, 0, v2
    s_nop 1
    v_cndmask_b32 v10, v10, v1, vcc
    v_cmp_eq_u32 vcc, 1, v2
    s_nop 1
    v_cndmask_b32 v10, v10, v15, vcc
    v_mov_b32 v11, 0
    v_cmp_eq_u32 vcc, 2, v2
    s_nop 1
    v_cndmask_b32 v11, v11, v1, vcc
    v_cmp_eq_u32 vcc, 3, v2
    s_nop 1
    v_cndmask_b32 v11, v11, v15, vcc
    v_mov_b32 v12, 0
    v_cmp_eq_u32 vcc, 4, v2
    s_nop 1
    v_cndmask_b32 v12, v12, v1, vcc
    v_cmp_eq_u32 vcc, 5, v2
    s_nop 1
    v_cndmask_b32 v12, v12, v15, vcc
    v_mov_b32 v13, 0
    v_cmp_eq_u32 vcc, 6, v2
    s_nop 1
    v_cndmask_b32 v13, v13, v1, vcc
    v_cmp_eq_u32 vcc, 7, v2
    s_nop 1
    v_cndmask_b32 v13, v13, v15, vcc
    v_bfe_u32 v2, v0, 4, 2
    v_cmp_eq_u32 vcc, 3, v2
    s_nop 1
    v_cndmask_b32 v14, v4, v3, vcc
    s_and_b32 s83, s36, 1
    s_mul_i32 s69, s83, 2621440
    s_add_u32 s69, s69, 0x4800000
    s_lshl_b32 s70, s35, 8
    s_add_u32 s84, s69, s70
    s_mov_b32 s85, s69
    s_mov_b32 s20, 0
    s_lshl_b32 s69, s83, 7
    s_add_u32 s21, s69, 0x3400
    s_lshl_b32 s70, s35, 2
    s_add_u32 s22, s21, s70
    s_lshl_b32 s69, s83, 12
    s_lshl_b32 s70, s35, 7
    s_add_u32 s69, s69, s70
    s_add_u32 s23, s69, 0x4000
    s_mul_i32 s81, s83, 40960
    s_mov_b32 s24, s81
    s_add_u32 s81, s81, 0x100000
    s_mul_i32 s25, s83, 81920
    s_add_u32 s25, s25, 0x1400000
    s_mov_b32 s82, 0
    s_mov_b32 s80, 0
    s_cmp_lg_u32 s34, 0
    s_cbranch_scc1 W0_182
    v_bfe_u32 v2, v0, 0, 6
    v_lshlrev_b32 v1, 3, v2
    s_mov_b32 s38, 262144
PL_183:
    buffer_load_dwordx2 v[2:3], v1, s[40:43], 0 offen sc1
    s_waitcnt vmcnt(0)
    v_min_u32 v2, v2, v3
    v_cmp_eq_u32 vcc, 0, v2
    s_cbranch_vccnz PN_184
    s_branch PO_185
PN_184:
    s_sleep 2
    s_sub_u32 s38, s38, 1
    s_cbranch_scc0 PL_183
    s_mov_b32 s68, 3
    s_branch FAIL
PO_185:
W0_182:
    s_barrier
    s_mul_i32 s69, s34, 10240
    s_add_u32 s70, s69, s82
    s_add_u32 s69, s69, s81
    s_mov_b32 m0, s70
    s_nop 0
    buffer_load_dwordx4 v4, s[40:43], s69 offen sc1 lds
    buffer_load_dwordx4 v4, s[40:43], s69 offen offset:1024 sc1 lds
    buffer_load_dwordx4 v4, s[40:43], s69 offen offset:2048 sc1 lds
    buffer_load_dwordx4 v4, s[40:43], s69 offen offset:3072 sc1 lds
    s_add_u32 s69, s69, 4096
    s_add_u32 s70, s70, 4096
    s_mov_b32 m0, s70
    s_nop 0
    buffer_load_dwordx4 v4, s[40:43], s69 offen sc1 lds
    buffer_load_dwordx4 v4, s[40:43], s69 offen offset:1024 sc1 lds
    buffer_load_dwordx4 v4, s[40:43], s69 offen offset:2048 sc1 lds
    buffer_load_dwordx4 v4, s[40:43], s69 offen offset:3072 sc1 lds
    s_add_u32 s69, s69, 4096
    s_add_u32 s70, s70, 4096
    s_mov_b32 m0, s70
    s_nop 0
    buffer_load_dwordx4 v4, s[40:43], s69 offen sc1 lds
    buffer_load_dwordx4 v4, s[40:43], s69 offen offset:1024 sc1 lds
    s_add_u32 s69, s81, 81920
    buffer_load_dword v144, v7, s[40:43], s69 offen
    s_add_u32 s69, s81, 163840
    buffer_load_dword v144, v7, s[40:43], s69 offen
    s_waitcnt vmcnt(2)
    s_barrier
    s_cmp_lg_u32 s37, 0
    s_cbranch_scc1 FFN_LOOP_safe
FFN_LOOP_fast:
    s_lshl_b32 s71, s35, 2
    s_add_u32 s71, s71, s34
    s_lshl_b32 s56, s71, 13
    s_add_u32 s56, s56, s85
    s_add_u32 s56, s56, s20
    s_and_b32 s57, s71, 1
    s_mul_i32 s57, s57, 20480
    s_lshr_b32 s58, s71, 1
    s_lshl_b32 s58, s58, 4
    s_add_u32 s57, s57, s58
    s_add_u32 s57, s57, s24
    s_lshl_b32 s58, s71, 9
    s_add_u32 s58, s58, s25
    s_add_u32 s71, s35, 128
    s_lshl_b32 s59, s71, 13
    s_add_u32 s59, s59, s85
    s_add_u32 s59, s59, s20
    s_and_b32 s60, s71, 1
    s_mul_i32 s60, s60, 20480
    s_lshr_b32 s61, s71, 1
    s_lshl_b32 s61, s61, 4
    s_add_u32 s60, s60, s61
    s_add_u32 s60, s60, s24
    s_lshl_b32 s61, s71, 9
    s_add_u32 s61, s61, s25
    s_cmp_eq_u32 s34, 0
    s_cselect_b32 s59, s59, 0x40000000
    s_cselect_b32 s60, s60, 0x40000000
    s_cselect_b32 s61, s61, 0x40000000
    buffer_load_dwordx2 v[140:141], v8, s[64:67], s57 offen
    buffer_load_dwordx2 v[176:177], v8, s[64:67], s60 offen
    s_add_u32 s69, s81, 163840
    buffer_load_dword v144, v7, s[40:43], s69 offen
    s_cmp_lt_u32 s80, 31
    s_cselect_b32 s69, 81920, 0
    s_add_u32 s81, s81, s69
    s_xor_b32 s82, s82, 0x10000
    s_cmp_ge_u32 s35, 27
    s_cbranch_scc1 FSK_186
    ds_read_b128 v[48:51], v5 offset:0
    ds_read_b128 v[52:55], v5 offset:1024
    ds_read_b128 v[56:59], v5 offset:2048
    ds_read_b128 v[60:63], v5 offset:3072
    s_waitcnt lgkmcnt(3)
    v_mfma_f32_32x32x16_bf16 v[16:31], a[0:3], v[48:51], 0
    s_mul_i32 s72, s34, 10240
    s_add_u32 s73, s72, s82
    s_add_u32 s72, s72, s81
    s_mov_b32 m0, s73
    s_nop 0
    buffer_load_dwordx4 v4, s[40:43], s72 offen sc1 lds
    ds_read_b128 v[48:51], v5 offset:4096
    s_waitcnt lgkmcnt(3)
    v_mfma_f32_32x32x16_bf16 v[16:31], a[4:7], v[52:55], v[16:31]
    ds_read_b128 v[52:55], v5 offset:5120
    s_waitcnt lgkmcnt(3)
    v_mfma_f32_32x32x16_bf16 v[16:31], a[8:11], v[56:59], v[16:31]
    buffer_load_dwordx4 v4, s[40:43], s72 offen offset:1024 sc1 lds
    ds_read_b128 v[56:59], v5 offset:6144
    s_waitcnt lgkmcnt(3)
    v_mfma_f32_32x32x16_bf16 v[16:31], a[12:15], v[60:63], v[16:31]
    ds_read_b128 v[60:63], v5 offset:7168
    s_waitcnt lgkmcnt(3)
    v_mfma_f32_32x32x16_bf16 v[16:31], a[16:19], v[48:51], v[16:31]
    buffer_load_dwordx4 v4, s[40:43], s72 offen offset:2048 sc1 lds
    ds_read_b128 v[48:51], v5 offset:8192
    s_waitcnt lgkmcnt(3)
    v_mfma_f32_32x32x16_bf16 v[16:31], a[20:23], v[52:55], v[16:31]
    ds_read_b128 v[52:55], v5 offset:9216
    s_waitcnt lgkmcnt(3)
    v_mfma_f32_32x32x16_bf16 v[16:31], a[24:27], v[56:59], v[16:31]
    buffer_load_dwordx4 v4, s[40:43], s72 offen offset:3072 sc1 lds
    ds_read_b128 v[56:59], v5 offset:10240
    s_waitcnt lgkmcnt(3)
    v_mfma_f32_32x32x16_bf16 v[16:31], a[28:31], v[60:63], v[16:31]
    ds_read_b128 v[60:63], v5 offset:11264
    s_waitcnt lgkmcnt(3)
    v_mfma_f32_32x32x16_bf16 v[16:31], a[32:35], v[48:51], v[16:31]
    s_add_u32 s73, s73, 4096
    s_mov_b32 m0, s73
    s_add_u32 s72, s72, 4096
    buffer_load_dwordx4 v4, s[40:43], s72 offen sc1 lds
    ds_read_b128 v[48:51], v5 offset:12288
    s_waitcnt lgkmcnt(3)
    v_mfma_f32_32x32x16_bf16 v[16:31], a[36:39], v[52:55], v[16:31]
    ds_read_b128 v[52:55], v5 offset:13312
    s_waitcnt lgkmcnt(3)
    v_mfma_f32_32x32x16_bf16 v[16:31], a[40:43], v[56:59], v[16:31]
    buffer_load_dwordx4 v4, s[40:43], s72 offen offset:1024 sc1 lds
    ds_read_b128 v[56:59], v5 offset:14336
    s_waitcnt lgkmcnt(3)
    v_mfma_f32_32x32x16_bf16 v[16:31], a[44:47], v[60:63], v[16:31]
    ds_read_b128 v[60:63], v5 offset:15360
    s_waitcnt lgkmcnt(3)
    v_mfma_f32_32x32x16_bf16 v[16:31], a[48:51], v[48:51], v[16:31]
    buffer_load_dwordx4 v4, s[40:43], s72 offen offset:2048 sc1 lds
    ds_read_b128 v[48:51], v5 offset:16384
    s_waitcnt lgkmcnt(3)
    v_mfma_f32_32x32x16_bf16 v[16:31], a[52:55], v[52:55], v[16:31]
    ds_read_b128 v[52:55], v5 offset:17408
    s_waitcnt lgkmcnt(3)
    v_mfma_f32_32x32x16_bf16 v[16:31], a[56:59], v[56:59], v[16:31]
    buffer_load_dwordx4 v4, s[40:43], s72 offen offset:3072 sc1 lds
    ds_read_b128 v[56:59], v5 offset:18432
    s_waitcnt lgkmcnt(3)
    v_mfma_f32_32x32x16_bf16 v[16:31], a[60:63], v[60:63], v[16:31]
    ds_read_b128 v[60:63], v5 offset:19456
    s_waitcnt lgkmcnt(3)
    v_mfma_f32_32x32x16_bf16 v[16:31], a[64:67], v[48:51], v[16:31]
    s_add_u32 s73, s73, 4096
    s_mov_b32 m0, s73
    s_add_u32 s72, s72, 4096
    buffer_load_dwordx4 v4, s[40:43], s72 offen sc1 lds
    ds_read_b128 v[48:51], v5 offset:20480
    s_waitcnt lgkmcnt(3)
    v_mfma_f32_32x32x16_bf16 v[16:31], a[68:71], v[52:55], v[16:31]
    ds_read_b128 v[52:55], v5 offset:21504
    s_waitcnt lgkmcnt(3)
    v_mfma_f32_32x32x16_bf16 v[16:31], a[72:75], v[56:59], v[16:31]
    buffer_load_dwordx4 v4, s[40:43], s72 offen offset:1024 sc1 lds
    ds_read_b128 v[56:59], v5 offset:22528
    s_waitcnt lgkmcnt(3)
    v_mfma_f32_32x32x16_bf16 v[16:31], a[76:79], v[60:63], v[16:31]
    ds_read_b128 v[60:63], v5 offset:23552
    s_waitcnt lgkmcnt(3)
    v_mfma_f32_32x32x16_bf16 v[16:31], a[80:83], v[48:51], v[16:31]
    ds_read_b128 v[48:51], v5 offset:24576
    s_waitcnt lgkmcnt(3)
    v_mfma_f32_32x32x16_bf16 v[16:31], a[84:87], v[52:55], v[16:31]
    ds_read_b128 v[52:55], v5 offset:25600
    s_waitcnt lgkmcnt(3)
    v_mfma_f32_32x32x16_bf16 v[16:31], a[88:91], v[56:59], v[16:31]
    ds_read_b128 v[56:59], v5 offset:26624
    s_waitcnt lgkmcnt(3)
    v_mfma_f32_32x32x16_bf16 v[16:31], a[92:95], v[60:63], v[16:31]
    ds_read_b128 v[60:63], v5 offset:27648
    s_waitcnt lgkmcnt(3)
    v_mfma_f32_32x32x16_bf16 v[16:31], a[96:99], v[48:51], v[16:31]
    ds_read_b128 v[48:51], v5 offset:28672
    s_waitcnt lgkmcnt(3)
    v_mfma_f32_32x32x16_bf16 v[16:31], a[100:103], v[52:55], v[16:31]
    ds_read_b128 v[52:55], v5 offset:29696
    s_waitcnt lgkmcnt(3)
    v_mfma_f32_32x32x16_bf16 v[16:31], a[104:107], v[56:59], v[16:31]
    ds_read_b128 v[56:59], v5 offset:30720
    s_waitcnt lgkmcnt(3)
    v_mfma_f32_32x32x16_bf16 v[16:31], a[108:111], v[60:63], v[16:31]
    ds_read_b128 v[60:63], v5 offset:31744
    s_waitcnt lgkmcnt(3)
    v_mfma_f32_32x32x16_bf16 v[16:31], a[112:115], v[48:51], v[16:31]
    ds_read_b128 v[48:51], v5 offset:32768
    s_waitcnt lgkmcnt(3)
    v_mfma_f32_32x32x16_bf16 v[16:31], a[116:119], v[52:55], v[16:31]
    ds_read_b128 v[52:55], v5 offset:33792
    s_waitcnt lgkmcnt(3)
    v_mfma_f32_32x32x16_bf16 v[16:31], a[120:123], v[56:59], v[16:31]
    ds_read_b128 v[56:59], v5 offset:34816
    s_waitcnt lgkmcnt(3)
    v_mfma_f32_32x32x16_bf16 v[16:31], a[124:127], v[60:63], v[16:31]
    ds_read_b128 v[60:63], v5 offset:35840
    s_waitcnt lgkmcnt(3)
    v_mfma_f32_32x32x16_bf16 v[16:31], a[128:131], v[48:51], v[16:31]
    ds_read_b128 v[48:51], v5 offset:36864
    s_waitcnt lgkmcnt(3)
    v_mfma_f32_32x32x16_bf16 v[16:31], a[132:135], v[52:55], v[16:31]
    ds_read_b128 v[52:55], v5 offset:37888
    s_waitcnt lgkmcnt(3)
    v_mfma_f32_32x32x16_bf16 v[16:31], a[136:139], v[56:59], v[16:31]
    ds_read_b128 v[56:59], v5 offset:38912
    s_waitcnt lgkmcnt(3)
    v_mfma_f32_32x32x16_bf16 v[16:31], a[140:143], v[60:63], v[16:31]
    ds_read_b128 v[60:63], v5 offset:39936
    s_waitcnt lgkmcnt(3)
    v_mfma_f32_32x32x16_bf16 v[16:31], a[144:147], v[48:51], v[16:31]
    s_waitcnt lgkmcnt(2)
    v_mfma_f32_32x32x16_bf16 v[16:31], a[148:151], v[52:55], v[16:31]
    s_waitcnt lgkmcnt(1)
    v_mfma_f32_32x32x16_bf16 v[16:31], a[152:155], v[56:59], v[16:31]
    s_waitcnt lgkmcnt(0)
    v_mfma_f32_32x32x16_bf16 v[16:31], a[156:159], v[60:63], v[16:31]
    s_nop 11
    v_cvt_pk_bf16_f32 v64, v16, v17
    v_cvt_pk_bf16_f32 v65, v18, v19
    v_cvt_pk_bf16_f32 v66, v20, v21
    v_cvt_pk_bf16_f32 v67, v22, v23
    v_cvt_pk_bf16_f32 v68, v24, v25
    v_cvt_pk_bf16_f32 v69, v26, v27
    v_cvt_pk_bf16_f32 v70, v28, v29
    v_cvt_pk_bf16_f32 v71, v30, v31
    v_lshlrev_b32 v16, 16, v64
    v_and_b32 v17, 0xffff0000, v64
    v_lshlrev_b32 v18, 16, v65
    v_and_b32 v19, 0xffff0000, v65
    v_lshlrev_b32 v20, 16, v66
    v_and_b32 v21, 0xffff0000, v66
    v_lshlrev_b32 v22, 16, v67
    v_and_b32 v23, 0xffff0000, v67
    v_lshlrev_b32 v24, 16, v68
    v_and_b32 v25, 0xffff0000, v68
    v_lshlrev_b32 v26, 16, v69
    v_and_b32 v27, 0xffff0000, v69
    v_lshlrev_b32 v28, 16, v70
    v_and_b32 v29, 0xffff0000, v70
    v_lshlrev_b32 v30, 16, v71
    v_and_b32 v31, 0xffff0000, v71
    v_mul_f32 v32, 0xbfb8aa3b, v16
    v_mul_f32 v33, 0xbfb8aa3b, v17
    v_mul_f32 v34, 0xbfb8aa3b, v18
    v_mul_f32 v35, 0xbfb8aa3b, v19
    v_mul_f32 v36, 0xbfb8aa3b, v20
    v_mul_f32 v37, 0xbfb8aa3b, v21
    v_mul_f32 v38, 0xbfb8aa3b, v22
    v_mul_f32 v39, 0xbfb8aa3b, v23
    v_exp_f32 v32, v32
    v_exp_f32 v33, v33
    v_exp_f32 v34, v34
    v_exp_f32 v35, v35
    v_exp_f32 v36, v36
    v_exp_f32 v37, v37
    v_exp_f32 v38, v38
    v_exp_f32 v39, v39
    v_add_f32 v32, 1.0, v32
    v_add_f32 v33, 1.0, v33
    v_add_f32 v34, 1.0, v34
    v_add_f32 v35, 1.0, v35
    v_add_f32 v36, 1.0, v36
    v_add_f32 v37, 1.0, v37
    v_add_f32 v38, 1.0, v38
    v_add_f32 v39, 1.0, v39
    v_rcp_f32 v32, v32
    v_rcp_f32 v33, v33
    v_rcp_f32 v34, v34
    v_rcp_f32 v35, v35
    v_rcp_f32 v36, v36
    v_rcp_f32 v37, v37
    v_rcp_f32 v38, v38
    v_rcp_f32 v39, v39
    v_mul_f32 v16, v16, v32
    v_mul_f32 v17, v17, v33
    v_mul_f32 v18, v18, v34
    v_mul_f32 v19, v19, v35
    v_mul_f32 v20, v20, v36
    v_mul_f32 v21, v21, v37
    v_mul_f32 v22, v22, v38
    v_mul_f32 v23, v23, v39
    v_cvt_pk_bf16_f32 v64, v16, v17
    v_cvt_pk_bf16_f32 v65, v18, v19
    v_cvt_pk_bf16_f32 v66, v20, v21
    v_cvt_pk_bf16_f32 v67, v22, v23
    v_lshlrev_b32 v16, 16, v64
    v_and_b32 v17, 0xffff0000, v64
    v_lshlrev_b32 v18, 16, v65
    v_and_b32 v19, 0xffff0000, v65
    v_lshlrev_b32 v20, 16, v66
    v_and_b32 v21, 0xffff0000, v66
    v_lshlrev_b32 v22, 16, v67
    v_and_b32 v23, 0xffff0000, v67
    v_mul_f32 v16, v16, v24
    v_mul_f32 v17, v17, v25
    v_mul_f32 v18, v18, v26
    v_mul_f32 v19, v19, v27
    v_mul_f32 v20, v20, v28
    v_mul_f32 v21, v21, v29
    v_mul_f32 v22, v22, v30
    v_mul_f32 v23, v23, v31
    v_cvt_pk_bf16_f32 v64, v16, v17
    v_cvt_pk_bf16_f32 v65, v18, v19
    v_cvt_pk_bf16_f32 v66, v20, v21
    v_cvt_pk_bf16_f32 v67, v22, v23
    s_lshl_b32 s69, s34, 10
    v_add_u32 v1, s69, v4
    ds_write_b128 v1, v[64:67] offset:40960
    s_waitcnt lgkmcnt(0)
    s_barrier
    ds_read_b128 v[72:75], v4 offset:40960
    ds_read_b128 v[76:79], v4 offset:41984
    ds_read_b128 v[80:83], v4 offset:43008
    ds_read_b128 v[84:87], v4 offset:44032
    s_waitcnt lgkmcnt(0)
    s_add_u32 s72, s84, s20
    v_mfma_f32_32x32x16_bf16 v[16:31], a[160:163], v[72:75], 0
    v_mfma_f32_32x32x16_bf16 v[16:31], a[164:167], v[76:79], v[16:31]
    v_mfma_f32_32x32x16_bf16 v[16:31], a[168:171], v[80:83], v[16:31]
    v_mfma_f32_32x32x16_bf16 v[16:31], a[172:175], v[84:87], v[16:31]
    v_mfma_f32_32x32x16_bf16 v[32:47], a[176:179], v[72:75], 0
    v_mfma_f32_32x32x16_bf16 v[32:47], a[180:183], v[76:79], v[32:47]
    v_mfma_f32_32x32x16_bf16 v[32:47], a[184:187], v[80:83], v[32:47]
    v_cvt_pk_bf16_f32 v64, v16, v17
    v_cvt_pk_bf16_f32 v65, v18, v19
    v_cvt_pk_bf16_f32 v66, v20, v21
    v_cvt_pk_bf16_f32 v67, v22, v23
    v_cvt_pk_bf16_f32 v68, v24, v25
    v_cvt_pk_bf16_f32 v69, v26, v27
    v_cvt_pk_bf16_f32 v70, v28, v29
    v_cvt_pk_bf16_f32 v71, v30, v31
    s_add_u32 s73, s72, 16384
    buffer_store_dwordx4 v[64:67], v6, s[40:43], s72 offen
    buffer_store_dwordx4 v[68:71], v6, s[40:43], s73 offen
    s_add_u32 s72, s72, 0x40000
    v_mfma_f32_32x32x16_bf16 v[32:47], a[188:191], v[84:87], v[32:47]
    v_mfma_f32_32x32x16_bf16 v[16:31], a[192:195], v[72:75], 0
    v_mfma_f32_32x32x16_bf16 v[16:31], a[196:199], v[76:79], v[16:31]
    v_mfma_f32_32x32x16_bf16 v[16:31], a[200:203], v[80:83], v[16:31]
    v_cvt_pk_bf16_f32 v64, v32, v33
    v_cvt_pk_bf16_f32 v65, v34, v35
    v_cvt_pk_bf16_f32 v66, v36, v37
    v_cvt_pk_bf16_f32 v67, v38, v39
    v_cvt_pk_bf16_f32 v68, v40, v41
    v_cvt_pk_bf16_f32 v69, v42, v43
    v_cvt_pk_bf16_f32 v70, v44, v45
    v_cvt_pk_bf16_f32 v71, v46, v47
    s_add_u32 s73, s72, 16384
    buffer_store_dwordx4 v[64:67], v6, s[40:43], s72 offen
    buffer_store_dwordx4 v[68:71], v6, s[40:43], s73 offen
    s_add_u32 s72, s72, 0x40000
    v_mfma_f32_32x32x16_bf16 v[16:31], a[204:207], v[84:87], v[16:31]
    v_mfma_f32_32x32x16_bf16 v[32:47], a[208:211], v[72:75], 0
    v_mfma_f32_32x32x16_bf16 v[32:47], a[212:215], v[76:79], v[32:47]
    v_mfma_f32_32x32x16_bf16 v[32:47], a[216:219], v[80:83], v[32:47]
    v_cvt_pk_bf16_f32 v64, v16, v17
    v_cvt_pk_bf16_f32 v65, v18, v19
    v_cvt_pk_bf16_f32 v66, v20, v21
    v_cvt_pk_bf16_f32 v67, v22, v23
    v_cvt_pk_bf16_f32 v68, v24, v25
    v_cvt_pk_bf16_f32 v69, v26, v27
    v_cvt_pk_bf16_f32 v70, v28, v29
    v_cvt_pk_bf16_f32 v71, v30, v31
    s_add_u32 s73, s72, 16384
    buffer_store_dwordx4 v[64:67], v6, s[40:43], s72 offen
    buffer_store_dwordx4 v[68:71], v6, s[40:43], s73 offen
    s_add_u32 s72, s72, 0x40000
    v_mfma_f32_32x32x16_bf16 v[32:47], a[220:223], v[84:87], v[32:47]
    v_mfma_f32_32x32x16_bf16 v[16:31], a[224:227], v[72:75], 0
    v_mfma_f32_32x32x16_bf16 v[16:31], a[228:231], v[76:79], v[16:31]
    v_mfma_f32_32x32x16_bf16 v[16:31], a[232:235], v[80:83], v[16:31]
    v_cvt_pk_bf16_f32 v64, v32, v33
    v_cvt_pk_bf16_f32 v65, v34, v35
    v_cvt_pk_bf16_f32 v66, v36, v37
    v_cvt_pk_bf16_f32 v67, v38, v39
    v_cvt_pk_bf16_f32 v68, v40, v41
    v_cvt_pk_bf16_f32 v69, v42, v43
    v_cvt_pk_bf16_f32 v70, v44, v45
    v_cvt_pk_bf16_f32 v71, v46, v47
    s_add_u32 s73, s72, 16384
    buffer_store_dwordx4 v[64:67], v6, s[40:43], s72 offen
    buffer_store_dwordx4 v[68:71], v6, s[40:43], s73 offen
    s_add_u32 s72, s72, 0x40000
    v_mfma_f32_32x32x16_bf16 v[16:31], a[236:239], v[84:87], v[16:31]
    s_nop 11
    v_cvt_pk_bf16_f32 v64, v16, v17
    v_cvt_pk_bf16_f32 v65, v18, v19
    v_cvt_pk_bf16_f32 v66, v20, v21
    v_cvt_pk_bf16_f32 v67, v22, v23
    v_cvt_pk_bf16_f32 v68, v24, v25
    v_cvt_pk_bf16_f32 v69, v26, v27
    v_cvt_pk_bf16_f32 v70, v28, v29
    v_cvt_pk_bf16_f32 v71, v30, v31
    s_add_u32 s73, s72, 16384
    buffer_store_dwordx4 v[64:67], v6, s[40:43], s72 offen
    buffer_store_dwordx4 v[68:71], v6, s[40:43], s73 offen
    s_add_u32 s72, s72, 0x40000
FSK_186:
    s_waitcnt vmcnt(0)
    s_barrier
    s_cmp_lg_u32 s34, 0
    s_cbranch_scc1 W0_187
    s_add_u32 s69, s80, 1
    v_mov_b32 v1, s69
    s_mov_b64 exec, 1
    buffer_store_dword v1, off, s[40:43], s22
    s_mov_b64 exec, -1
    v_mov_b32 v1, s80
    s_mov_b64 exec, 1
    buffer_store_dword v1, off, s[40:43], s23 sc1
    s_mov_b64 exec, -1
W0_187:
    s_add_u32 s69, s80, 1
    v_and_b32 v1, 31, v0
    v_lshlrev_b32 v1, 2, v1
    s_mov_b32 s38, 262144
PL_188:
    buffer_load_dword v2, v1, s[40:43], s21 offen sc1
    s_waitcnt vmcnt(0)
    v_cmp_gt_u32 vcc, s69, v2
    s_cbranch_vccnz PN_189
    s_branch PO_190
PN_189:
    s_sleep 1
    s_sub_u32 s38, s38, 1
    s_cbranch_scc0 PL_188
    s_mov_b32 s68, 30
    s_branch FAIL
PO_190:
    s_add_u32 s73, s56, 4096
    buffer_load_dwordx4 v[104:107], v4, s[40:43], s56 offen offset:0 sc1
    buffer_load_dwordx4 v[108:111], v4, s[40:43], s56 offen offset:1024 sc1
    buffer_load_dwordx4 v[112:115], v4, s[40:43], s56 offen offset:2048 sc1
    buffer_load_dwordx4 v[116:119], v4, s[40:43], s56 offen offset:3072 sc1
    buffer_load_dwordx4 v[120:123], v4, s[40:43], s73 offen offset:0 sc1
    buffer_load_dwordx4 v[124:127], v4, s[40:43], s73 offen offset:1024 sc1
    buffer_load_dwordx4 v[128:131], v14, s[40:43], s73 offen offset:2048 sc1
    s_cmp_lg_u32 s34, 0
    s_cbranch_scc1 RONE_192
    s_add_u32 s73, s59, 4096
    buffer_load_dwordx4 v[72:75], v4, s[40:43], s59 offen offset:0 sc1
    buffer_load_dwordx4 v[76:79], v4, s[40:43], s59 offen offset:1024 sc1
    buffer_load_dwordx4 v[80:83], v4, s[40:43], s59 offen offset:2048 sc1
    buffer_load_dwordx4 v[84:87], v4, s[40:43], s59 offen offset:3072 sc1
    buffer_load_dwordx4 v[88:91], v4, s[40:43], s73 offen offset:0 sc1
    buffer_load_dwordx4 v[92:95], v4, s[40:43], s73 offen offset:1024 sc1
    buffer_load_dwordx4 v[96:99], v14, s[40:43], s73 offen offset:2048 sc1
    s_waitcnt vmcnt(13)
    v_mfma_f32_16x16x32_bf16 v[136:139], v[10:13], v[104:107], 0
    v_and_b32 v143, 0xffff0000, v141
    v_lshlrev_b32 v142, 16, v141
    v_and_b32 v141, 0xffff0000, v140
    v_lshlrev_b32 v140, 16, v140
    s_waitcnt vmcnt(12)
    v_mfma_f32_16x16x32_bf16 v[136:139], v[10:13], v[108:111], v[136:139]
    s_waitcnt vmcnt(11)
    v_mfma_f32_16x16x32_bf16 v[136:139], v[10:13], v[112:115], v[136:139]
    s_waitcnt vmcnt(10)
    v_mfma_f32_16x16x32_bf16 v[136:139], v[10:13], v[116:119], v[136:139]
    s_waitcnt vmcnt(9)
    v_mfma_f32_16x16x32_bf16 v[136:139], v[10:13], v[120:123], v[136:139]
    s_waitcnt vmcnt(8)
    v_mfma_f32_16x16x32_bf16 v[136:139], v[10:13], v[124:127], v[136:139]
    s_waitcnt vmcnt(7)
    v_mfma_f32_16x16x32_bf16 v[136:139], v[10:13], v[128:131], v[136:139]
    s_nop 7
    v_pk_add_f32 v[136:137], v[136:137], v[140:141]
    v_pk_add_f32 v[138:139], v[138:139], v[142:143]
    buffer_store_dwordx4 v[136:139], v9, s[40:43], s58 offen sc1
    s_waitcnt vmcnt(7)
    v_mfma_f32_16x16x32_bf16 v[16:19], v[10:13], v[72:75], 0
    v_and_b32 v179, 0xffff0000, v177
    v_lshlrev_b32 v178, 16, v177
    v_and_b32 v177, 0xffff0000, v176
    v_lshlrev_b32 v176, 16, v176
    s_waitcnt vmcnt(6)
    v_mfma_f32_16x16x32_bf16 v[16:19], v[10:13], v[76:79], v[16:19]
    s_waitcnt vmcnt(5)
    v_mfma_f32_16x16x32_bf16 v[16:19], v[10:13], v[80:83], v[16:19]
    s_waitcnt vmcnt(4)
    v_mfma_f32_16x16x32_bf16 v[16:19], v[10:13], v[84:87], v[16:19]
    s_waitcnt vmcnt(3)
    v_mfma_f32_16x16x32_bf16 v[16:19], v[10:13], v[88:91], v[16:19]
    s_waitcnt vmcnt(2)
    v_mfma_f32_16x16x32_bf16 v[16:19], v[10:13], v[92:95], v[16:19]
    s_waitcnt vmcnt(1)
    v_mfma_f32_16x16x32_bf16 v[16:19], v[10:13], v[96:99], v[16:19]
    s_nop 7
    v_pk_add_f32 v[16:17], v[16:17], v[176:177]
    v_pk_add_f32 v[18:19], v[18:19], v[178:179]
    buffer_store_dwordx4 v[16:19], v9, s[40:43], s61 offen sc1
    s_branch RW0_191
RONE_192:
    s_waitcnt vmcnt(6)
    v_mfma_f32_16x16x32_bf16 v[136:139], v[10:13], v[104:107], 0
    v_and_b32 v143, 0xffff0000, v141
    v_lshlrev_b32 v142, 16, v141
    v_and_b32 v141, 0xffff0000, v140
    v_lshlrev_b32 v140, 16, v140
    s_waitcnt vmcnt(5)
    v_mfma_f32_16x16x32_bf16 v[136:139], v[10:13], v[108:111], v[136:139]
    s_waitcnt vmcnt(4)
    v_mfma_f32_16x16x32_bf16 v[136:139], v[10:13], v[112:115], v[136:139]
    s_waitcnt vmcnt(3)
    v_mfma_f32_16x16x32_bf16 v[136:139], v[10:13], v[116:119], v[136:139]
    s_waitcnt vmcnt(2)
    v_mfma_f32_16x16x32_bf16 v[136:139], v[10:13], v[120:123], v[136:139]
    s_waitcnt vmcnt(1)
    v_mfma_f32_16x16x32_bf16 v[136:139], v[10:13], v[124:127], v[136:139]
    s_waitcnt vmcnt(0)
    v_mfma_f32_16x16x32_bf16 v[136:139], v[10:13], v[128:131], v[136:139]
    s_nop 7
    v_pk_add_f32 v[136:137], v[136:137], v[140:141]
    v_pk_add_f32 v[138:139], v[138:139], v[142:143]
    buffer_store_dwordx4 v[136:139], v9, s[40:43], s58 offen sc1
RW0_191:
    s_xor_b32 s20, s20, 0x140000
    s_add_u32 s24, s24, 81920
    s_add_u32 s25, s25, 163840
    v_xor_b32 v5, 0x10000, v5
    s_add_u32 s80, s80, 1
    s_cmp_lt_u32 s80, 32
    s_cbranch_scc1 FFN_LOOP_fast
    s_waitcnt vmcnt(0)
    s_barrier
    s_cmp_lg_u32 s34, 0
    s_cbranch_scc1 W0_193
    v_mov_b32 v1, 32
    s_mov_b64 exec, 1
    buffer_store_dword v1, off, s[40:43], s23 sc1
    s_mov_b64 exec, -1
W0_193:
    s_branch END
FFN_LOOP_safe:
    s_lshl_b32 s71, s35, 2
    s_add_u32 s71, s71, s34
    s_lshl_b32 s56, s71, 13
    s_add_u32 s56, s56, s85
    s_add_u32 s56, s56, s20
    s_and_b32 s57, s71, 1
    s_mul_i32 s57, s57, 20480
    s_lshr_b32 s58, s71, 1
    s_lshl_b32 s58, s58, 4
    s_add_u32 s57, s57, s58
    s_add_u32 s57, s57, s24
    s_lshl_b32 s58, s71, 9
    s_add_u32 s58, s58, s25
    s_add_u32 s71, s35, 128
    s_lshl_b32 s59, s71, 13
    s_add_u32 s59, s59, s85
    s_add_u32 s59, s59, s20
    s_and_b32 s60, s71, 1
    s_mul_i32 s60, s60, 20480
    s_lshr_b32 s61, s71, 1
    s_lshl_b32 s61, s61, 4
    s_add_u32 s60, s60, s61
    s_add_u32 s60, s60, s24
    s_lshl_b32 s61, s71, 9
    s_add_u32 s61, s61, s25
    s_cmp_eq_u32 s34, 0
    s_cselect_b32 s59, s59, 0x40000000
    s_cselect_b32 s60, s60, 0x40000000
    s_cselect_b32 s61, s61, 0x40000000
    buffer_load_dwordx2 v[140:141], v8, s[64:67], s57 offen
    buffer_load_dwordx2 v[176:177], v8, s[64:67], s60 offen
    s_add_u32 s69, s81, 163840
    buffer_load_dword v144, v7, s[40:43], s69 offen
    s_cmp_lt_u32 s80, 31
    s_cselect_b32 s69, 81920, 0
    s_add_u32 s81, s81, s69
    s_xor_b32 s82, s82, 0x10000
    s_cmp_ge_u32 s35, 27
    s_cbranch_scc1 FSK_194
    ds_read_b128 v[48:51], v5 offset:0
    ds_read_b128 v[52:55], v5 offset:1024
    ds_read_b128 v[56:59], v5 offset:2048
    ds_read_b128 v[60:63], v5 offset:3072
    s_waitcnt lgkmcnt(3)
    v_mfma_f32_32x32x16_bf16 v[16:31], a[0:3], v[48:51], 0
    s_mul_i32 s72, s34, 10240
    s_add_u32 s73, s72, s82
    s_add_u32 s72, s72, s81
    s_mov_b32 m0, s73
    s_nop 0
    buffer_load_dwordx4 v4, s[40:43], s72 offen sc1 lds
    ds_read_b128 v[48:51], v5 offset:4096
    s_waitcnt lgkmcnt(3)
    v_mfma_f32_32x32x16_bf16 v[16:31], a[4:7], v[52:55], v[16:31]
    ds_read_b128 v[52:55], v5 offset:5120
    s_waitcnt lgkmcnt(3)
    v_mfma_f32_32x32x16_bf16 v[16:31], a[8:11], v[56:59], v[16:31]
    buffer_load_dwordx4 v4, s[40:43], s72 offen offset:1024 sc1 lds
    ds_read_b128 v[56:59], v5 offset:6144
    s_waitcnt lgkmcnt(3)
    v_mfma_f32_32x32x16_bf16 v[16:31], a[12:15], v[60:63], v[16:31]
    ds_read_b128 v[60:63], v5 offset:7168
    s_waitcnt lgkmcnt(3)
    v_mfma_f32_32x32x16_bf16 v[16:31], a[16:19], v[48:51], v[16:31]
    buffer_load_dwordx4 v4, s[40:43], s72 offen offset:2048 sc1 lds
    ds_read_b128 v[48:51], v5 offset:8192
    s_waitcnt lgkmcnt(3)
    v_mfma_f32_32x32x16_bf16 v[16:31], a[20:23], v[52:55], v[16:31]
    ds_read_b128 v[52:55], v5 offset:9216
    s_waitcnt lgkmcnt(3)
    v_mfma_f32_32x32x16_bf16 v[16:31], a[24:27], v[56:59], v[16:31]
    buffer_load_dwordx4 v4, s[40:43], s72 offen offset:3072 sc1 lds
    ds_read_b128 v[56:59], v5 offset:10240
    s_waitcnt lgkmcnt(3)
    v_mfma_f32_32x32x16_bf16 v[16:31], a[28:31], v[60:63], v[16:31]
    ds_read_b128 v[60:63], v5 offset:11264
    s_waitcnt lgkmcnt(3)
    v_mfma_f32_32x32x16_bf16 v[16:31], a[32:35], v[48:51], v[16:31]
    s_add_u32 s73, s73, 4096
    s_mov_b32 m0, s73
    s_add_u32 s72, s72, 4096
    buffer_load_dwordx4 v4, s[40:43], s72 offen sc1 lds
    ds_read_b128 v[48:51], v5 offset:12288
    s_waitcnt lgkmcnt(3)
    v_mfma_f32_32x32x16_bf16 v[16:31], a[36:39], v[52:55], v[16:31]
    ds_read_b128 v[52:55], v5 offset:13312
    s_waitcnt lgkmcnt(3)
    v_mfma_f32_32x32x16_bf16 v[16:31], a[40:43], v[56:59], v[16:31]
    buffer_load_dwordx4 v4, s[40:43], s72 offen offset:1024 sc1 lds
    ds_read_b128 v[56:59], v5 offset:14336
    s_waitcnt lgkmcnt(3)
    v_mfma_f32_32x32x16_bf16 v[16:31], a[44:47], v[60:63], v[16:31]
    ds_read_b128 v[60:63], v5 offset:15360
    s_waitcnt lgkmcnt(3)
    v_mfma_f32_32x32x16_bf16 v[16:31], a[48:51], v[48:51], v[16:31]
    buffer_load_dwordx4 v4, s[40:43], s72 offen offset:2048 sc1 lds
    ds_read_b128 v[48:51], v5 offset:16384
    s_waitcnt lgkmcnt(3)
    v_mfma_f32_32x32x16_bf16 v[16:31], a[52:55], v[52:55], v[16:31]
    ds_read_b128 v[52:55], v5 offset:17408
    s_waitcnt lgkmcnt(3)
    v_mfma_f32_32x32x16_bf16 v[16:31], a[56:59], v[56:59], v[16:31]
    buffer_load_dwordx4 v4, s[40:43], s72 offen offset:3072 sc1 lds
    ds_read_b128 v[56:59], v5 offset:18432
    s_waitcnt lgkmcnt(3)
    v_mfma_f32_32x32x16_bf16 v[16:31], a[60:63], v[60:63], v[16:31]
    ds_read_b128 v[60:63], v5 offset:19456
    s_waitcnt lgkmcnt(3)
    v_mfma_f32_32x32x16_bf16 v[16:31], a[64:67], v[48:51], v[16:31]
    s_add_u32 s73, s73, 4096
    s_mov_b32 m0, s73
    s_add_u32 s72, s72, 4096
    buffer_load_dwordx4 v4, s[40:43], s72 offen sc1 lds
    ds_read_b128 v[48:51], v5 offset:20480
    s_waitcnt lgkmcnt(3)
    v_mfma_f32_32x32x16_bf16 v[16:31], a[68:71], v[52:55], v[16:31]
    ds_read_b128 v[52:55], v5 offset:21504
    s_waitcnt lgkmcnt(3)
    v_mfma_f32_32x32x16_bf16 v[16:31], a[72:75], v[56:59], v[16:31]
    buffer_load_dwordx4 v4, s[40:43], s72 offen offset:1024 sc1 lds
    ds_read_b128 v[56:59], v5 offset:22528
    s_waitcnt lgkmcnt(3)
    v_mfma_f32_32x32x16_bf16 v[16:31], a[76:79], v[60:63], v[16:31]
    ds_read_b128 v[60:63], v5 offset:23552
    s_waitcnt lgkmcnt(3)
    v_mfma_f32_32x32x16_bf16 v[16:31], a[80:83], v[48:51], v[16:31]
    ds_read_b128 v[48:51], v5 offset:24576
    s_waitcnt lgkmcnt(3)
    v_mfma_f32_32x32x16_bf16 v[16:31], a[84:87], v[52:55], v[16:31]
    ds_read_b128 v[52:55], v5 offset:25600
    s_waitcnt lgkmcnt(3)
    v_mfma_f32_32x32x16_bf16 v[16:31], a[88:91], v[56:59], v[16:31]
    ds_read_b128 v[56:59], v5 offset:26624
    s_waitcnt lgkmcnt(3)
    v_mfma_f32_32x32x16_bf16 v[16:31], a[92:95], v[60:63], v[16:31]
    ds_read_b128 v[60:63], v5 offset:27648
    s_waitcnt lgkmcnt(3)
    v_mfma_f32_32x32x16_bf16 v[16:31], a[96:99], v[48:51], v[16:31]
    ds_read_b128 v[48:51], v5 offset:28672
    s_waitcnt lgkmcnt(3)
    v_mfma_f32_32x32x16_bf16 v[16:31], a[100:103], v[52:55], v[16:31]
    ds_read_b128 v[52:55], v5 offset:29696
    s_waitcnt lgkmcnt(3)
    v_mfma_f32_32x32x16_bf16 v[16:31], a[104:107], v[56:59], v[16:31]
    ds_read_b128 v[56:59], v5 offset:30720
    s_waitcnt lgkmcnt(3)
    v_mfma_f32_32x32x16_bf16 v[16:31], a[108:111], v[60:63], v[16:31]
    ds_read_b128 v[60:63], v5 offset:31744
    s_waitcnt lgkmcnt(3)
    v_mfma_f32_32x32x16_bf16 v[16:31], a[112:115], v[48:51], v[16:31]
    ds_read_b128 v[48:51], v5 offset:32768
    s_waitcnt lgkmcnt(3)
    v_mfma_f32_32x32x16_bf16 v[16:31], a[116:119], v[52:55], v[16:31]
    ds_read_b128 v[52:55], v5 offset:33792
    s_waitcnt lgkmcnt(3)
    v_mfma_f32_32x32x16_bf16 v[16:31], a[120:123], v[56:59], v[16:31]
    ds_read_b128 v[56:59], v5 offset:34816
    s_waitcnt lgkmcnt(3)
    v_mfma_f32_32x32x16_bf16 v[16:31], a[124:127], v[60:63], v[16:31]
    ds_read_b128 v[60:63], v5 offset:35840
    s_waitcnt lgkmcnt(3)
    v_mfma_f32_32x32x16_bf16 v[16:31], a[128:131], v[48:51], v[16:31]
    ds_read_b128 v[48:51], v5 offset:36864
    s_waitcnt lgkmcnt(3)
    v_mfma_f32_32x32x16_bf16 v[16:31], a[132:135], v[52:55], v[16:31]
    ds_read_b128 v[52:55], v5 offset:37888
    s_waitcnt lgkmcnt(3)
    v_mfma_f32_32x32x16_bf16 v[16:31], a[136:139], v[56:59], v[16:31]
    ds_read_b128 v[56:59], v5 offset:38912
    s_waitcnt lgkmcnt(3)
    v_mfma_f32_32x32x16_bf16 v[16:31], a[140:143], v[60:63], v[16:31]
    ds_read_b128 v[60:63], v5 offset:39936
    s_waitcnt lgkmcnt(3)
    v_mfma_f32_32x32x16_bf16 v[16:31], a[144:147], v[48:51], v[16:31]
    s_waitcnt lgkmcnt(2)
    v_mfma_f32_32x32x16_bf16 v[16:31], a[148:151], v[52:55], v[16:31]
    s_waitcnt lgkmcnt(1)
    v_mfma_f32_32x32x16_bf16 v[16:31], a[152:155], v[56:59], v[16:31]
    s_waitcnt lgkmcnt(0)
    v_mfma_f32_32x32x16_bf16 v[16:31], a[156:159], v[60:63], v[16:31]
    s_nop 11
    v_cvt_pk_bf16_f32 v64, v16, v17
    v_cvt_pk_bf16_f32 v65, v18, v19
    v_cvt_pk_bf16_f32 v66, v20, v21
    v_cvt_pk_bf16_f32 v67, v22, v23
    v_cvt_pk_bf16_f32 v68, v24, v25
    v_cvt_pk_bf16_f32 v69, v26, v27
    v_cvt_pk_bf16_f32 v70, v28, v29
    v_cvt_pk_bf16_f32 v71, v30, v31
    v_lshlrev_b32 v16, 16, v64
    v_and_b32 v17, 0xffff0000, v64
    v_lshlrev_b32 v18, 16, v65
    v_and_b32 v19, 0xffff0000, v65
    v_lshlrev_b32 v20, 16, v66
    v_and_b32 v21, 0xffff0000, v66
    v_lshlrev_b32 v22, 16, v67
    v_and_b32 v23, 0xffff0000, v67
    v_lshlrev_b32 v24, 16, v68
    v_and_b32 v25, 0xffff0000, v68
    v_lshlrev_b32 v26, 16, v69
    v_and_b32 v27, 0xffff0000, v69
    v_lshlrev_b32 v28, 16, v70
    v_and_b32 v29, 0xffff0000, v70
    v_lshlrev_b32 v30, 16, v71
    v_and_b32 v31, 0xffff0000, v71
    v_mul_f32 v32, 0xbfb8aa3b, v16
    v_mul_f32 v33, 0xbfb8aa3b, v17
    v_mul_f32 v34, 0xbfb8aa3b, v18
    v_mul_f32 v35, 0xbfb8aa3b, v19
    v_mul_f32 v36, 0xbfb8aa3b, v20
    v_mul_f32 v37, 0xbfb8aa3b, v21
    v_mul_f32 v38, 0xbfb8aa3b, v22
    v_mul_f32 v39, 0xbfb8aa3b, v23
    v_exp_f32 v32, v32
    v_exp_f32 v33, v33
    v_exp_f32 v34, v34
    v_exp_f32 v35, v35
    v_exp_f32 v36, v36
    v_exp_f32 v37, v37
    v_exp_f32 v38, v38
    v_exp_f32 v39, v39
    v_add_f32 v32, 1.0, v32
    v_add_f32 v33, 1.0, v33
    v_add_f32 v34, 1.0, v34
    v_add_f32 v35, 1.0, v35
    v_add_f32 v36, 1.0, v36
    v_add_f32 v37, 1.0, v37
    v_add_f32 v38, 1.0, v38
    v_add_f32 v39, 1.0, v39
    v_rcp_f32 v32, v32
    v_rcp_f32 v33, v33
    v_rcp_f32 v34, v34
    v_rcp_f32 v35, v35
    v_rcp_f32 v36, v36
    v_rcp_f32 v37, v37
    v_rcp_f32 v38, v38
    v_rcp_f32 v39, v39
    v_mul_f32 v16, v16, v32
    v_mul_f32 v17, v17, v33
    v_mul_f32 v18, v18, v34
    v_mul_f32 v19, v19, v35
    v_mul_f32 v20, v20, v36
    v_mul_f32 v21, v21, v37
    v_mul_f32 v22, v22, v38
    v_mul_f32 v23, v23, v39
    v_cvt_pk_bf16_f32 v64, v16, v17
    v_cvt_pk_bf16_f32 v65, v18, v19
    v_cvt_pk_bf16_f32 v66, v20, v21
    v_cvt_pk_bf16_f32 v67, v22, v23
    v_lshlrev_b32 v16, 16, v64
    v_and_b32 v17, 0xffff0000, v64
    v_lshlrev_b32 v18, 16, v65
    v_and_b32 v19, 0xffff0000, v65
    v_lshlrev_b32 v20, 16, v66
    v_and_b32 v21, 0xffff0000, v66
    v_lshlrev_b32 v22, 16, v67
    v_and_b32 v23, 0xffff0000, v67
    v_mul_f32 v16, v16, v24
    v_mul_f32 v17, v17, v25
    v_mul_f32 v18, v18, v26
    v_mul_f32 v19, v19, v27
    v_mul_f32 v20, v20, v28
    v_mul_f32 v21, v21, v29
    v_mul_f32 v22, v22, v30
    v_mul_f32 v23, v23, v31
    v_cvt_pk_bf16_f32 v64, v16, v17
    v_cvt_pk_bf16_f32 v65, v18, v19
    v_cvt_pk_bf16_f32 v66, v20, v21
    v_cvt_pk_bf16_f32 v67, v22, v23
    s_lshl_b32 s69, s34, 10
    v_add_u32 v1, s69, v4
    ds_write_b128 v1, v[64:67] offset:40960
    s_waitcnt lgkmcnt(0)
    s_barrier
    ds_read_b128 v[72:75], v4 offset:40960
    ds_read_b128 v[76:79], v4 offset:41984
    ds_read_b128 v[80:83], v4 offset:43008
    ds_read_b128 v[84:87], v4 offset:44032
    s_waitcnt lgkmcnt(0)
    s_add_u32 s72, s84, s20
    v_mfma_f32_32x32x16_bf16 v[16:31], a[160:163], v[72:75], 0
    v_mfma_f32_32x32x16_bf16 v[16:31], a[164:167], v[76:79], v[16:31]
    v_mfma_f32_32x32x16_bf16 v[16:31], a[168:171], v[80:83], v[16:31]
    v_mfma_f32_32x32x16_bf16 v[16:31], a[172:175], v[84:87], v[16:31]
    v_mfma_f32_32x32x16_bf16 v[32:47], a[176:179], v[72:75], 0
    v_mfma_f32_32x32x16_bf16 v[32:47], a[180:183], v[76:79], v[32:47]
    v_mfma_f32_32x32x16_bf16 v[32:47], a[184:187], v[80:83], v[32:47]
    v_cvt_pk_bf16_f32 v64, v16, v17
    v_cvt_pk_bf16_f32 v65, v18, v19
    v_cvt_pk_bf16_f32 v66, v20, v21
    v_cvt_pk_bf16_f32 v67, v22, v23
    v_cvt_pk_bf16_f32 v68, v24, v25
    v_cvt_pk_bf16_f32 v69, v26, v27
    v_cvt_pk_bf16_f32 v70, v28, v29
    v_cvt_pk_bf16_f32 v71, v30, v31
    s_add_u32 s73, s72, 16384
    buffer_store_dwordx4 v[64:67], v6, s[40:43], s72 offen sc1
    buffer_store_dwordx4 v[68:71], v6, s[40:43], s73 offen sc1
    s_add_u32 s72, s72, 0x40000
    v_mfma_f32_32x32x16_bf16 v[32:47], a[188:191], v[84:87], v[32:47]
    v_mfma_f32_32x32x16_bf16 v[16:31], a[192:195], v[72:75], 0
    v_mfma_f32_32x32x16_bf16 v[16:31], a[196:199], v[76:79], v[16:31]
    v_mfma_f32_32x32x16_bf16 v[16:31], a[200:203], v[80:83], v[16:31]
    v_cvt_pk_bf16_f32 v64, v32, v33
    v_cvt_pk_bf16_f32 v65, v34, v35
    v_cvt_pk_bf16_f32 v66, v36, v37
    v_cvt_pk_bf16_f32 v67, v38, v39
    v_cvt_pk_bf16_f32 v68, v40, v41
    v_cvt_pk_bf16_f32 v69, v42, v43
    v_cvt_pk_bf16_f32 v70, v44, v45
    v_cvt_pk_bf16_f32 v71, v46, v47
    s_add_u32 s73, s72, 16384
    buffer_store_dwordx4 v[64:67], v6, s[40:43], s72 offen sc1
    buffer_store_dwordx4 v[68:71], v6, s[40:43], s73 offen sc1
    s_add_u32 s72, s72, 0x40000
    v_mfma_f32_32x32x16_bf16 v[16:31], a[204:207], v[84:87], v[16:31]
    v_mfma_f32_32x32x16_bf16 v[32:47], a[208:211], v[72:75], 0
    v_mfma_f32_32x32x16_bf16 v[32:47], a[212:215], v[76:79], v[32:47]
    v_mfma_f32_32x32x16_bf16 v[32:47], a[216:219], v[80:83], v[32:47]
    v_cvt_pk_bf16_f32 v64, v16, v17
    v_cvt_pk_bf16_f32 v65, v18, v19
    v_cvt_pk_bf16_f32 v66, v20, v21
    v_cvt_pk_bf16_f32 v67, v22, v23
    v_cvt_pk_bf16_f32 v68, v24, v25
    v_cvt_pk_bf16_f32 v69, v26, v27
    v_cvt_pk_bf16_f32 v70, v28, v29
    v_cvt_pk_bf16_f32 v71, v30, v31
    s_add_u32 s73, s72, 16384
    buffer_store_dwordx4 v[64:67], v6, s[40:43], s72 offen sc1
    buffer_store_dwordx4 v[68:71], v6, s[40:43], s73 offen sc1
    s_add_u32 s72, s72, 0x40000
    v_mfma_f32_32x32x16_bf16 v[32:47], a[220:223], v[84:87], v[32:47]
    v_mfma_f32_32x32x16_bf16 v[16:31], a[224:227], v[72:75], 0
    v_mfma_f32_32x32x16_bf16 v[16:31], a[228:231], v[76:79], v[16:31]
    v_mfma_f32_32x32x16_bf16 v[16:31], a[232:235], v[80:83], v[16:31]
    v_cvt_pk_bf16_f32 v64, v32, v33
    v_cvt_pk_bf16_f32 v65, v34, v35
    v_cvt_pk_bf16_f32 v66, v36, v37
    v_cvt_pk_bf16_f32 v67, v38, v39
    v_cvt_pk_bf16_f32 v68, v40, v41
    v_cvt_pk_bf16_f32 v69, v42, v43
    v_cvt_pk_bf16_f32 v70, v44, v45
    v_cvt_pk_bf16_f32 v71, v46, v47
    s_add_u32 s73, s72, 16384
    buffer_store_dwordx4 v[64:67], v6, s[40:43], s72 offen sc1
    buffer_store_dwordx4 v[68:71], v6, s[40:43], s73 offen sc1
    s_add_u32 s72, s72, 0x40000
    v_mfma_f32_32x32x16_bf16 v[16:31], a[236:239], v[84:87], v[16:31]
    s_nop 11
    v_cvt_pk_bf16_f32 v64, v16, v17
    v_cvt_pk_bf16_f32 v65, v18, v19
    v_cvt_pk_bf16_f32 v66, v20, v21
    v_cvt_pk_bf16_f32 v67, v22, v23
    v_cvt_pk_bf16_f32 v68, v24, v25
    v_cvt_pk_bf16_f32 v69, v26, v27
    v_cvt_pk_bf16_f32 v70, v28, v29
    v_cvt_pk_bf16_f32 v71, v30, v31
    s_add_u32 s73, s72, 16384
    buffer_store_dwordx4 v[64:67], v6, s[40:43], s72 offen sc1
    buffer_store_dwordx4 v[68:71], v6, s[40:43], s73 offen sc1
    s_add_u32 s72, s72, 0x40000
FSK_194:
    s_waitcnt vmcnt(0)
    s_barrier
    s_cmp_lg_u32 s34, 0
    s_cbranch_scc1 W0_195
    s_add_u32 s69, s80, 1
    v_mov_b32 v1, s69
    s_mov_b64 exec, 1
    buffer_store_dword v1, off, s[40:43], s22 sc1
    s_mov_b64 exec, -1
    v_mov_b32 v1, s80
    s_mov_b64 exec, 1
    buffer_store_dword v1, off, s[40:43], s23 sc1
    s_mov_b64 exec, -1
W0_195:
    s_add_u32 s69, s80, 1
    v_and_b32 v1, 31, v0
    v_lshlrev_b32 v1, 2, v1
    s_mov_b32 s38, 262144
PL_196:
    buffer_load_dword v2, v1, s[40:43], s21 offen sc1
    s_waitcnt vmcnt(0)
    v_cmp_gt_u32 vcc, s69, v2
    s_cbranch_vccnz PN_197
    s_branch PO_198
PN_197:
    s_sleep 1
    s_sub_u32 s38, s38, 1
    s_cbranch_scc0 PL_196
    s_mov_b32 s68, 30
    s_branch FAIL
PO_198:
    s_add_u32 s73, s56, 4096
    buffer_load_dwordx4 v[104:107], v4, s[40:43], s56 offen offset:0 sc1
    buffer_load_dwordx4 v[108:111], v4, s[40:43], s56 offen offset:1024 sc1
    buffer_load_dwordx4 v[112:115], v4, s[40:43], s56 offen offset:2048 sc1
    buffer_load_dwordx4 v[116:119], v4, s[40:43], s56 offen offset:3072 sc1
    buffer_load_dwordx4 v[120:123], v4, s[40:43], s73 offen offset:0 sc1
    buffer_load_dwordx4 v[124:127], v4, s[40:43], s73 offen offset:1024 sc1
    buffer_load_dwordx4 v[128:131], v14, s[40:43], s73 offen offset:2048 sc1
    s_cmp_lg_u32 s34, 0
    s_cbranch_scc1 RONE_200
    s_add_u32 s73, s59, 4096
    buffer_load_dwordx4 v[72:75], v4, s[40:43], s59 offen offset:0 sc1
    buffer_load_dwordx4 v[76:79], v4, s[40:43], s59 offen offset:1024 sc1
    buffer_load_dwordx4 v[80:83], v4, s[40:43], s59 offen offset:2048 sc1
    buffer_load_dwordx4 v[84:87], v4, s[40:43], s59 offen offset:3072 sc1
    buffer_load_dwordx4 v[88:91], v4, s[40:43], s73 offen offset:0 sc1
    buffer_load_dwordx4 v[92:95], v4, s[40:43], s73 offen offset:1024 sc1
    buffer_load_dwordx4 v[96:99], v14, s[40:43], s73 offen offset:2048 sc1
    s_waitcnt vmcnt(13)
    v_mfma_f32_16x16x32_bf16 v[136:139], v[10:13], v[104:107], 0
    v_and_b32 v143, 0xffff0000, v141
    v_lshlrev_b32 v142, 16, v141
    v_and_b32 v141, 0xffff0000, v140
    v_lshlrev_b32 v140, 16, v140
    s_waitcnt vmcnt(12)
    v_mfma_f32_16x16x32_bf16 v[136:139], v[10:13], v[108:111], v[136:139]
    s_waitcnt vmcnt(11)
    v_mfma_f32_16x16x32_bf16 v[136:139], v[10:13], v[112:115], v[136:139]
    s_waitcnt vmcnt(10)
    v_mfma_f32_16x16x32_bf16 v[136:139], v[10:13], v[116:119], v[136:139]
    s_waitcnt vmcnt(9)
    v_mfma_f32_16x16x32_bf16 v[136:139], v[10:13], v[120:123], v[136:139]
    s_waitcnt vmcnt(8)
    v_mfma_f32_16x16x32_bf16 v[136:139], v[10:13], v[124:127], v[136:139]
    s_waitcnt vmcnt(7)
    v_mfma_f32_16x16x32_bf16 v[136:139], v[10:13], v[128:131], v[136:139]
    s_nop 7
    v_pk_add_f32 v[136:137], v[136:137], v[140:141]
    v_pk_add_f32 v[138:139], v[138:139], v[142:143]
    buffer_store_dwordx4 v[136:139], v9, s[40:43], s58 offen sc1
    s_waitcnt vmcnt(7)
    v_mfma_f32_16x16x32_bf16 v[16:19], v[10:13], v[72:75], 0
    v_and_b32 v179, 0xffff0000, v177
    v_lshlrev_b32 v178, 16, v177
    v_and_b32 v177, 0xffff0000, v176
    v_lshlrev_b32 v176, 16, v176
    s_waitcnt vmcnt(6)
    v_mfma_f32_16x16x32_bf16 v[16:19], v[10:13], v[76:79], v[16:19]
    s_waitcnt vmcnt(5)
    v_mfma_f32_16x16x32_bf16 v[16:19], v[10:13], v[80:83], v[16:19]
    s_waitcnt vmcnt(4)
    v_mfma_f32_16x16x32_bf16 v[16:19], v[10:13], v[84:87], v[16:19]
    s_waitcnt vmcnt(3)
    v_mfma_f32_16x16x32_bf16 v[16:19], v[10:13], v[88:91], v[16:19]
    s_waitcnt vmcnt(2)
    v_mfma_f32_16x16x32_bf16 v[16:19], v[10:13], v[92:95], v[16:19]
    s_waitcnt vmcnt(1)
    v_mfma_f32_16x16x32_bf16 v[16:19], v[10:13], v[96:99], v[16:19]
    s_nop 7
    v_pk_add_f32 v[16:17], v[16:17], v[176:177]
    v_pk_add_f32 v[18:19], v[18:19], v[178:179]
    buffer_store_dwordx4 v[16:19], v9, s[40:43], s61 offen sc1
    s_branch RW0_199
RONE_200:
    s_waitcnt vmcnt(6)
    v_mfma_f32_16x16x32_bf16 v[136:139], v[10:13], v[104:107], 0
    v_and_b32 v143, 0xffff0000, v141
    v_lshlrev_b32 v142, 16, v141
    v_and_b32 v141, 0xffff0000, v140
    v_lshlrev_b32 v140, 16, v140
    s_waitcnt vmcnt(5)
    v_mfma_f32_16x16x32_bf16 v[136:139], v[10:13], v[108:111], v[136:139]
    s_waitcnt vmcnt(4)
    v_mfma_f32_16x16x32_bf16 v[136:139], v[10:13], v[112:115], v[136:139]
    s_waitcnt vmcnt(3)
    v_mfma_f32_16x16x32_bf16 v[136:139], v[10:13], v[116:119], v[136:139]
    s_waitcnt vmcnt(2)
    v_mfma_f32_16x16x32_bf16 v[136:139], v[10:13], v[120:123], v[136:139]
    s_waitcnt vmcnt(1)
    v_mfma_f32_16x16x32_bf16 v[136:139], v[10:13], v[124:127], v[136:139]
    s_waitcnt vmcnt(0)
    v_mfma_f32_16x16x32_bf16 v[136:139], v[10:13], v[128:131], v[136:139]
    s_nop 7
    v_pk_add_f32 v[136:137], v[136:137], v[140:141]
    v_pk_add_f32 v[138:139], v[138:139], v[142:143]
    buffer_store_dwordx4 v[136:139], v9, s[40:43], s58 offen sc1
RW0_199:
    s_xor_b32 s20, s20, 0x140000
    s_add_u32 s24, s24, 81920
    s_add_u32 s25, s25, 163840
    v_xor_b32 v5, 0x10000, v5
    s_add_u32 s80, s80, 1
    s_cmp_lt_u32 s80, 32
    s_cbranch_scc1 FFN_LOOP_safe
    s_waitcnt vmcnt(0)
    s_barrier
    s_cmp_lg_u32 s34, 0
    s_cbranch_scc1 W0_201
    v_mov_b32 v1, 32
    s_mov_b64 exec, 1
    buffer_store_dword v1, off, s[40:43], s23 sc1
    s_mov_b64 exec, -1
W0_201:
    s_branch END
ROLE_KV:
    s_lshl_b32 s82, s35, 7
    s_and_b32 s69, s36, 1
    s_lshl_b32 s69, s69, 2
    s_add_u32 s82, s82, s69
    s_add_u32 s82, s82, 0x1000
    v_bfe_u32 v2, v0, 0, 4
    v_lshlrev_b32 v8, 4, v2
    v_bfe_u32 v2, v0, 4, 2
    v_lshlrev_b32 v2, 6, v2
    v_xor_b32 v8, v2, v8
    v_bfe_u32 v2, v0, 4, 2
    s_mov_b32 s75, 8192
    v_mad_u32_u24 v8, v2, s75, v8
    s_lshl_b32 s72, s35, 8
    v_bfe_u32 v2, v0, 0, 6
    v_lshlrev_b32 v4, 4, v2
    v_bfe_u32 v2, v0, 0, 6
    v_lshlrev_b32 v7, 6, v2
    s_mul_i32 s75, s35, 1280
    v_add_u32 v7, s75, v7
    v_cmp_gt_u32 vcc, 20, v0
    v_mov_b32 v2, 0x40000000
    s_nop 0
    v_cndmask_b32 v7, v2, v7, vcc
    s_cmp_eq_u32 s36, 5
    s_cbranch_scc1 ROLE_V
    s_mov_b32 s48, s10
    s_mov_b32 s49, s11
    s_mov_b32 s50, 0x500000
    s_mov_b32 s51, 0x20000
    v_bfe_u32 v2, v0, 6, 2
    v_lshlrev_b32 v10, 6, v2
    v_bfe_u32 v2, v0, 0, 1
    v_lshl_add_u32 v10, v2, 5, v10
    v_bfe_u32 v2, v0, 4, 1
    v_lshl_add_u32 v10, v2, 4, v10
    v_bfe_u32 v2, v0, 1, 1
    v_lshl_add_u32 v10, v2, 3, v10
    v_bfe_u32 v2, v0, 2, 2
    v_lshlrev_b32 v2, 6, v2
    v_xor_b32 v10, v2, v10
    v_bfe_u32 v2, v0, 2, 2
    v_lshl_add_u32 v10, v2, 8, v10
    v_bfe_u32 v2, v0, 5, 1
    v_lshl_add_u32 v10, v2, 11, v10
    v_add_u32 v11, 0x10000, v10
    v_add_u32 v12, 0x20000, v10
    s_mul_i32 s71, s34, 131072
    s_add_u32 s71, s71, s72
    s_lshl_b32 s70, s34, 12
    s_add_u32 m0, s70, 0
    s_nop 0
    buffer_load_dwordx4 v8, s[48:51], s71 offen  lds
    s_add_u32 s69, s71, 32768
    s_lshl_b32 s70, s34, 12
    s_add_u32 m0, s70, 1024
    s_nop 0
    buffer_load_dwordx4 v8, s[48:51], s69 offen  lds
    s_add_u32 s69, s71, 65536
    s_lshl_b32 s70, s34, 12
    s_add_u32 m0, s70, 2048
    s_nop 0
    buffer_load_dwordx4 v8, s[48:51], s69 offen  lds
    s_add_u32 s69, s71, 98304
    s_lshl_b32 s70, s34, 12
    s_add_u32 m0, s70, 3072
    s_nop 0
    buffer_load_dwordx4 v8, s[48:51], s69 offen  lds
    s_cmp_lg_u32 s34, 1
    s_cbranch_scc1 CI_202
    s_cmp_eq_u32 s101, 0
    s_cbranch_scc1 CI_202
    s_waitcnt vmcnt(4)
    s_lshl_b32 s68, s33, 5
    s_add_u32 s68, s68, 16
    v_mov_b32 v13, 1
    s_mov_b64 exec, 1
    buffer_atomic_add v13, off, s[44:47], s68
    s_mov_b64 exec, -1
CI_202:
    s_add_u32 s71, s71, 524288
    s_lshl_b32 s70, s34, 12
    s_add_u32 m0, s70, 16384
    s_nop 0
    buffer_load_dwordx4 v8, s[48:51], s71 offen  lds
    s_add_u32 s69, s71, 32768
    s_lshl_b32 s70, s34, 12
    s_add_u32 m0, s70, 17408
    s_nop 0
    buffer_load_dwordx4 v8, s[48:51], s69 offen  lds
    s_add_u32 s69, s71, 65536
    s_lshl_b32 s70, s34, 12
    s_add_u32 m0, s70, 18432
    s_nop 0
    buffer_load_dwordx4 v8, s[48:51], s69 offen  lds
    s_add_u32 s69, s71, 98304
    s_lshl_b32 s70, s34, 12
    s_add_u32 m0, s70, 19456
    s_nop 0
    buffer_load_dwordx4 v8, s[48:51], s69 offen  lds
    s_add_u32 s71, s71, 524288
    s_lshl_b32 s70, s34, 12
    s_add_u32 m0, s70, 32768
    s_nop 0
    buffer_load_dwordx4 v8, s[48:51], s71 offen  lds
    s_add_u32 s69, s71, 32768
    s_lshl_b32 s70, s34, 12
    s_add_u32 m0, s70, 33792
    s_nop 0
    buffer_load_dwordx4 v8, s[48:51], s69 offen  lds
    s_add_u32 s69, s71, 65536
    s_lshl_b32 s70, s34, 12
    s_add_u32 m0, s70, 34816
    s_nop 0
    buffer_load_dwordx4 v8, s[48:51], s69 offen  lds
    s_add_u32 s69, s71, 98304
    s_lshl_b32 s70, s34, 12
    s_add_u32 m0, s70, 35840
    s_nop 0
    buffer_load_dwordx4 v8, s[48:51], s69 offen  lds
    s_add_u32 s71, s71, 524288
    s_lshl_b32 s70, s34, 12
    s_add_u32 m0, s70, 49152
    s_nop 0
    buffer_load_dwordx4 v8, s[48:51], s71 offen  lds
    s_add_u32 s69, s71, 32768
    s_lshl_b32 s70, s34, 12
    s_add_u32 m0, s70, 50176
    s_nop 0
    buffer_load_dwordx4 v8, s[48:51], s69 offen  lds
    s_add_u32 s69, s71, 65536
    s_lshl_b32 s70, s34, 12
    s_add_u32 m0, s70, 51200
    s_nop 0
    buffer_load_dwordx4 v8, s[48:51], s69 offen  lds
    s_add_u32 s69, s71, 98304
    s_lshl_b32 s70, s34, 12
    s_add_u32 m0, s70, 52224
    s_nop 0
    buffer_load_dwordx4 v8, s[48:51], s69 offen  lds
    s_add_u32 s71, s71, 524288
    s_lshl_b32 s70, s34, 12
    s_add_u32 m0, s70, 65536
    s_nop 0
    buffer_load_dwordx4 v8, s[48:51], s71 offen  lds
    s_add_u32 s69, s71, 32768
    s_lshl_b32 s70, s34, 12
    s_add_u32 m0, s70, 66560
    s_nop 0
    buffer_load_dwordx4 v8, s[48:51], s69 offen  lds
    s_add_u32 s69, s71, 65536
    s_lshl_b32 s70, s34, 12
    s_add_u32 m0, s70, 67584
    s_nop 0
    buffer_load_dwordx4 v8, s[48:51], s69 offen  lds
    s_add_u32 s69, s71, 98304
    s_lshl_b32 s70, s34, 12
    s_add_u32 m0, s70, 68608
    s_nop 0
    buffer_load_dwordx4 v8, s[48:51], s69 offen  lds
    s_add_u32 s71, s71, 524288
    s_lshl_b32 s70, s34, 12
    s_add_u32 m0, s70, 81920
    s_nop 0
    buffer_load_dwordx4 v8, s[48:51], s71 offen  lds
    s_add_u32 s69, s71, 32768
    s_lshl_b32 s70, s34, 12
    s_add_u32 m0, s70, 82944
    s_nop 0
    buffer_load_dwordx4 v8, s[48:51], s69 offen  lds
    s_add_u32 s69, s71, 65536
    s_lshl_b32 s70, s34, 12
    s_add_u32 m0, s70, 83968
    s_nop 0
    buffer_load_dwordx4 v8, s[48:51], s69 offen  lds
    s_add_u32 s69, s71, 98304
    s_lshl_b32 s70, s34, 12
    s_add_u32 m0, s70, 84992
    s_nop 0
    buffer_load_dwordx4 v8, s[48:51], s69 offen  lds
    s_add_u32 s71, s71, 524288
    s_lshl_b32 s70, s34, 12
    s_add_u32 m0, s70, 98304
    s_nop 0
    buffer_load_dwordx4 v8, s[48:51], s71 offen  lds
    s_add_u32 s69, s71, 32768
    s_lshl_b32 s70, s34, 12
    s_add_u32 m0, s70, 99328
    s_nop 0
    buffer_load_dwordx4 v8, s[48:51], s69 offen  lds
    s_add_u32 s69, s71, 65536
    s_lshl_b32 s70, s34, 12
    s_add_u32 m0, s70, 100352
    s_nop 0
    buffer_load_dwordx4 v8, s[48:51], s69 offen  lds
    s_add_u32 s69, s71, 98304
    s_lshl_b32 s70, s34, 12
    s_add_u32 m0, s70, 101376
    s_nop 0
    buffer_load_dwordx4 v8, s[48:51], s69 offen  lds
    v_mov_b32 v13, 0x4
    v_bfe_u32 v2, v0, 0, 3
    v_lshl_add_u32 v13, v2, 5, v13
    v_bfe_u32 v2, v0, 3, 1
    s_mov_b32 s75, 12
    v_mad_u32_u24 v13, v2, s75, v13
    buffer_load_dword v16, v13, s[44:47], 0 offen sc1
    s_add_u32 s71, s71, 524288
    s_lshl_b32 s70, s34, 12
    s_add_u32 m0, s70, 114688
    s_nop 0
    buffer_load_dwordx4 v8, s[48:51], s71 offen  lds
    s_add_u32 s69, s71, 32768
    s_lshl_b32 s70, s34, 12
    s_add_u32 m0, s70, 115712
    s_nop 0
    buffer_load_dwordx4 v8, s[48:51], s69 offen  lds
    s_add_u32 s69, s71, 65536
    s_lshl_b32 s70, s34, 12
    s_add_u32 m0, s70, 116736
    s_nop 0
    buffer_load_dwordx4 v8, s[48:51], s69 offen  lds
    s_add_u32 s69, s71, 98304
    s_lshl_b32 s70, s34, 12
    s_add_u32 m0, s70, 117760
    s_nop 0
    buffer_load_dwordx4 v8, s[48:51], s69 offen  lds
    s_add_u32 s71, s71, 524288
    s_lshl_b32 s70, s34, 12
    s_add_u32 m0, s70, 131072
    s_nop 0
    buffer_load_dwordx4 v8, s[48:51], s71 offen  lds
    s_add_u32 s69, s71, 32768
    s_lshl_b32 s70, s34, 12
    s_add_u32 m0, s70, 132096
    s_nop 0
    buffer_load_dwordx4 v8, s[48:51], s69 offen  lds
    s_add_u32 s69, s71, 65536
    s_lshl_b32 s70, s34, 12
    s_add_u32 m0, s70, 133120
    s_nop 0
    buffer_load_dwordx4 v8, s[48:51], s69 offen  lds
    s_add_u32 s69, s71, 98304
    s_lshl_b32 s70, s34, 12
    s_add_u32 m0, s70, 134144
    s_nop 0
    buffer_load_dwordx4 v8, s[48:51], s69 offen  lds
    s_add_u32 s71, s71, 524288
    s_lshl_b32 s70, s34, 12
    s_add_u32 m0, s70, 147456
    s_nop 0
    buffer_load_dwordx4 v8, s[48:51], s71 offen  lds
    s_add_u32 s69, s71, 32768
    s_lshl_b32 s70, s34, 12
    s_add_u32 m0, s70, 148480
    s_nop 0
    buffer_load_dwordx4 v8, s[48:51], s69 offen  lds
    s_add_u32 s69, s71, 65536
    s_lshl_b32 s70, s34, 12
    s_add_u32 m0, s70, 149504
    s_nop 0
    buffer_load_dwordx4 v8, s[48:51], s69 offen  lds
    s_add_u32 s69, s71, 98304
    s_lshl_b32 s70, s34, 12
    s_add_u32 m0, s70, 150528
    s_nop 0
    buffer_load_dwordx4 v8, s[48:51], s69 offen  lds
    s_waitcnt vmcnt(36)
    s_barrier
    ds_read_b64_tr_b16 a[0:1], v10 offset:0
    ds_read_b64_tr_b16 a[2:3], v10 offset:1024
    ds_read_b64_tr_b16 a[4:5], v10 offset:4096
    ds_read_b64_tr_b16 a[6:7], v10 offset:5120
    ds_read_b64_tr_b16 a[8:9], v10 offset:8192
    ds_read_b64_tr_b16 a[10:11], v10 offset:9216
    ds_read_b64_tr_b16 a[12:13], v10 offset:12288
    ds_read_b64_tr_b16 a[14:15], v10 offset:13312
    s_waitcnt vmcnt(32)
    s_barrier
    ds_read_b64_tr_b16 a[16:17], v10 offset:16384
    ds_read_b64_tr_b16 a[18:19], v10 offset:17408
    ds_read_b64_tr_b16 a[20:21], v10 offset:20480
    ds_read_b64_tr_b16 a[22:23], v10 offset:21504
    ds_read_b64_tr_b16 a[24:25], v10 offset:24576
    ds_read_b64_tr_b16 a[26:27], v10 offset:25600
    ds_read_b64_tr_b16 a[28:29], v10 offset:28672
    ds_read_b64_tr_b16 a[30:31], v10 offset:29696
    s_waitcnt vmcnt(28)
    s_barrier
    ds_read_b64_tr_b16 a[32:33], v10 offset:32768
    ds_read_b64_tr_b16 a[34:35], v10 offset:33792
    ds_read_b64_tr_b16 a[36:37], v10 offset:36864
    ds_read_b64_tr_b16 a[38:39], v10 offset:37888
    ds_read_b64_tr_b16 a[40:41], v10 offset:40960
    ds_read_b64_tr_b16 a[42:43], v10 offset:41984
    ds_read_b64_tr_b16 a[44:45], v10 offset:45056
    ds_read_b64_tr_b16 a[46:47], v10 offset:46080
    s_waitcnt vmcnt(24)
    s_barrier
    ds_read_b64_tr_b16 a[48:49], v10 offset:49152
    ds_read_b64_tr_b16 a[50:51], v10 offset:50176
    ds_read_b64_tr_b16 a[52:53], v10 offset:53248
    ds_read_b64_tr_b16 a[54:55], v10 offset:54272
    ds_read_b64_tr_b16 a[56:57], v10 offset:57344
    ds_read_b64_tr_b16 a[58:59], v10 offset:58368
    ds_read_b64_tr_b16 a[60:61], v10 offset:61440
    ds_read_b64_tr_b16 a[62:63], v10 offset:62464
    s_waitcnt vmcnt(20)
    s_barrier
    ds_read_b64_tr_b16 a[64:65], v11 offset:0
    ds_read_b64_tr_b16 a[66:67], v11 offset:1024
    ds_read_b64_tr_b16 a[68:69], v11 offset:4096
    ds_read_b64_tr_b16 a[70:71], v11 offset:5120
    ds_read_b64_tr_b16 a[72:73], v11 offset:8192
    ds_read_b64_tr_b16 a[74:75], v11 offset:9216
    ds_read_b64_tr_b16 a[76:77], v11 offset:12288
    ds_read_b64_tr_b16 a[78:79], v11 offset:13312
    s_waitcnt vmcnt(16)
    s_barrier
    ds_read_b64_tr_b16 a[80:81], v11 offset:16384
    ds_read_b64_tr_b16 a[82:83], v11 offset:17408
    ds_read_b64_tr_b16 a[84:85], v11 offset:20480
    ds_read_b64_tr_b16 a[86:87], v11 offset:21504
    ds_read_b64_tr_b16 a[88:89], v11 offset:24576
    ds_read_b64_tr_b16 a[90:91], v11 offset:25600
    ds_read_b64_tr_b16 a[92:93], v11 offset:28672
    ds_read_b64_tr_b16 a[94:95], v11 offset:29696
    s_waitcnt vmcnt(12)
    s_barrier
    ds_read_b64_tr_b16 a[96:97], v11 offset:32768
    ds_read_b64_tr_b16 a[98:99], v11 offset:33792
    ds_read_b64_tr_b16 a[100:101], v11 offset:36864
    ds_read_b64_tr_b16 a[102:103], v11 offset:37888
    ds_read_b64_tr_b16 a[104:105], v11 offset:40960
    ds_read_b64_tr_b16 a[106:107], v11 offset:41984
    ds_read_b64_tr_b16 a[108:109], v11 offset:45056
    ds_read_b64_tr_b16 a[110:111], v11 offset:46080
    s_waitcnt vmcnt(8)
    s_barrier
    v_bfe_u32 v2, v0, 0, 6
    v_lshlrev_b32 v14, 3, v2
    buffer_load_dwordx2 v[18:19], v14, s[40:43], 0 offen sc1
    ds_read_b64_tr_b16 a[112:113], v11 offset:49152
    ds_read_b64_tr_b16 a[114:115], v11 offset:50176
    ds_read_b64_tr_b16 a[116:117], v11 offset:53248
    ds_read_b64_tr_b16 a[118:119], v11 offset:54272
    ds_read_b64_tr_b16 a[120:121], v11 offset:57344
    ds_read_b64_tr_b16 a[122:123], v11 offset:58368
    ds_read_b64_tr_b16 a[124:125], v11 offset:61440
    ds_read_b64_tr_b16 a[126:127], v11 offset:62464
    s_waitcnt vmcnt(4)
    s_barrier
    ds_read_b64_tr_b16 a[128:129], v12 offset:0
    ds_read_b64_tr_b16 a[130:131], v12 offset:1024
    ds_read_b64_tr_b16 a[132:133], v12 offset:4096
    ds_read_b64_tr_b16 a[134:135], v12 offset:5120
    ds_read_b64_tr_b16 a[136:137], v12 offset:8192
    ds_read_b64_tr_b16 a[138:139], v12 offset:9216
    ds_read_b64_tr_b16 a[140:141], v12 offset:12288
    ds_read_b64_tr_b16 a[142:143], v12 offset:13312
    s_waitcnt vmcnt(0)
    s_barrier
    ds_read_b64_tr_b16 a[144:145], v12 offset:16384
    ds_read_b64_tr_b16 a[146:147], v12 offset:17408
    ds_read_b64_tr_b16 a[148:149], v12 offset:20480
    ds_read_b64_tr_b16 a[150:151], v12 offset:21504
    ds_read_b64_tr_b16 a[152:153], v12 offset:24576
    ds_read_b64_tr_b16 a[154:155], v12 offset:25600
    ds_read_b64_tr_b16 a[156:157], v12 offset:28672
    ds_read_b64_tr_b16 a[158:159], v12 offset:29696
    s_waitcnt lgkmcnt(0)
    s_waitcnt vmcnt(0)
    v_and_b32 v17, 8, v0
    v_cmp_ne_u32 vcc, 0, v17
    v_mov_b32 v17, -1
    s_nop 0
    v_cndmask_b32 v17, v17, 32, vcc
    v_cmp_ne_u32 vcc, v17, v16
    s_cbranch_vccnz KS_203
    v_min_u32 v18, v18, v19
    v_cmp_ne_u32 vcc, 1, v18
    s_cbranch_vccz KF_204
    s_branch KS_203_l
KS_203:
    v_mov_b32 v1, 0x4
    v_bfe_u32 v2, v0, 0, 3
    v_lshl_add_u32 v1, v2, 5, v1
    v_bfe_u32 v2, v0, 3, 1
    s_mov_b32 s75, 12
    v_mad_u32_u24 v1, v2, s75, v1
    s_mov_b32 s38, 262144
PL_205:
    buffer_load_dword v2, v1, s[44:47], 0 offen sc1
    s_waitcnt vmcnt(0)
    v_and_b32 v3, 8, v0
    v_cmp_ne_u32 vcc, 0, v3
    s_nop 1
    v_cndmask_b32 v3, 0, v2, vcc
    s_nop 1
    v_add_u32_dpp v3, v3, v3 row_ror:8 row_mask:0xf bank_mask:0xf
    s_nop 1
    v_add_u32_dpp v3, v3, v3 row_ror:4 row_mask:0xf bank_mask:0xf
    s_nop 1
    v_add_u32_dpp v3, v3, v3 quad_perm:[2,3,0,1] row_mask:0xf bank_mask:0xf
    s_nop 1
    v_add_u32_dpp v3, v3, v3 quad_perm:[1,0,3,2] row_mask:0xf bank_mask:0xf
    v_cmp_gt_u32 vcc, 0x100, v3
    s_cbranch_vccnz PN_206
    s_branch PO_207
PN_206:
    s_sleep 1
    s_sub_u32 s38, s38, 1
    s_cbranch_scc0 PL_205
    s_mov_b32 s68, 2
    s_branch FAIL
PO_207:
    s_cmp_eq_u32 s101, 0
    s_cbranch_scc1 VOK_208
    v_and_b32 v3, 8, v0
    v_cmp_ne_u32 vcc, 0, v3
    v_mov_b32 v3, -1
    s_nop 0
    v_cndmask_b32 v3, v3, 32, vcc
    v_cmp_ne_u32 vcc, v3, v2
    s_cbranch_vccz VOK_208
    s_branch RESPEC
VOK_208:
KS_203_l:
    v_bfe_u32 v2, v0, 0, 6
    v_lshlrev_b32 v1, 3, v2
    s_mov_b32 s38, 262144
PL_209:
    buffer_load_dwordx2 v[2:3], v1, s[40:43], 0 offen sc1
    s_waitcnt vmcnt(0)
    v_min_u32 v2, v2, v3
    v_cmp_eq_u32 vcc, 0, v2
    s_cbranch_vccnz PN_210
    s_branch PO_211
PN_210:
    s_sleep 2
    s_sub_u32 s38, s38, 1
    s_cbranch_scc0 PL_209
    s_mov_b32 s68, 3
    s_branch FAIL
PO_211:
KF_204:
    s_barrier
    v_bfe_u32 v2, v0, 4, 1
    v_lshlrev_b32 v6, 12, v2
    v_bfe_u32 v2, v0, 6, 2
    v_lshl_add_u32 v6, v2, 10, v6
    v_bfe_u32 v2, v0, 5, 1
    v_lshl_add_u32 v6, v2, 9, v6
    v_bfe_u32 v2, v0, 0, 4
    v_lshl_add_u32 v6, v2, 4, v6
    s_lshl_b32 s83, s35, 13
    s_add_u32 s83, s83, 0x2000000
    s_mov_b32 s80, 0x100000
    s_mov_b32 s81, 0
    s_mov_b32 s84, 0
    v_mov_b32 v5, v4
    s_mul_i32 s69, s34, 10240
    s_add_u32 s70, s69, s81
    s_add_u32 s69, s69, s80
    s_mov_b32 m0, s70
    s_nop 0
    buffer_load_dwordx4 v4, s[40:43], s69 offen sc1 lds
    buffer_load_dwordx4 v4, s[40:43], s69 offen offset:1024 sc1 lds
    buffer_load_dwordx4 v4, s[40:43], s69 offen offset:2048 sc1 lds
    buffer_load_dwordx4 v4, s[40:43], s69 offen offset:3072 sc1 lds
    s_add_u32 s69, s69, 4096
    s_add_u32 s70, s70, 4096
    s_mov_b32 m0, s70
    s_nop 0
    buffer_load_dwordx4 v4, s[40:43], s69 offen sc1 lds
    buffer_load_dwordx4 v4, s[40:43], s69 offen offset:1024 sc1 lds
    buffer_load_dwordx4 v4, s[40:43], s69 offen offset:2048 sc1 lds
    buffer_load_dwordx4 v4, s[40:43], s69 offen offset:3072 sc1 lds
    s_add_u32 s69, s69, 4096
    s_add_u32 s70, s70, 4096
    s_mov_b32 m0, s70
    s_nop 0
    buffer_load_dwordx4 v4, s[40:43], s69 offen sc1 lds
    buffer_load_dwordx4 v4, s[40:43], s69 offen offset:1024 sc1 lds
    s_add_u32 s69, s80, 40960
    buffer_load_dword v9, v7, s[40:43], s69 offen
    s_add_u32 s69, s80, 81920
    buffer_load_dword v9, v7, s[40:43], s69 offen
    s_waitcnt vmcnt(2)
KV_LOOP_K:
    s_barrier
    s_cmp_lt_u32 s84, 63
    s_cselect_b32 s69, 40960, 0
    s_add_u32 s80, s80, s69
    s_xor_b32 s81, s81, 0x10000
    ds_read_b128 v[48:51], v5 offset:0
    ds_read_b128 v[52:55], v5 offset:1024
    ds_read_b128 v[56:59], v5 offset:2048
    ds_read_b128 v[60:63], v5 offset:3072
    s_waitcnt lgkmcnt(3)
    v_mfma_f32_32x32x16_bf16 v[16:31], a[0:3], v[48:51], 0
    s_mul_i32 s72, s34, 10240
    s_add_u32 s73, s72, s81
    s_add_u32 s72, s72, s80
    s_mov_b32 m0, s73
    s_nop 0
    buffer_load_dwordx4 v4, s[40:43], s72 offen sc1 lds
    ds_read_b128 v[48:51], v5 offset:4096
    s_waitcnt lgkmcnt(3)
    v_mfma_f32_32x32x16_bf16 v[16:31], a[4:7], v[52:55], v[16:31]
    ds_read_b128 v[52:55], v5 offset:5120
    s_waitcnt lgkmcnt(3)
    v_mfma_f32_32x32x16_bf16 v[16:31], a[8:11], v[56:59], v[16:31]
    buffer_load_dwordx4 v4, s[40:43], s72 offen offset:1024 sc1 lds
    ds_read_b128 v[56:59], v5 offset:6144
    s_waitcnt lgkmcnt(3)
    v_mfma_f32_32x32x16_bf16 v[16:31], a[12:15], v[60:63], v[16:31]
    ds_read_b128 v[60:63], v5 offset:7168
    s_waitcnt lgkmcnt(3)
    v_mfma_f32_32x32x16_bf16 v[16:31], a[16:19], v[48:51], v[16:31]
    buffer_load_dwordx4 v4, s[40:43], s72 offen offset:2048 sc1 lds
    ds_read_b128 v[48:51], v5 offset:8192
    s_waitcnt lgkmcnt(3)
    v_mfma_f32_32x32x16_bf16 v[16:31], a[20:23], v[52:55], v[16:31]
    ds_read_b128 v[52:55], v5 offset:9216
    s_waitcnt lgkmcnt(3)
    v_mfma_f32_32x32x16_bf16 v[16:31], a[24:27], v[56:59], v[16:31]
    buffer_load_dwordx4 v4, s[40:43], s72 offen offset:3072 sc1 lds
    ds_read_b128 v[56:59], v5 offset:10240
    s_waitcnt lgkmcnt(3)
    v_mfma_f32_32x32x16_bf16 v[16:31], a[28:31], v[60:63], v[16:31]
    ds_read_b128 v[60:63], v5 offset:11264
    s_waitcnt lgkmcnt(3)
    v_mfma_f32_32x32x16_bf16 v[16:31], a[32:35], v[48:51], v[16:31]
    s_add_u32 s73, s73, 4096
    s_mov_b32 m0, s73
    s_add_u32 s72, s72, 4096
    buffer_load_dwordx4 v4, s[40:43], s72 offen sc1 lds
    ds_read_b128 v[48:51], v5 offset:12288
    s_waitcnt lgkmcnt(3)
    v_mfma_f32_32x32x16_bf16 v[16:31], a[36:39], v[52:55], v[16:31]
    ds_read_b128 v[52:55], v5 offset:13312
    s_waitcnt lgkmcnt(3)
    v_mfma_f32_32x32x16_bf16 v[16:31], a[40:43], v[56:59], v[16:31]
    buffer_load_dwordx4 v4, s[40:43], s72 offen offset:1024 sc1 lds
    ds_read_b128 v[56:59], v5 offset:14336
    s_waitcnt lgkmcnt(3)
    v_mfma_f32_32x32x16_bf16 v[16:31], a[44:47], v[60:63], v[16:31]
    ds_read_b128 v[60:63], v5 offset:15360
    s_waitcnt lgkmcnt(3)
    v_mfma_f32_32x32x16_bf16 v[16:31], a[48:51], v[48:51], v[16:31]
    buffer_load_dwordx4 v4, s[40:43], s72 offen offset:2048 sc1 lds
    ds_read_b128 v[48:51], v5 offset:16384
    s_waitcnt lgkmcnt(3)
    v_mfma_f32_32x32x16_bf16 v[16:31], a[52:55], v[52:55], v[16:31]
    ds_read_b128 v[52:55], v5 offset:17408
    s_waitcnt lgkmcnt(3)
    v_mfma_f32_32x32x16_bf16 v[16:31], a[56:59], v[56:59], v[16:31]
    buffer_load_dwordx4 v4, s[40:43], s72 offen offset:3072 sc1 lds
    ds_read_b128 v[56:59], v5 offset:18432
    s_waitcnt lgkmcnt(3)
    v_mfma_f32_32x32x16_bf16 v[16:31], a[60:63], v[60:63], v[16:31]
    ds_read_b128 v[60:63], v5 offset:19456
    s_waitcnt lgkmcnt(3)
    v_mfma_f32_32x32x16_bf16 v[16:31], a[64:67], v[48:51], v[16:31]
    s_add_u32 s73, s73, 4096
    s_mov_b32 m0, s73
    s_add_u32 s72, s72, 4096
    buffer_load_dwordx4 v4, s[40:43], s72 offen sc1 lds
    ds_read_b128 v[48:51], v5 offset:20480
    s_waitcnt lgkmcnt(3)
    v_mfma_f32_32x32x16_bf16 v[16:31], a[68:71], v[52:55], v[16:31]
    ds_read_b128 v[52:55], v5 offset:21504
    s_waitcnt lgkmcnt(3)
    v_mfma_f32_32x32x16_bf16 v[16:31], a[72:75], v[56:59], v[16:31]
    buffer_load_dwordx4 v4, s[40:43], s72 offen offset:1024 sc1 lds
    ds_read_b128 v[56:59], v5 offset:22528
    s_waitcnt lgkmcnt(3)
    v_mfma_f32_32x32x16_bf16 v[16:31], a[76:79], v[60:63], v[16:31]
    ds_read_b128 v[60:63], v5 offset:23552
    s_waitcnt lgkmcnt(3)
    v_mfma_f32_32x32x16_bf16 v[16:31], a[80:83], v[48:51], v[16:31]
    s_add_u32 s69, s80, 81920
    buffer_load_dword v9, v7, s[40:43], s69 offen
    ds_read_b128 v[48:51], v5 offset:24576
    s_waitcnt lgkmcnt(3)
    v_mfma_f32_32x32x16_bf16 v[16:31], a[84:87], v[52:55], v[16:31]
    ds_read_b128 v[52:55], v5 offset:25600
    s_waitcnt lgkmcnt(3)
    v_mfma_f32_32x32x16_bf16 v[16:31], a[88:91], v[56:59], v[16:31]
    ds_read_b128 v[56:59], v5 offset:26624
    s_waitcnt lgkmcnt(3)
    v_mfma_f32_32x32x16_bf16 v[16:31], a[92:95], v[60:63], v[16:31]
    ds_read_b128 v[60:63], v5 offset:27648
    s_waitcnt lgkmcnt(3)
    v_mfma_f32_32x32x16_bf16 v[16:31], a[96:99], v[48:51], v[16:31]
    s_waitcnt vmcnt(11)
    s_barrier
    v_mov_b32 v1, s84
    s_mov_b64 exec, 1
    buffer_store_dword v1, off, s[40:43], s82 sc1
    s_mov_b64 exec, -1
    ds_read_b128 v[48:51], v5 offset:28672
    s_waitcnt lgkmcnt(3)
    v_mfma_f32_32x32x16_bf16 v[16:31], a[100:103], v[52:55], v[16:31]
    ds_read_b128 v[52:55], v5 offset:29696
    s_waitcnt lgkmcnt(3)
    v_mfma_f32_32x32x16_bf16 v[16:31], a[104:107], v[56:59], v[16:31]
    ds_read_b128 v[56:59], v5 offset:30720
    s_waitcnt lgkmcnt(3)
    v_mfma_f32_32x32x16_bf16 v[16:31], a[108:111], v[60:63], v[16:31]
    ds_read_b128 v[60:63], v5 offset:31744
    s_waitcnt lgkmcnt(3)
    v_mfma_f32_32x32x16_bf16 v[16:31], a[112:115], v[48:51], v[16:31]
    ds_read_b128 v[48:51], v5 offset:32768
    s_waitcnt lgkmcnt(3)
    v_mfma_f32_32x32x16_bf16 v[16:31], a[116:119], v[52:55], v[16:31]
    ds_read_b128 v[52:55], v5 offset:33792
    s_waitcnt lgkmcnt(3)
    v_mfma_f32_32x32x16_bf16 v[16:31], a[120:123], v[56:59], v[16:31]
    ds_read_b128 v[56:59], v5 offset:34816
    s_waitcnt lgkmcnt(3)
    v_mfma_f32_32x32x16_bf16 v[16:31], a[124:127], v[60:63], v[16:31]
    ds_read_b128 v[60:63], v5 offset:35840
    s_waitcnt lgkmcnt(3)
    v_mfma_f32_32x32x16_bf16 v[16:31], a[128:131], v[48:51], v[16:31]
    ds_read_b128 v[48:51], v5 offset:36864
    s_waitcnt lgkmcnt(3)
    v_mfma_f32_32x32x16_bf16 v[16:31], a[132:135], v[52:55], v[16:31]
    ds_read_b128 v[52:55], v5 offset:37888
    s_waitcnt lgkmcnt(3)
    v_mfma_f32_32x32x16_bf16 v[16:31], a[136:139], v[56:59], v[16:31]
    ds_read_b128 v[56:59], v5 offset:38912
    s_waitcnt lgkmcnt(3)
    v_mfma_f32_32x32x16_bf16 v[16:31], a[140:143], v[60:63], v[16:31]
    ds_read_b128 v[60:63], v5 offset:39936
    s_waitcnt lgkmcnt(3)
    v_mfma_f32_32x32x16_bf16 v[16:31], a[144:147], v[48:51], v[16:31]
    s_waitcnt lgkmcnt(2)
    v_mfma_f32_32x32x16_bf16 v[16:31], a[148:151], v[52:55], v[16:31]
    s_waitcnt lgkmcnt(1)
    v_mfma_f32_32x32x16_bf16 v[16:31], a[152:155], v[56:59], v[16:31]
    s_waitcnt lgkmcnt(0)
    v_mfma_f32_32x32x16_bf16 v[16:31], a[156:159], v[60:63], v[16:31]
    v_xor_b32 v5, 0x10000, v5
    s_nop 10
    v_cvt_pk_bf16_f32 v64, v16, v17
    v_cvt_pk_bf16_f32 v65, v18, v19
    v_cvt_pk_bf16_f32 v66, v20, v21
    v_cvt_pk_bf16_f32 v67, v22, v23
    v_cvt_pk_bf16_f32 v68, v24, v25
    v_cvt_pk_bf16_f32 v69, v26, v27
    v_cvt_pk_bf16_f32 v70, v28, v29
    v_cvt_pk_bf16_f32 v71, v30, v31
    buffer_store_dwordx4 v[64:67], v6, s[40:43], s83 offen offset:0 sc1
    buffer_store_dwordx4 v[68:71], v6, s[40:43], s83 offen offset:256 sc1
    s_add_u32 s83, s83, 0x40000
    s_add_u32 s84, s84, 1
    s_cmp_gt_u32 s84, 2
    s_cbranch_scc1 EF_212
    s_waitcnt vmcnt(0)
    s_barrier
    v_mov_b32 v1, s84
    s_mov_b64 exec, 1
    buffer_store_dword v1, off, s[40:43], s82 sc1
    s_mov_b64 exec, -1
EF_212:
    s_waitcnt vmcnt(3)
    s_cmp_lt_u32 s84, 64
    s_cbranch_scc1 KV_LOOP_K
    s_waitcnt vmcnt(0)
    s_barrier
    v_mov_b32 v1, s84
    s_mov_b64 exec, 1
    buffer_store_dword v1, off, s[40:43], s82 sc1
    s_mov_b64 exec, -1
    s_branch END
ROLE_V:
    s_mov_b32 s48, s12
    s_mov_b32 s49, s13
    s_mov_b32 s50, 0x500000
    s_mov_b32 s51, 0x20000
    v_bfe_u32 v2, v0, 6, 2
    v_lshlrev_b32 v10, 6, v2
    v_bfe_u32 v2, v0, 4, 1
    v_lshl_add_u32 v10, v2, 5, v10
    v_bfe_u32 v2, v0, 0, 2
    v_lshl_add_u32 v10, v2, 3, v10
    v_bfe_u32 v2, v0, 2, 2
    v_lshlrev_b32 v2, 6, v2
    v_xor_b32 v10, v2, v10
    v_bfe_u32 v2, v0, 2, 2
    v_lshl_add_u32 v10, v2, 8, v10
    v_bfe_u32 v2, v0, 5, 1
    v_lshl_add_u32 v10, v2, 11, v10
    v_add_u32 v11, 0x10000, v10
    v_add_u32 v12, 0x20000, v10
    s_mul_i32 s71, s34, 131072
    s_add_u32 s71, s71, s72
    s_lshl_b32 s70, s34, 12
    s_add_u32 m0, s70, 0
    s_nop 0
    buffer_load_dwordx4 v8, s[48:51], s71 offen  lds
    s_add_u32 s69, s71, 32768
    s_lshl_b32 s70, s34, 12
    s_add_u32 m0, s70, 1024
    s_nop 0
    buffer_load_dwordx4 v8, s[48:51], s69 offen  lds
    s_add_u32 s69, s71, 65536
    s_lshl_b32 s70, s34, 12
    s_add_u32 m0, s70, 2048
    s_nop 0
    buffer_load_dwordx4 v8, s[48:51], s69 offen  lds
    s_add_u32 s69, s71, 98304
    s_lshl_b32 s70, s34, 12
    s_add_u32 m0, s70, 3072
    s_nop 0
    buffer_load_dwordx4 v8, s[48:51], s69 offen  lds
    s_cmp_lg_u32 s34, 1
    s_cbranch_scc1 CI_213
    s_cmp_eq_u32 s101, 0
    s_cbranch_scc1 CI_213
    s_waitcnt vmcnt(4)
    s_lshl_b32 s68, s33, 5
    s_add_u32 s68, s68, 16
    v_mov_b32 v13, 1
    s_mov_b64 exec, 1
    buffer_atomic_add v13, off, s[44:47], s68
    s_mov_b64 exec, -1
CI_213:
    s_add_u32 s71, s71, 524288
    s_lshl_b32 s70, s34, 12
    s_add_u32 m0, s70, 16384
    s_nop 0
    buffer_load_dwordx4 v8, s[48:51], s71 offen  lds
    s_add_u32 s69, s71, 32768
    s_lshl_b32 s70, s34, 12
    s_add_u32 m0, s70, 17408
    s_nop 0
    buffer_load_dwordx4 v8, s[48:51], s69 offen  lds
    s_add_u32 s69, s71, 65536
    s_lshl_b32 s70, s34, 12
    s_add_u32 m0, s70, 18432
    s_nop 0
    buffer_load_dwordx4 v8, s[48:51], s69 offen  lds
    s_add_u32 s69, s71, 98304
    s_lshl_b32 s70, s34, 12
    s_add_u32 m0, s70, 19456
    s_nop 0
    buffer_load_dwordx4 v8, s[48:51], s69 offen  lds
    s_add_u32 s71, s71, 524288
    s_lshl_b32 s70, s34, 12
    s_add_u32 m0, s70, 32768
    s_nop 0
    buffer_load_dwordx4 v8, s[48:51], s71 offen  lds
    s_add_u32 s69, s71, 32768
    s_lshl_b32 s70, s34, 12
    s_add_u32 m0, s70, 33792
    s_nop 0
    buffer_load_dwordx4 v8, s[48:51], s69 offen  lds
    s_add_u32 s69, s71, 65536
    s_lshl_b32 s70, s34, 12
    s_add_u32 m0, s70, 34816
    s_nop 0
    buffer_load_dwordx4 v8, s[48:51], s69 offen  lds
    s_add_u32 s69, s71, 98304
    s_lshl_b32 s70, s34, 12
    s_add_u32 m0, s70, 35840
    s_nop 0
    buffer_load_dwordx4 v8, s[48:51], s69 offen  lds
    s_add_u32 s71, s71, 524288
    s_lshl_b32 s70, s34, 12
    s_add_u32 m0, s70, 49152
    s_nop 0
    buffer_load_dwordx4 v8, s[48:51], s71 offen  lds
    s_add_u32 s69, s71, 32768
    s_lshl_b32 s70, s34, 12
    s_add_u32 m0, s70, 50176
    s_nop 0
    buffer_load_dwordx4 v8, s[48:51], s69 offen  lds
    s_add_u32 s69, s71, 65536
    s_lshl_b32 s70, s34, 12
    s_add_u32 m0, s70, 51200
    s_nop 0
    buffer_load_dwordx4 v8, s[48:51], s69 offen  lds
    s_add_u32 s69, s71, 98304
    s_lshl_b32 s70, s34, 12
    s_add_u32 m0, s70, 52224
    s_nop 0
    buffer_load_dwordx4 v8, s[48:51], s69 offen  lds
    s_add_u32 s71, s71, 524288
    s_lshl_b32 s70, s34, 12
    s_add_u32 m0, s70, 65536
    s_nop 0
    buffer_load_dwordx4 v8, s[48:51], s71 offen  lds
    s_add_u32 s69, s71, 32768
    s_lshl_b32 s70, s34, 12
    s_add_u32 m0, s70, 66560
    s_nop 0
    buffer_load_dwordx4 v8, s[48:51], s69 offen  lds
    s_add_u32 s69, s71, 65536
    s_lshl_b32 s70, s34, 12
    s_add_u32 m0, s70, 67584
    s_nop 0
    buffer_load_dwordx4 v8, s[48:51], s69 offen  lds
    s_add_u32 s69, s71, 98304
    s_lshl_b32 s70, s34, 12
    s_add_u32 m0, s70, 68608
    s_nop 0
    buffer_load_dwordx4 v8, s[48:51], s69 offen  lds
    s_add_u32 s71, s71, 524288
    s_lshl_b32 s70, s34, 12
    s_add_u32 m0, s70, 81920
    s_nop 0
    buffer_load_dwordx4 v8, s[48:51], s71 offen  lds
    s_add_u32 s69, s71, 32768
    s_lshl_b32 s70, s34, 12
    s_add_u32 m0, s70, 82944
    s_nop 0
    buffer_load_dwordx4 v8, s[48:51], s69 offen  lds
    s_add_u32 s69, s71, 65536
    s_lshl_b32 s70, s34, 12
    s_add_u32 m0, s70, 83968
    s_nop 0
    buffer_load_dwordx4 v8, s[48:51], s69 offen  lds
    s_add_u32 s69, s71, 98304
    s_lshl_b32 s70, s34, 12
    s_add_u32 m0, s70, 84992
    s_nop 0
    buffer_load_dwordx4 v8, s[48:51], s69 offen  lds
    s_add_u32 s71, s71, 524288
    s_lshl_b32 s70, s34, 12
    s_add_u32 m0, s70, 98304
    s_nop 0
    buffer_load_dwordx4 v8, s[48:51], s71 offen  lds
    s_add_u32 s69, s71, 32768
    s_lshl_b32 s70, s34, 12
    s_add_u32 m0, s70, 99328
    s_nop 0
    buffer_load_dwordx4 v8, s[48:51], s69 offen  lds
    s_add_u32 s69, s71, 65536
    s_lshl_b32 s70, s34, 12
    s_add_u32 m0, s70, 100352
    s_nop 0
    buffer_load_dwordx4 v8, s[48:51], s69 offen  lds
    s_add_u32 s69, s71, 98304
    s_lshl_b32 s70, s34, 12
    s_add_u32 m0, s70, 101376
    s_nop 0
    buffer_load_dwordx4 v8, s[48:51], s69 offen  lds
    v_mov_b32 v13, 0x4
    v_bfe_u32 v2, v0, 0, 3
    v_lshl_add_u32 v13, v2, 5, v13
    v_bfe_u32 v2, v0, 3, 1
    s_mov_b32 s75, 12
    v_mad_u32_u24 v13, v2, s75, v13
    buffer_load_dword v16, v13, s[44:47], 0 offen sc1
    s_add_u32 s71, s71, 524288
    s_lshl_b32 s70, s34, 12
    s_add_u32 m0, s70, 114688
    s_nop 0
    buffer_load_dwordx4 v8, s[48:51], s71 offen  lds
    s_add_u32 s69, s71, 32768
    s_lshl_b32 s70, s34, 12
    s_add_u32 m0, s70, 115712
    s_nop 0
    buffer_load_dwordx4 v8, s[48:51], s69 offen  lds
    s_add_u32 s69, s71, 65536
    s_lshl_b32 s70, s34, 12
    s_add_u32 m0, s70, 116736
    s_nop 0
    buffer_load_dwordx4 v8, s[48:51], s69 offen  lds
    s_add_u32 s69, s71, 98304
    s_lshl_b32 s70, s34, 12
    s_add_u32 m0, s70, 117760
    s_nop 0
    buffer_load_dwordx4 v8, s[48:51], s69 offen  lds
    s_add_u32 s71, s71, 524288
    s_lshl_b32 s70, s34, 12
    s_add_u32 m0, s70, 131072
    s_nop 0
    buffer_load_dwordx4 v8, s[48:51], s71 offen  lds
    s_add_u32 s69, s71, 32768
    s_lshl_b32 s70, s34, 12
    s_add_u32 m0, s70, 132096
    s_nop 0
    buffer_load_dwordx4 v8, s[48:51], s69 offen  lds
    s_add_u32 s69, s71, 65536
    s_lshl_b32 s70, s34, 12
    s_add_u32 m0, s70, 133120
    s_nop 0
    buffer_load_dwordx4 v8, s[48:51], s69 offen  lds
    s_add_u32 s69, s71, 98304
    s_lshl_b32 s70, s34, 12
    s_add_u32 m0, s70, 134144
    s_nop 0
    buffer_load_dwordx4 v8, s[48:51], s69 offen  lds
    s_add_u32 s71, s71, 524288
    s_lshl_b32 s70, s34, 12
    s_add_u32 m0, s70, 147456
    s_nop 0
    buffer_load_dwordx4 v8, s[48:51], s71 offen  lds
    s_add_u32 s69, s71, 32768
    s_lshl_b32 s70, s34, 12
    s_add_u32 m0, s70, 148480
    s_nop 0
    buffer_load_dwordx4 v8, s[48:51], s69 offen  lds
    s_add_u32 s69, s71, 65536
    s_lshl_b32 s70, s34, 12
    s_add_u32 m0, s70, 149504
    s_nop 0
    buffer_load_dwordx4 v8, s[48:51], s69 offen  lds
    s_add_u32 s69, s71, 98304
    s_lshl_b32 s70, s34, 12
    s_add_u32 m0, s70, 150528
    s_nop 0
    buffer_load_dwordx4 v8, s[48:51], s69 offen  lds
    s_waitcnt vmcnt(36)
    s_barrier
    ds_read_b64_tr_b16 a[0:1], v10 offset:0
    ds_read_b64_tr_b16 a[2:3], v10 offset:1024
    ds_read_b64_tr_b16 a[4:5], v10 offset:4096
    ds_read_b64_tr_b16 a[6:7], v10 offset:5120
    ds_read_b64_tr_b16 a[8:9], v10 offset:8192
    ds_read_b64_tr_b16 a[10:11], v10 offset:9216
    ds_read_b64_tr_b16 a[12:13], v10 offset:12288
    ds_read_b64_tr_b16 a[14:15], v10 offset:13312
    s_waitcnt vmcnt(32)
    s_barrier
    ds_read_b64_tr_b16 a[16:17], v10 offset:16384
    ds_read_b64_tr_b16 a[18:19], v10 offset:17408
    ds_read_b64_tr_b16 a[20:21], v10 offset:20480
    ds_read_b64_tr_b16 a[22:23], v10 offset:21504
    ds_read_b64_tr_b16 a[24:25], v10 offset:24576
    ds_read_b64_tr_b16 a[26:27], v10 offset:25600
    ds_read_b64_tr_b16 a[28:29], v10 offset:28672
    ds_read_b64_tr_b16 a[30:31], v10 offset:29696
    s_waitcnt vmcnt(28)
    s_barrier
    ds_read_b64_tr_b16 a[32:33], v10 offset:32768
    ds_read_b64_tr_b16 a[34:35], v10 offset:33792
    ds_read_b64_tr_b16 a[36:37], v10 offset:36864
    ds_read_b64_tr_b16 a[38:39], v10 offset:37888
    ds_read_b64_tr_b16 a[40:41], v10 offset:40960
    ds_read_b64_tr_b16 a[42:43], v10 offset:41984
    ds_read_b64_tr_b16 a[44:45], v10 offset:45056
    ds_read_b64_tr_b16 a[46:47], v10 offset:46080
    s_waitcnt vmcnt(24)
    s_barrier
    ds_read_b64_tr_b16 a[48:49], v10 offset:49152
    ds_read_b64_tr_b16 a[50:51], v10 offset:50176
    ds_read_b64_tr_b16 a[52:53], v10 offset:53248
    ds_read_b64_tr_b16 a[54:55], v10 offset:54272
    ds_read_b64_tr_b16 a[56:57], v10 offset:57344
    ds_read_b64_tr_b16 a[58:59], v10 offset:58368
    ds_read_b64_tr_b16 a[60:61], v10 offset:61440
    ds_read_b64_tr_b16 a[62:63], v10 offset:62464
    s_waitcnt vmcnt(20)
    s_barrier
    ds_read_b64_tr_b16 a[64:65], v11 offset:0
    ds_read_b64_tr_b16 a[66:67], v11 offset:1024
    ds_read_b64_tr_b16 a[68:69], v11 offset:4096
    ds_read_b64_tr_b16 a[70:71], v11 offset:5120
    ds_read_b64_tr_b16 a[72:73], v11 offset:8192
    ds_read_b64_tr_b16 a[74:75], v11 offset:9216
    ds_read_b64_tr_b16 a[76:77], v11 offset:12288
    ds_read_b64_tr_b16 a[78:79], v11 offset:13312
    s_waitcnt vmcnt(16)
    s_barrier
    ds_read_b64_tr_b16 a[80:81], v11 offset:16384
    ds_read_b64_tr_b16 a[82:83], v11 offset:17408
    ds_read_b64_tr_b16 a[84:85], v11 offset:20480
    ds_read_b64_tr_b16 a[86:87], v11 offset:21504
    ds_read_b64_tr_b16 a[88:89], v11 offset:24576
    ds_read_b64_tr_b16 a[90:91], v11 offset:25600
    ds_read_b64_tr_b16 a[92:93], v11 offset:28672
    ds_read_b64_tr_b16 a[94:95], v11 offset:29696
    s_waitcnt vmcnt(12)
    s_barrier
    ds_read_b64_tr_b16 a[96:97], v11 offset:32768
    ds_read_b64_tr_b16 a[98:99], v11 offset:33792
    ds_read_b64_tr_b16 a[100:101], v11 offset:36864
    ds_read_b64_tr_b16 a[102:103], v11 offset:37888
    ds_read_b64_tr_b16 a[104:105], v11 offset:40960
    ds_read_b64_tr_b16 a[106:107], v11 offset:41984
    ds_read_b64_tr_b16 a[108:109], v11 offset:45056
    ds_read_b64_tr_b16 a[110:111], v11 offset:46080
    s_waitcnt vmcnt(8)
    s_barrier
    v_bfe_u32 v2, v0, 0, 6
    v_lshlrev_b32 v14, 3, v2
    buffer_load_dwordx2 v[18:19], v14, s[40:43], 0 offen sc1
    ds_read_b64_tr_b16 a[112:113], v11 offset:49152
    ds_read_b64_tr_b16 a[114:115], v11 offset:50176
    ds_read_b64_tr_b16 a[116:117], v11 offset:53248
    ds_read_b64_tr_b16 a[118:119], v11 offset:54272
    ds_read_b64_tr_b16 a[120:121], v11 offset:57344
    ds_read_b64_tr_b16 a[122:123], v11 offset:58368
    ds_read_b64_tr_b16 a[124:125], v11 offset:61440
    ds_read_b64_tr_b16 a[126:127], v11 offset:62464
    s_waitcnt vmcnt(4)
    s_barrier
    ds_read_b64_tr_b16 a[128:129], v12 offset:0
    ds_read_b64_tr_b16 a[130:131], v12 offset:1024
    ds_read_b64_tr_b16 a[132:133], v12 offset:4096
    ds_read_b64_tr_b16 a[134:135], v12 offset:5120
    ds_read_b64_tr_b16 a[136:137], v12 offset:8192
    ds_read_b64_tr_b16 a[138:139], v12 offset:9216
    ds_read_b64_tr_b16 a[140:141], v12 offset:12288
    ds_read_b64_tr_b16 a[142:143], v12 offset:13312
    s_waitcnt vmcnt(0)
    s_barrier
    ds_read_b64_tr_b16 a[144:145], v12 offset:16384
    ds_read_b64_tr_b16 a[146:147], v12 offset:17408
    ds_read_b64_tr_b16 a[148:149], v12 offset:20480
    ds_read_b64_tr_b16 a[150:151], v12 offset:21504
    ds_read_b64_tr_b16 a[152:153], v12 offset:24576
    ds_read_b64_tr_b16 a[154:155], v12 offset:25600
    ds_read_b64_tr_b16 a[156:157], v12 offset:28672
    ds_read_b64_tr_b16 a[158:159], v12 offset:29696
    s_waitcnt lgkmcnt(0)
    s_waitcnt vmcnt(0)
    v_and_b32 v17, 8, v0
    v_cmp_ne_u32 vcc, 0, v17
    v_mov_b32 v17, -1
    s_nop 0
    v_cndmask_b32 v17, v17, 32, vcc
    v_cmp_ne_u32 vcc, v17, v16
    s_cbranch_vccnz KS_214
    v_min_u32 v18, v18, v19
    v_cmp_ne_u32 vcc, 1, v18
    s_cbranch_vccz KF_215
    s_branch KS_214_l
KS_214:
    v_mov_b32 v1, 0x4
    v_bfe_u32 v2, v0, 0, 3
    v_lshl_add_u32 v1, v2, 5, v1
    v_bfe_u32 v2, v0, 3, 1
    s_mov_b32 s75, 12
    v_mad_u32_u24 v1, v2, s75, v1
    s_mov_b32 s38, 262144
PL_216:
    buffer_load_dword v2, v1, s[44:47], 0 offen sc1
    s_waitcnt vmcnt(0)
    v_and_b32 v3, 8, v0
    v_cmp_ne_u32 vcc, 0, v3
    s_nop 1
    v_cndmask_b32 v3, 0, v2, vcc
    s_nop 1
    v_add_u32_dpp v3, v3, v3 row_ror:8 row_mask:0xf bank_mask:0xf
    s_nop 1
    v_add_u32_dpp v3, v3, v3 row_ror:4 row_mask:0xf bank_mask:0xf
    s_nop 1
    v_add_u32_dpp v3, v3, v3 quad_perm:[2,3,0,1] row_mask:0xf bank_mask:0xf
    s_nop 1
    v_add_u32_dpp v3, v3, v3 quad_perm:[1,0,3,2] row_mask:0xf bank_mask:0xf
    v_cmp_gt_u32 vcc, 0x100, v3
    s_cbranch_vccnz PN_217
    s_branch PO_218
PN_217:
    s_sleep 1
    s_sub_u32 s38, s38, 1
    s_cbranch_scc0 PL_216
    s_mov_b32 s68, 2
    s_branch FAIL
PO_218:
    s_cmp_eq_u32 s101, 0
    s_cbranch_scc1 VOK_219
    v_and_b32 v3, 8, v0
    v_cmp_ne_u32 vcc, 0, v3
    v_mov_b32 v3, -1
    s_nop 0
    v_cndmask_b32 v3, v3, 32, vcc
    v_cmp_ne_u32 vcc, v3, v2
    s_cbranch_vccz VOK_219
    s_branch RESPEC
VOK_219:
KS_214_l:
    v_bfe_u32 v2, v0, 0, 6
    v_lshlrev_b32 v1, 3, v2
    s_mov_b32 s38, 262144
PL_220:
    buffer_load_dwordx2 v[2:3], v1, s[40:43], 0 offen sc1
    s_waitcnt vmcnt(0)
    v_min_u32 v2, v2, v3
    v_cmp_eq_u32 vcc, 0, v2
    s_cbranch_vccnz PN_221
    s_branch PO_222
PN_221:
    s_sleep 2
    s_sub_u32 s38, s38, 1
    s_cbranch_scc0 PL_220
    s_mov_b32 s68, 3
    s_branch FAIL
PO_222:
KF_215:
    s_barrier
    v_bfe_u32 v2, v0, 6, 2
    v_lshlrev_b32 v6, 11, v2
    v_bfe_u32 v2, v0, 4, 1
    v_lshl_add_u32 v6, v2, 10, v6
    v_bfe_u32 v2, v0, 5, 1
    v_lshl_add_u32 v6, v2, 8, v6
    v_bfe_u32 v2, v0, 0, 4
    v_lshl_add_u32 v6, v2, 4, v6
    s_lshl_b32 s83, s35, 13
    s_add_u32 s83, s83, 0x3000000
    s_mov_b32 s80, 0x100000
    s_mov_b32 s81, 0
    s_mov_b32 s84, 0
    v_mov_b32 v5, v4
    s_mul_i32 s69, s34, 10240
    s_add_u32 s70, s69, s81
    s_add_u32 s69, s69, s80
    s_mov_b32 m0, s70
    s_nop 0
    buffer_load_dwordx4 v4, s[40:43], s69 offen sc1 lds
    buffer_load_dwordx4 v4, s[40:43], s69 offen offset:1024 sc1 lds
    buffer_load_dwordx4 v4, s[40:43], s69 offen offset:2048 sc1 lds
    buffer_load_dwordx4 v4, s[40:43], s69 offen offset:3072 sc1 lds
    s_add_u32 s69, s69, 4096
    s_add_u32 s70, s70, 4096
    s_mov_b32 m0, s70
    s_nop 0
    buffer_load_dwordx4 v4, s[40:43], s69 offen sc1 lds
    buffer_load_dwordx4 v4, s[40:43], s69 offen offset:1024 sc1 lds
    buffer_load_dwordx4 v4, s[40:43], s69 offen offset:2048 sc1 lds
    buffer_load_dwordx4 v4, s[40:43], s69 offen offset:3072 sc1 lds
    s_add_u32 s69, s69, 4096
    s_add_u32 s70, s70, 4096
    s_mov_b32 m0, s70
    s_nop 0
    buffer_load_dwordx4 v4, s[40:43], s69 offen sc1 lds
    buffer_load_dwordx4 v4, s[40:43], s69 offen offset:1024 sc1 lds
    s_add_u32 s69, s80, 40960
    buffer_load_dword v9, v7, s[40:43], s69 offen
    s_add_u32 s69, s80, 81920
    buffer_load_dword v9, v7, s[40:43], s69 offen
    s_waitcnt vmcnt(2)
KV_LOOP_V:
    s_barrier
    s_cmp_lt_u32 s84, 63
    s_cselect_b32 s69, 40960, 0
    s_add_u32 s80, s80, s69
    s_xor_b32 s81, s81, 0x10000
    ds_read_b128 v[48:51], v5 offset:0
    ds_read_b128 v[52:55], v5 offset:1024
    ds_read_b128 v[56:59], v5 offset:2048
    ds_read_b128 v[60:63], v5 offset:3072
    s_waitcnt lgkmcnt(3)
    v_mfma_f32_32x32x16_bf16 v[16:31], v[48:51], a[0:3], 0
    s_mul_i32 s72, s34, 10240
    s_add_u32 s73, s72, s81
    s_add_u32 s72, s72, s80
    s_mov_b32 m0, s73
    s_nop 0
    buffer_load_dwordx4 v4, s[40:43], s72 offen sc1 lds
    ds_read_b128 v[48:51], v5 offset:4096
    s_waitcnt lgkmcnt(3)
    v_mfma_f32_32x32x16_bf16 v[16:31], v[52:55], a[4:7], v[16:31]
    ds_read_b128 v[52:55], v5 offset:5120
    s_waitcnt lgkmcnt(3)
    v_mfma_f32_32x32x16_bf16 v[16:31], v[56:59], a[8:11], v[16:31]
    buffer_load_dwordx4 v4, s[40:43], s72 offen offset:1024 sc1 lds
    ds_read_b128 v[56:59], v5 offset:6144
    s_waitcnt lgkmcnt(3)
    v_mfma_f32_32x32x16_bf16 v[16:31], v[60:63], a[12:15], v[16:31]
    ds_read_b128 v[60:63], v5 offset:7168
    s_waitcnt lgkmcnt(3)
    v_mfma_f32_32x32x16_bf16 v[16:31], v[48:51], a[16:19], v[16:31]
    buffer_load_dwordx4 v4, s[40:43], s72 offen offset:2048 sc1 lds
    ds_read_b128 v[48:51], v5 offset:8192
    s_waitcnt lgkmcnt(3)
    v_mfma_f32_32x32x16_bf16 v[16:31], v[52:55], a[20:23], v[16:31]
    ds_read_b128 v[52:55], v5 offset:9216
    s_waitcnt lgkmcnt(3)
    v_mfma_f32_32x32x16_bf16 v[16:31], v[56:59], a[24:27], v[16:31]
    buffer_load_dwordx4 v4, s[40:43], s72 offen offset:3072 sc1 lds
    ds_read_b128 v[56:59], v5 offset:10240
    s_waitcnt lgkmcnt(3)
    v_mfma_f32_32x32x16_bf16 v[16:31], v[60:63], a[28:31], v[16:31]
    ds_read_b128 v[60:63], v5 offset:11264
    s_waitcnt lgkmcnt(3)
    v_mfma_f32_32x32x16_bf16 v[16:31], v[48:51], a[32:35], v[16:31]
    s_add_u32 s73, s73, 4096
    s_mov_b32 m0, s73
    s_add_u32 s72, s72, 4096
    buffer_load_dwordx4 v4, s[40:43], s72 offen sc1 lds
    ds_read_b128 v[48:51], v5 offset:12288
    s_waitcnt lgkmcnt(3)
    v_mfma_f32_32x32x16_bf16 v[16:31], v[52:55], a[36:39], v[16:31]
    ds_read_b128 v[52:55], v5 offset:13312
    s_waitcnt lgkmcnt(3)
    v_mfma_f32_32x32x16_bf16 v[16:31], v[56:59], a[40:43], v[16:31]
    buffer_load_dwordx4 v4, s[40:43], s72 offen offset:1024 sc1 lds
    ds_read_b128 v[56:59], v5 offset:14336
    s_waitcnt lgkmcnt(3)
    v_mfma_f32_32x32x16_bf16 v[16:31], v[60:63], a[44:47], v[16:31]
    ds_read_b128 v[60:63], v5 offset:15360
    s_waitcnt lgkmcnt(3)
    v_mfma_f32_32x32x16_bf16 v[16:31], v[48:51], a[48:51], v[16:31]
    buffer_load_dwordx4 v4, s[40:43], s72 offen offset:2048 sc1 lds
    ds_read_b128 v[48:51], v5 offset:16384
    s_waitcnt lgkmcnt(3)
    v_mfma_f32_32x32x16_bf16 v[16:31], v[52:55], a[52:55], v[16:31]
    ds_read_b128 v[52:55], v5 offset:17408
    s_waitcnt lgkmcnt(3)
    v_mfma_f32_32x32x16_bf16 v[16:31], v[56:59], a[56:59], v[16:31]
    buffer_load_dwordx4 v4, s[40:43], s72 offen offset:3072 sc1 lds
    ds_read_b128 v[56:59], v5 offset:18432
    s_waitcnt lgkmcnt(3)
    v_mfma_f32_32x32x16_bf16 v[16:31], v[60:63], a[60:63], v[16:31]
    ds_read_b128 v[60:63], v5 offset:19456
    s_waitcnt lgkmcnt(3)
    v_mfma_f32_32x32x16_bf16 v[16:31], v[48:51], a[64:67], v[16:31]
    s_add_u32 s73, s73, 4096
    s_mov_b32 m0, s73
    s_add_u32 s72, s72, 4096
    buffer_load_dwordx4 v4, s[40:43], s72 offen sc1 lds
    ds_read_b128 v[48:51], v5 offset:20480
    s_waitcnt lgkmcnt(3)
    v_mfma_f32_32x32x16_bf16 v[16:31], v[52:55], a[68:71], v[16:31]
    ds_read_b128 v[52:55], v5 offset:21504
    s_waitcnt lgkmcnt(3)
    v_mfma_f32_32x32x16_bf16 v[16:31], v[56:59], a[72:75], v[16:31]
    buffer_load_dwordx4 v4, s[40:43], s72 offen offset:1024 sc1 lds
    ds_read_b128 v[56:59], v5 offset:22528
    s_waitcnt lgkmcnt(3)
    v_mfma_f32_32x32x16_bf16 v[16:31], v[60:63], a[76:79], v[16:31]
    ds_read_b128 v[60:63], v5 offset:23552
    s_waitcnt lgkmcnt(3)
    v_mfma_f32_32x32x16_bf16 v[16:31], v[48:51], a[80:83], v[16:31]
    s_add_u32 s69, s80, 81920
    buffer_load_dword v9, v7, s[40:43], s69 offen
    ds_read_b128 v[48:51], v5 offset:24576
    s_waitcnt lgkmcnt(3)
    v_mfma_f32_32x32x16_bf16 v[16:31], v[52:55], a[84:87], v[16:31]
    ds_read_b128 v[52:55], v5 offset:25600
    s_waitcnt lgkmcnt(3)
    v_mfma_f32_32x32x16_bf16 v[16:31], v[56:59], a[88:91], v[16:31]
    ds_read_b128 v[56:59], v5 offset:26624
    s_waitcnt lgkmcnt(3)
    v_mfma_f32_32x32x16_bf16 v[16:31], v[60:63], a[92:95], v[16:31]
    ds_read_b128 v[60:63], v5 offset:27648
    s_waitcnt lgkmcnt(3)
    v_mfma_f32_32x32x16_bf16 v[16:31], v[48:51], a[96:99], v[16:31]
    s_waitcnt vmcnt(11)
    s_barrier
    v_mov_b32 v1, s84
    s_mov_b64 exec, 1
    buffer_store_dword v1, off, s[40:43], s82 sc1
    s_mov_b64 exec, -1
    ds_read_b128 v[48:51], v5 offset:28672
    s_waitcnt lgkmcnt(3)
    v_mfma_f32_32x32x16_bf16 v[16:31], v[52:55], a[100:103], v[16:31]
    ds_read_b128 v[52:55], v5 offset:29696
    s_waitcnt lgkmcnt(3)
    v_mfma_f32_32x32x16_bf16 v[16:31], v[56:59], a[104:107], v[16:31]
    ds_read_b128 v[56:59], v5 offset:30720
    s_waitcnt lgkmcnt(3)
    v_mfma_f32_32x32x16_bf16 v[16:31], v[60:63], a[108:111], v[16:31]
    ds_read_b128 v[60:63], v5 offset:31744
    s_waitcnt lgkmcnt(3)
    v_mfma_f32_32x32x16_bf16 v[16:31], v[48:51], a[112:115], v[16:31]
    ds_read_b128 v[48:51], v5 offset:32768
    s_waitcnt lgkmcnt(3)
    v_mfma_f32_32x32x16_bf16 v[16:31], v[52:55], a[116:119], v[16:31]
    ds_read_b128 v[52:55], v5 offset:33792
    s_waitcnt lgkmcnt(3)
    v_mfma_f32_32x32x16_bf16 v[16:31], v[56:59], a[120:123], v[16:31]
    ds_read_b128 v[56:59], v5 offset:34816
    s_waitcnt lgkmcnt(3)
    v_mfma_f32_32x32x16_bf16 v[16:31], v[60:63], a[124:127], v[16:31]
    ds_read_b128 v[60:63], v5 offset:35840
    s_waitcnt lgkmcnt(3)
    v_mfma_f32_32x32x16_bf16 v[16:31], v[48:51], a[128:131], v[16:31]
    ds_read_b128 v[48:51], v5 offset:36864
    s_waitcnt lgkmcnt(3)
    v_mfma_f32_32x32x16_bf16 v[16:31], v[52:55], a[132:135], v[16:31]
    ds_read_b128 v[52:55], v5 offset:37888
    s_waitcnt lgkmcnt(3)
    v_mfma_f32_32x32x16_bf16 v[16:31], v[56:59], a[136:139], v[16:31]
    ds_read_b128 v[56:59], v5 offset:38912
    s_waitcnt lgkmcnt(3)
    v_mfma_f32_32x32x16_bf16 v[16:31], v[60:63], a[140:143], v[16:31]
    ds_read_b128 v[60:63], v5 offset:39936
    s_waitcnt lgkmcnt(3)
    v_mfma_f32_32x32x16_bf16 v[16:31], v[48:51], a[144:147], v[16:31]
    s_waitcnt lgkmcnt(2)
    v_mfma_f32_32x32x16_bf16 v[16:31], v[52:55], a[148:151], v[16:31]
    s_waitcnt lgkmcnt(1)
    v_mfma_f32_32x32x16_bf16 v[16:31], v[56:59], a[152:155], v[16:31]
    s_waitcnt lgkmcnt(0)
    v_mfma_f32_32x32x16_bf16 v[16:31], v[60:63], a[156:159], v[16:31]
    v_xor_b32 v5, 0x10000, v5
    s_nop 10
    v_cvt_pk_bf16_f32 v64, v16, v17
    v_cvt_pk_bf16_f32 v65, v18, v19
    v_cvt_pk_bf16_f32 v66, v24, v25
    v_cvt_pk_bf16_f32 v67, v26, v27
    v_cvt_pk_bf16_f32 v68, v20, v21
    v_cvt_pk_bf16_f32 v69, v22, v23
    v_cvt_pk_bf16_f32 v70, v28, v29
    v_cvt_pk_bf16_f32 v71, v30, v31
    buffer_store_dwordx4 v[64:67], v6, s[40:43], s83 offen offset:0 sc1
    buffer_store_dwordx4 v[68:71], v6, s[40:43], s83 offen offset:512 sc1
    s_add_u32 s83, s83, 0x40000
    s_add_u32 s84, s84, 1
    s_cmp_gt_u32 s84, 2
    s_cbranch_scc1 EF_223
    s_waitcnt vmcnt(0)
    s_barrier
    v_mov_b32 v1, s84
    s_mov_b64 exec, 1
    buffer_store_dword v1, off, s[40:43], s82 sc1
    s_mov_b64 exec, -1
EF_223:
    s_waitcnt vmcnt(3)
    s_cmp_lt_u32 s84, 64
    s_cbranch_scc1 KV_LOOP_V
    s_waitcnt vmcnt(0)
    s_barrier
    v_mov_b32 v1, s84
    s_mov_b64 exec, 1
    buffer_store_dword v1, off, s[40:43], s82 sc1
    s_mov_b64 exec, -1
    s_branch END
FAIL:
    s_lshl_b32 s69, s2, 2
    s_add_u32 s69, s69, 0x5020000
    v_mov_b32 v1, s68
    s_mov_b64 exec, 1
    buffer_store_dword v1, off, s[40:43], s69 sc1
    s_waitcnt vmcnt(0)
END:
    s_endpgm
.section .rodata,"a"
.p2align 6
.amdhsa_kernel parallel_sum__memory_aug_recurrent_mem_tr__swiglu_ffn__prompt_kernel
  .amdhsa_next_free_vgpr 512
  .amdhsa_next_free_sgpr 102
  .amdhsa_accum_offset 256
  .amdhsa_group_segment_fixed_size 0
  .amdhsa_kernarg_size 112
  .amdhsa_user_sgpr_count 2
  .amdhsa_user_sgpr_kernarg_segment_ptr 1
  .amdhsa_system_sgpr_workgroup_id_x 1
  .amdhsa_float_denorm_mode_32 3
.end_amdhsa_kernel
```
